```python
import torch

def _softmax(x, axis=-1):
    return torch.softmax(x, dim=axis)
def _gelu(x):
    return torch.nn.functional.gelu(x, approximate="tanh")
def _silu(x):
    return torch.nn.functional.silu(x)
def _sigmoid(x):
    return torch.sigmoid(x)
def _layernorm(x, axis=-1, eps=1e-5):
    m = x.mean(dim=axis, keepdim=True)
    v = x.var(dim=axis, keepdim=True, unbiased=False)
    return (x - m) / torch.sqrt(v + eps)
def _scatter_add(tgt, idx, src, axis=0):
    return tgt.clone().index_add_(axis, idx, src)
def _segment_sum(src, seg, n):
    out = torch.zeros((n,) + src.shape[1:], dtype=src.dtype)
    return out.index_add_(0, seg, src)
def _pad(x, pw):
    flat = tuple(v for pair in reversed(pw) for v in pair)
    return torch.nn.functional.pad(x, flat)

kernel_name = 'recurrent_scan__sliding_block__glu_gated_swiglu__prompt'

def setup_inputs():

    _w = (lambda a: (lambda t: t.to(torch.bfloat16) if t.is_floating_point() else t)(torch.as_tensor(a)))
    def _A_setup():
        B, S, D = 1, 2048, 512
        return {
            "x": _w((lambda *s: torch.randn(*s, dtype=torch.bfloat16) * 0.05)(B, S, D)),
            "wqkv": _w((lambda *s: torch.randn(*s, dtype=torch.bfloat16) * 0.2)(D, 3 * D)),
            "wo": _w((lambda *s: torch.randn(*s, dtype=torch.bfloat16) * 0.2)(D, D)),
        }
    _A_in = _A_setup()

    def _B_setup():
        B, S, D, F = 1, 2048, 512, 1376
        return {
            "x": _w((lambda *s: torch.randn(*s, dtype=torch.bfloat16) * 0.05)(B, S, D)),
            "w1": _w((lambda *s: torch.randn(*s, dtype=torch.bfloat16) * 0.1)(D, F) * (2.0 / D) ** 0.5),
            "w3": _w((lambda *s: torch.randn(*s, dtype=torch.bfloat16) * 0.1)(D, F) * (2.0 / D) ** 0.5),
            "w2": _w((lambda *s: torch.randn(*s, dtype=torch.bfloat16) * 0.1)(F, D) * (2.0 / F) ** 0.5),
        }
    _B_in = _B_setup()

    return {
        "A_x": _A_in["x"],
        "A_wqkv": _A_in["wqkv"],
        "A_wo": _A_in["wo"],
        "B_x": _B_in["x"],
        "B_w1": _B_in["w1"],
        "B_w3": _B_in["w3"],
        "B_w2": _B_in["w2"],
    }

def reference(A_x, A_wqkv, A_wo, B_x, B_w1, B_w3, B_w2):
    def _A_ref(x, wqkv, wo):
        B, S, D = x.shape
        H = 32; Dh = D // H; W = 256
        qkv = (lambda x, *d: x.permute(*d))((x @ wqkv).reshape(B, S, 3, H, Dh), 2, 0, 3, 1, 4)
        q, k, v = qkv[0], qkv[1], qkv[2]
        scores = torch.einsum("bhqd,bhkd->bhqk", q, k) * (Dh ** -0.5)
        idx = torch.arange(S)
        mask = (idx[:, None] - idx[None, :] >= 0) & (idx[:, None] - idx[None, :] < W)
        scores = torch.where(mask[None, None], scores, -1e9)
        p = _softmax(scores, axis=-1)
        o = torch.einsum("bhqk,bhkd->bhqd", p, v)
        return (lambda x, *d: x.permute(*d))(o, 0, 2, 1, 3).reshape(B, S, D) @ wo

    def _B_ref(x, w1, w3, w2):
        gate = torch.einsum("bsd,df->bsf", x, w1)
        up = torch.einsum("bsd,df->bsf", x, w3)
        h = _silu(gate) * up
        out = torch.einsum("bsf,fd->bsd", h, w2)
        return out

    x = A_x
    xn = _layernorm(x, axis=-1)
    s = _A_ref(xn, A_wqkv, A_wo)
    g = _silu(_B_ref(xn, B_w1, B_w3, B_w2))
    return x + s * g
```

```asm
; @launch kernel=k1_gemm_kernel grid=(256,1,1) block=(512,1,1) lds=143360
; @launch kernel=k2_attn_kernel grid=(512,1,1) block=(256,1,1) lds=0
; @launch kernel=k3_out_kernel grid=(256,1,1) block=(256,1,1) lds=131072
.amdgcn_target "amdgcn-amd-amdhsa--gfx950"
.text
.p2align 8
.globl k1_gemm_kernel
.type k1_gemm_kernel,@function
k1_gemm_kernel:
    s_cmp_ge_u32 s2, 256
    s_nop 0
    s_cbranch_scc1 L_k1_exit
    s_load_dwordx2 s[20:21], s[0:1], 0
    s_load_dwordx2 s[22:23], s[0:1], 8
    s_load_dwordx2 s[24:25], s[0:1], 32
    s_load_dwordx2 s[26:27], s[0:1], 40
    s_load_dwordx2 s[28:29], s[0:1], 72
    v_and_b32 v1, 63, v0
    v_and_b32 v20, 31, v0
    v_lshrrev_b32 v21, 6, v0
    s_nop 0
    v_readfirstlane_b32 s16, v21
    s_lshr_b32 s17, s2, 5
    s_and_b32 s18, s2, 7
    s_lshl_b32 s18, s18, 2
    s_bfe_u32 s46, s2, 0x20003
    s_add_u32 s18, s18, s46
    s_mov_b32 s50, 0
    s_mov_b32 s51, -1
    s_waitcnt lgkmcnt(0)
    s_mov_b32 s4, s20
    s_mov_b32 s5, s21
    s_mov_b32 s6, 0x200000
    s_mov_b32 s7, 0x00020000
    s_mov_b32 s12, s28
    s_mov_b32 s13, s29
    s_mov_b32 s14, 0x10000000
    s_mov_b32 s15, 0x00020000
    s_cmp_ge_u32 s18, 10
    s_nop 0
    s_cbranch_scc1 L_k1_ffn
    s_cmp_ge_u32 s18, 6
    s_nop 0
    s_cbranch_scc1 L_k1_v
    s_cmp_ge_u32 s16, 6
    s_cselect_b32 s46, 1, 0
    s_cselect_b32 s47, 6, 0
    s_sub_u32 s47, s16, s47
    s_mov_b32 s8, s22
    s_mov_b32 s9, s23
    s_mov_b32 s10, 0x180000
    s_mov_b32 s11, 0x00020000
    s_mul_i32 s35, s18, 6
    s_cmp_ge_u32 s16, 6
    s_cselect_b32 s48, 6, 0
    s_sub_u32 s19, s16, s48
    s_add_u32 s52, s35, s47
    s_min_u32 s52, s52, 47
    s_lshl_b32 s52, s52, 6
    s_and_b32 s48, s16, 3
    s_add_u32 s48, s48, 2
    s_add_u32 s53, s35, s48
    s_min_u32 s53, s53, 31
    s_lshl_b32 s53, s53, 6
    s_min_u32 s52, s52, 1984
    s_mul_i32 s63, s48, 10240
    s_add_u32 s63, s63, 82944
    s_mov_b32 s59, 49152
    s_mul_i32 s62, s47, 10240
    s_lshl_b32 s48, s46, 10
    s_add_u32 s62, s62, s48
    s_add_u32 s62, s62, 81920
    s_mul_i32 s58, s46, 49152
    s_add_u32 s36, s19, 0
    s_cmp_ge_u32 s36, 6
    s_cselect_b32 s48, 6, 0
    s_sub_u32 s36, s36, s48
    s_add_u32 s37, s19, 1
    s_cmp_ge_u32 s37, 6
    s_cselect_b32 s48, 6, 0
    s_sub_u32 s37, s37, s48
    s_add_u32 s38, s19, 2
    s_cmp_ge_u32 s38, 6
    s_cselect_b32 s48, 6, 0
    s_sub_u32 s38, s38, s48
    s_add_u32 s39, s19, 3
    s_cmp_ge_u32 s39, 6
    s_cselect_b32 s48, 6, 0
    s_sub_u32 s39, s39, s48
    s_add_u32 s40, s19, 4
    s_cmp_ge_u32 s40, 6
    s_cselect_b32 s48, 6, 0
    s_sub_u32 s40, s40, s48
    s_add_u32 s41, s19, 5
    s_cmp_ge_u32 s41, 6
    s_cselect_b32 s48, 6, 0
    s_sub_u32 s41, s41, s48
    s_lshl_b32 s30, s17, 18
    s_add_u32 s31, s30, 16384
    s_mul_i32 s33, s16, 10240
    v_lshrrev_b32 v21, 2, v1
    v_lshlrev_b32 v21, 10, v21
    s_lshl_b32 s48, s16, 15
    v_add_u32 v14, s48, v21
    v_lshrrev_b32 v21, 4, v1
    v_xor_b32 v21, v21, v1
    v_and_b32 v21, 3, v21
    v_lshl_add_u32 v14, v21, 4, v14
    v_lshrrev_b32 v21, 2, v1
    s_movk_i32 s48, 3072
    v_mul_lo_u32 v21, v21, s48
    v_and_b32 v22, 3, v1
    v_lshl_add_u32 v21, v22, 4, v21
    v_add_u32 v15, s52, v21
    v_add_u32 v16, s53, v21
    v_lshrrev_b32 v21, 5, v1
    v_bfe_u32 v22, v1, 2, 2
    v_lshlrev_b32 v23, 6, v20
    v_add_u32 v23, s33, v23
    v_add_u32 v24, 0, v21
    v_xor_b32 v24, v24, v22
    v_lshl_add_u32 v2, v24, 4, v23
    v_add_u32 v24, 2, v21
    v_xor_b32 v24, v24, v22
    v_lshl_add_u32 v3, v24, 4, v23
    v_lshrrev_b32 v21, 5, v1
    v_bfe_u32 v22, v1, 2, 2
    v_lshl_add_u32 v21, v21, 3, v22
    v_lshlrev_b32 v21, 6, v21
    v_bfe_u32 v22, v1, 4, 1
    v_lshl_add_u32 v21, v22, 5, v21
    v_and_b32 v22, 3, v1
    v_lshl_add_u32 v21, v22, 3, v21
    s_mul_i32 s48, s36, 10240
    s_add_u32 s48, s48, 81920
    v_add_u32 v4, s48, v21
    s_mul_i32 s48, s37, 10240
    s_add_u32 s48, s48, 81920
    v_add_u32 v5, s48, v21
    s_mul_i32 s48, s38, 10240
    s_add_u32 s48, s48, 81920
    v_add_u32 v6, s48, v21
    s_mul_i32 s48, s39, 10240
    s_add_u32 s48, s48, 81920
    v_add_u32 v7, s48, v21
    s_mul_i32 s48, s40, 10240
    s_add_u32 s48, s48, 81920
    v_add_u32 v8, s48, v21
    s_mul_i32 s48, s41, 10240
    s_add_u32 s48, s48, 81920
    v_add_u32 v9, s48, v21
    v_mov_b32 v88, 0
    v_mov_b32 v89, 0
    v_mov_b32 v90, 0
    v_mov_b32 v91, 0
    s_mov_b32 s54, 0x3f803f80
    s_add_u32 m0, s33, 0
    s_nop 0
    buffer_load_dwordx4 v14, s[4:7], s30 offen lds
    s_add_u32 m0, s33, 1024
    s_nop 0
    buffer_load_dwordx4 v14, s[4:7], s31 offen lds
    s_add_u32 m0, s62, 0
    s_nop 0
    buffer_load_dwordx4 v15, s[8:11], s58 offen lds
    s_add_u32 m0, s63, 0
    s_nop 0
    buffer_load_dwordx4 v16, s[8:11], s59 offen lds
    s_add_u32 s30, s30, 64
    s_add_u32 s31, s31, 64
    s_add_u32 s58, s58, 98304
    s_add_u32 s59, s59, 98304
    s_add_u32 m0, s33, 2048
    s_nop 0
    buffer_load_dwordx4 v14, s[4:7], s30 offen lds
    s_add_u32 m0, s33, 3072
    s_nop 0
    buffer_load_dwordx4 v14, s[4:7], s31 offen lds
    s_add_u32 m0, s62, 2048
    s_nop 0
    buffer_load_dwordx4 v15, s[8:11], s58 offen lds
    s_add_u32 m0, s63, 2048
    s_nop 0
    buffer_load_dwordx4 v16, s[8:11], s59 offen lds
    s_add_u32 s30, s30, 64
    s_add_u32 s31, s31, 64
    s_add_u32 s58, s58, 98304
    s_add_u32 s59, s59, 98304
    s_add_u32 m0, s33, 4096
    s_nop 0
    buffer_load_dwordx4 v14, s[4:7], s30 offen lds
    s_add_u32 m0, s33, 5120
    s_nop 0
    buffer_load_dwordx4 v14, s[4:7], s31 offen lds
    s_add_u32 m0, s62, 4096
    s_nop 0
    buffer_load_dwordx4 v15, s[8:11], s58 offen lds
    s_add_u32 m0, s63, 4096
    s_nop 0
    buffer_load_dwordx4 v16, s[8:11], s59 offen lds
    s_add_u32 s30, s30, 64
    s_add_u32 s31, s31, 64
    s_add_u32 s58, s58, 98304
    s_add_u32 s59, s59, 98304
    s_waitcnt vmcnt(8)
    s_barrier
    ds_read_b128 v[64:67], v2 offset:0
    ds_read_b64_tr_b16 v[72:73], v4 offset:0
    ds_read_b64_tr_b16 v[74:75], v4 offset:256
    ds_read_b64_tr_b16 v[76:77], v5 offset:0
    ds_read_b64_tr_b16 v[78:79], v5 offset:256
    ds_read_b64_tr_b16 v[80:81], v6 offset:0
    ds_read_b64_tr_b16 v[82:83], v6 offset:256
    ds_read_b64_tr_b16 v[84:85], v7 offset:0
    ds_read_b64_tr_b16 v[86:87], v7 offset:256
    s_waitcnt lgkmcnt(6)
    v_mfma_f32_32x32x16_bf16 v[96:111], v[72:75], v[64:67], 0
    v_dot2_f32_bf16 v88, v64, s54, v88
    v_dot2_f32_bf16 v89, v64, v64, v89
    v_dot2_f32_bf16 v88, v65, s54, v88
    v_dot2_f32_bf16 v89, v65, v65, v89
    v_dot2_f32_bf16 v88, v66, s54, v88
    v_dot2_f32_bf16 v89, v66, v66, v89
    v_dot2_f32_bf16 v88, v67, s54, v88
    v_dot2_f32_bf16 v89, v67, v67, v89
    v_dot2_f32_bf16 v90, v72, s54, v90
    v_dot2_f32_bf16 v90, v73, s54, v90
    v_dot2_f32_bf16 v90, v74, s54, v90
    v_dot2_f32_bf16 v90, v75, s54, v90
    s_add_u32 m0, s33, 6144
    s_nop 0
    buffer_load_dwordx4 v14, s[4:7], s30 offen lds
    ds_read_b64_tr_b16 v[72:73], v8 offset:0
    ds_read_b64_tr_b16 v[74:75], v8 offset:256
    s_waitcnt lgkmcnt(6)
    v_mfma_f32_32x32x16_bf16 v[112:127], v[76:79], v[64:67], 0
    s_add_u32 m0, s33, 7168
    s_nop 0
    buffer_load_dwordx4 v14, s[4:7], s31 offen lds
    ds_read_b64_tr_b16 v[76:77], v9 offset:0
    ds_read_b64_tr_b16 v[78:79], v9 offset:256
    s_waitcnt lgkmcnt(6)
    v_mfma_f32_32x32x16_bf16 v[128:143], v[80:83], v[64:67], 0
    s_add_u32 m0, s62, 6144
    s_nop 0
    buffer_load_dwordx4 v15, s[8:11], s58 offen lds
    ds_read_b128 v[68:71], v3 offset:0
    ds_read_b64_tr_b16 v[80:81], v4 offset:1024
    ds_read_b64_tr_b16 v[82:83], v4 offset:1280
    s_waitcnt lgkmcnt(7)
    v_mfma_f32_32x32x16_bf16 v[144:159], v[84:87], v[64:67], 0
    s_add_u32 m0, s63, 6144
    s_nop 0
    buffer_load_dwordx4 v16, s[8:11], s59 offen lds
    ds_read_b64_tr_b16 v[84:85], v5 offset:1024
    ds_read_b64_tr_b16 v[86:87], v5 offset:1280
    s_waitcnt lgkmcnt(7)
    v_mfma_f32_32x32x16_bf16 v[160:175], v[72:75], v[64:67], 0
    s_add_u32 s30, s30, 64
    s_add_u32 s31, s31, 64
    s_add_u32 s58, s58, 98304
    s_add_u32 s59, s59, 98304
    ds_read_b64_tr_b16 v[72:73], v6 offset:1024
    ds_read_b64_tr_b16 v[74:75], v6 offset:1280
    s_waitcnt lgkmcnt(7)
    v_mfma_f32_32x32x16_bf16 v[176:191], v[76:79], v[64:67], 0
    ds_read_b64_tr_b16 v[76:77], v7 offset:1024
    ds_read_b64_tr_b16 v[78:79], v7 offset:1280
    s_waitcnt lgkmcnt(6)
    v_mfma_f32_32x32x16_bf16 v[96:111], v[80:83], v[68:71], v[96:111]
    v_dot2_f32_bf16 v88, v68, s54, v88
    v_dot2_f32_bf16 v89, v68, v68, v89
    v_dot2_f32_bf16 v88, v69, s54, v88
    v_dot2_f32_bf16 v89, v69, v69, v89
    v_dot2_f32_bf16 v88, v70, s54, v88
    v_dot2_f32_bf16 v89, v70, v70, v89
    v_dot2_f32_bf16 v88, v71, s54, v88
    v_dot2_f32_bf16 v89, v71, v71, v89
    v_dot2_f32_bf16 v90, v80, s54, v90
    v_dot2_f32_bf16 v90, v81, s54, v90
    v_dot2_f32_bf16 v90, v82, s54, v90
    v_dot2_f32_bf16 v90, v83, s54, v90
    ds_read_b64_tr_b16 v[80:81], v8 offset:1024
    ds_read_b64_tr_b16 v[82:83], v8 offset:1280
    s_waitcnt lgkmcnt(6)
    v_mfma_f32_32x32x16_bf16 v[112:127], v[84:87], v[68:71], v[112:127]
    ds_read_b64_tr_b16 v[84:85], v9 offset:1024
    ds_read_b64_tr_b16 v[86:87], v9 offset:1280
    s_waitcnt lgkmcnt(6)
    v_mfma_f32_32x32x16_bf16 v[128:143], v[72:75], v[68:71], v[128:143]
    s_waitcnt vmcnt(8)
    s_barrier
    ds_read_b128 v[64:67], v2 offset:2048
    ds_read_b64_tr_b16 v[72:73], v4 offset:2048
    ds_read_b64_tr_b16 v[74:75], v4 offset:2304
    s_waitcnt lgkmcnt(7)
    v_mfma_f32_32x32x16_bf16 v[144:159], v[76:79], v[68:71], v[144:159]
    s_add_u32 m0, s33, 8192
    s_nop 0
    buffer_load_dwordx4 v14, s[4:7], s30 offen lds
    ds_read_b64_tr_b16 v[76:77], v5 offset:2048
    ds_read_b64_tr_b16 v[78:79], v5 offset:2304
    s_waitcnt lgkmcnt(7)
    v_mfma_f32_32x32x16_bf16 v[160:175], v[80:83], v[68:71], v[160:175]
    s_add_u32 m0, s33, 9216
    s_nop 0
    buffer_load_dwordx4 v14, s[4:7], s31 offen lds
    ds_read_b64_tr_b16 v[80:81], v6 offset:2048
    ds_read_b64_tr_b16 v[82:83], v6 offset:2304
    s_waitcnt lgkmcnt(7)
    v_mfma_f32_32x32x16_bf16 v[176:191], v[84:87], v[68:71], v[176:191]
    s_add_u32 m0, s62, 8192
    s_nop 0
    buffer_load_dwordx4 v15, s[8:11], s58 offen lds
    ds_read_b64_tr_b16 v[84:85], v7 offset:2048
    ds_read_b64_tr_b16 v[86:87], v7 offset:2304
    s_waitcnt lgkmcnt(6)
    v_mfma_f32_32x32x16_bf16 v[96:111], v[72:75], v[64:67], v[96:111]
    v_dot2_f32_bf16 v88, v64, s54, v88
    v_dot2_f32_bf16 v89, v64, v64, v89
    v_dot2_f32_bf16 v88, v65, s54, v88
    v_dot2_f32_bf16 v89, v65, v65, v89
    v_dot2_f32_bf16 v88, v66, s54, v88
    v_dot2_f32_bf16 v89, v66, v66, v89
    v_dot2_f32_bf16 v88, v67, s54, v88
    v_dot2_f32_bf16 v89, v67, v67, v89
    v_dot2_f32_bf16 v90, v72, s54, v90
    v_dot2_f32_bf16 v90, v73, s54, v90
    v_dot2_f32_bf16 v90, v74, s54, v90
    v_dot2_f32_bf16 v90, v75, s54, v90
    s_add_u32 m0, s63, 8192
    s_nop 0
    buffer_load_dwordx4 v16, s[8:11], s59 offen lds
    ds_read_b64_tr_b16 v[72:73], v8 offset:2048
    ds_read_b64_tr_b16 v[74:75], v8 offset:2304
    s_waitcnt lgkmcnt(6)
    v_mfma_f32_32x32x16_bf16 v[112:127], v[76:79], v[64:67], v[112:127]
    s_add_u32 s30, s30, 64
    s_add_u32 s31, s31, 64
    s_add_u32 s58, s58, 98304
    s_add_u32 s59, s59, 98304
    ds_read_b64_tr_b16 v[76:77], v9 offset:2048
    ds_read_b64_tr_b16 v[78:79], v9 offset:2304
    s_waitcnt lgkmcnt(6)
    v_mfma_f32_32x32x16_bf16 v[128:143], v[80:83], v[64:67], v[128:143]
    ds_read_b128 v[68:71], v3 offset:2048
    ds_read_b64_tr_b16 v[80:81], v4 offset:3072
    ds_read_b64_tr_b16 v[82:83], v4 offset:3328
    s_waitcnt lgkmcnt(7)
    v_mfma_f32_32x32x16_bf16 v[144:159], v[84:87], v[64:67], v[144:159]
    ds_read_b64_tr_b16 v[84:85], v5 offset:3072
    ds_read_b64_tr_b16 v[86:87], v5 offset:3328
    s_waitcnt lgkmcnt(7)
    v_mfma_f32_32x32x16_bf16 v[160:175], v[72:75], v[64:67], v[160:175]
    ds_read_b64_tr_b16 v[72:73], v6 offset:3072
    ds_read_b64_tr_b16 v[74:75], v6 offset:3328
    s_waitcnt lgkmcnt(7)
    v_mfma_f32_32x32x16_bf16 v[176:191], v[76:79], v[64:67], v[176:191]
    ds_read_b64_tr_b16 v[76:77], v7 offset:3072
    ds_read_b64_tr_b16 v[78:79], v7 offset:3328
    s_waitcnt lgkmcnt(6)
    v_mfma_f32_32x32x16_bf16 v[96:111], v[80:83], v[68:71], v[96:111]
    v_dot2_f32_bf16 v88, v68, s54, v88
    v_dot2_f32_bf16 v89, v68, v68, v89
    v_dot2_f32_bf16 v88, v69, s54, v88
    v_dot2_f32_bf16 v89, v69, v69, v89
    v_dot2_f32_bf16 v88, v70, s54, v88
    v_dot2_f32_bf16 v89, v70, v70, v89
    v_dot2_f32_bf16 v88, v71, s54, v88
    v_dot2_f32_bf16 v89, v71, v71, v89
    v_dot2_f32_bf16 v90, v80, s54, v90
    v_dot2_f32_bf16 v90, v81, s54, v90
    v_dot2_f32_bf16 v90, v82, s54, v90
    v_dot2_f32_bf16 v90, v83, s54, v90
    ds_read_b64_tr_b16 v[80:81], v8 offset:3072
    ds_read_b64_tr_b16 v[82:83], v8 offset:3328
    s_waitcnt lgkmcnt(6)
    v_mfma_f32_32x32x16_bf16 v[112:127], v[84:87], v[68:71], v[112:127]
    ds_read_b64_tr_b16 v[84:85], v9 offset:3072
    ds_read_b64_tr_b16 v[86:87], v9 offset:3328
    s_waitcnt lgkmcnt(6)
    v_mfma_f32_32x32x16_bf16 v[128:143], v[72:75], v[68:71], v[128:143]
    s_waitcnt vmcnt(8)
    s_barrier
    ds_read_b128 v[64:67], v2 offset:4096
    ds_read_b64_tr_b16 v[72:73], v4 offset:4096
    ds_read_b64_tr_b16 v[74:75], v4 offset:4352
    s_waitcnt lgkmcnt(7)
    v_mfma_f32_32x32x16_bf16 v[144:159], v[76:79], v[68:71], v[144:159]
    s_add_u32 m0, s33, 0
    s_nop 0
    buffer_load_dwordx4 v14, s[4:7], s30 offen lds
    ds_read_b64_tr_b16 v[76:77], v5 offset:4096
    ds_read_b64_tr_b16 v[78:79], v5 offset:4352
    s_waitcnt lgkmcnt(7)
    v_mfma_f32_32x32x16_bf16 v[160:175], v[80:83], v[68:71], v[160:175]
    s_add_u32 m0, s33, 1024
    s_nop 0
    buffer_load_dwordx4 v14, s[4:7], s31 offen lds
    ds_read_b64_tr_b16 v[80:81], v6 offset:4096
    ds_read_b64_tr_b16 v[82:83], v6 offset:4352
    s_waitcnt lgkmcnt(7)
    v_mfma_f32_32x32x16_bf16 v[176:191], v[84:87], v[68:71], v[176:191]
    s_add_u32 m0, s62, 0
    s_nop 0
    buffer_load_dwordx4 v15, s[8:11], s58 offen lds
    ds_read_b64_tr_b16 v[84:85], v7 offset:4096
    ds_read_b64_tr_b16 v[86:87], v7 offset:4352
    s_waitcnt lgkmcnt(6)
    v_mfma_f32_32x32x16_bf16 v[96:111], v[72:75], v[64:67], v[96:111]
    v_dot2_f32_bf16 v88, v64, s54, v88
    v_dot2_f32_bf16 v89, v64, v64, v89
    v_dot2_f32_bf16 v88, v65, s54, v88
    v_dot2_f32_bf16 v89, v65, v65, v89
    v_dot2_f32_bf16 v88, v66, s54, v88
    v_dot2_f32_bf16 v89, v66, v66, v89
    v_dot2_f32_bf16 v88, v67, s54, v88
    v_dot2_f32_bf16 v89, v67, v67, v89
    v_dot2_f32_bf16 v90, v72, s54, v90
    v_dot2_f32_bf16 v90, v73, s54, v90
    v_dot2_f32_bf16 v90, v74, s54, v90
    v_dot2_f32_bf16 v90, v75, s54, v90
    s_add_u32 m0, s63, 0
    s_nop 0
    buffer_load_dwordx4 v16, s[8:11], s59 offen lds
    ds_read_b64_tr_b16 v[72:73], v8 offset:4096
    ds_read_b64_tr_b16 v[74:75], v8 offset:4352
    s_waitcnt lgkmcnt(6)
    v_mfma_f32_32x32x16_bf16 v[112:127], v[76:79], v[64:67], v[112:127]
    s_add_u32 s30, s30, 64
    s_add_u32 s31, s31, 64
    s_add_u32 s58, s58, 98304
    s_add_u32 s59, s59, 98304
    ds_read_b64_tr_b16 v[76:77], v9 offset:4096
    ds_read_b64_tr_b16 v[78:79], v9 offset:4352
    s_waitcnt lgkmcnt(6)
    v_mfma_f32_32x32x16_bf16 v[128:143], v[80:83], v[64:67], v[128:143]
    ds_read_b128 v[68:71], v3 offset:4096
    ds_read_b64_tr_b16 v[80:81], v4 offset:5120
    ds_read_b64_tr_b16 v[82:83], v4 offset:5376
    s_waitcnt lgkmcnt(7)
    v_mfma_f32_32x32x16_bf16 v[144:159], v[84:87], v[64:67], v[144:159]
    ds_read_b64_tr_b16 v[84:85], v5 offset:5120
    ds_read_b64_tr_b16 v[86:87], v5 offset:5376
    s_waitcnt lgkmcnt(7)
    v_mfma_f32_32x32x16_bf16 v[160:175], v[72:75], v[64:67], v[160:175]
    ds_read_b64_tr_b16 v[72:73], v6 offset:5120
    ds_read_b64_tr_b16 v[74:75], v6 offset:5376
    s_waitcnt lgkmcnt(7)
    v_mfma_f32_32x32x16_bf16 v[176:191], v[76:79], v[64:67], v[176:191]
    ds_read_b64_tr_b16 v[76:77], v7 offset:5120
    ds_read_b64_tr_b16 v[78:79], v7 offset:5376
    s_waitcnt lgkmcnt(6)
    v_mfma_f32_32x32x16_bf16 v[96:111], v[80:83], v[68:71], v[96:111]
    v_dot2_f32_bf16 v88, v68, s54, v88
    v_dot2_f32_bf16 v89, v68, v68, v89
    v_dot2_f32_bf16 v88, v69, s54, v88
    v_dot2_f32_bf16 v89, v69, v69, v89
    v_dot2_f32_bf16 v88, v70, s54, v88
    v_dot2_f32_bf16 v89, v70, v70, v89
    v_dot2_f32_bf16 v88, v71, s54, v88
    v_dot2_f32_bf16 v89, v71, v71, v89
    v_dot2_f32_bf16 v90, v80, s54, v90
    v_dot2_f32_bf16 v90, v81, s54, v90
    v_dot2_f32_bf16 v90, v82, s54, v90
    v_dot2_f32_bf16 v90, v83, s54, v90
    ds_read_b64_tr_b16 v[80:81], v8 offset:5120
    ds_read_b64_tr_b16 v[82:83], v8 offset:5376
    s_waitcnt lgkmcnt(6)
    v_mfma_f32_32x32x16_bf16 v[112:127], v[84:87], v[68:71], v[112:127]
    ds_read_b64_tr_b16 v[84:85], v9 offset:5120
    ds_read_b64_tr_b16 v[86:87], v9 offset:5376
    s_waitcnt lgkmcnt(6)
    v_mfma_f32_32x32x16_bf16 v[128:143], v[72:75], v[68:71], v[128:143]
    s_waitcnt vmcnt(8)
    s_barrier
    ds_read_b128 v[64:67], v2 offset:6144
    ds_read_b64_tr_b16 v[72:73], v4 offset:6144
    ds_read_b64_tr_b16 v[74:75], v4 offset:6400
    s_waitcnt lgkmcnt(7)
    v_mfma_f32_32x32x16_bf16 v[144:159], v[76:79], v[68:71], v[144:159]
    s_add_u32 m0, s33, 2048
    s_nop 0
    buffer_load_dwordx4 v14, s[4:7], s30 offen lds
    ds_read_b64_tr_b16 v[76:77], v5 offset:6144
    ds_read_b64_tr_b16 v[78:79], v5 offset:6400
    s_waitcnt lgkmcnt(7)
    v_mfma_f32_32x32x16_bf16 v[160:175], v[80:83], v[68:71], v[160:175]
    s_add_u32 m0, s33, 3072
    s_nop 0
    buffer_load_dwordx4 v14, s[4:7], s31 offen lds
    ds_read_b64_tr_b16 v[80:81], v6 offset:6144
    ds_read_b64_tr_b16 v[82:83], v6 offset:6400
    s_waitcnt lgkmcnt(7)
    v_mfma_f32_32x32x16_bf16 v[176:191], v[84:87], v[68:71], v[176:191]
    s_add_u32 m0, s62, 2048
    s_nop 0
    buffer_load_dwordx4 v15, s[8:11], s58 offen lds
    ds_read_b64_tr_b16 v[84:85], v7 offset:6144
    ds_read_b64_tr_b16 v[86:87], v7 offset:6400
    s_waitcnt lgkmcnt(6)
    v_mfma_f32_32x32x16_bf16 v[96:111], v[72:75], v[64:67], v[96:111]
    v_dot2_f32_bf16 v88, v64, s54, v88
    v_dot2_f32_bf16 v89, v64, v64, v89
    v_dot2_f32_bf16 v88, v65, s54, v88
    v_dot2_f32_bf16 v89, v65, v65, v89
    v_dot2_f32_bf16 v88, v66, s54, v88
    v_dot2_f32_bf16 v89, v66, v66, v89
    v_dot2_f32_bf16 v88, v67, s54, v88
    v_dot2_f32_bf16 v89, v67, v67, v89
    v_dot2_f32_bf16 v90, v72, s54, v90
    v_dot2_f32_bf16 v90, v73, s54, v90
    v_dot2_f32_bf16 v90, v74, s54, v90
    v_dot2_f32_bf16 v90, v75, s54, v90
    s_add_u32 m0, s63, 2048
    s_nop 0
    buffer_load_dwordx4 v16, s[8:11], s59 offen lds
    ds_read_b64_tr_b16 v[72:73], v8 offset:6144
    ds_read_b64_tr_b16 v[74:75], v8 offset:6400
    s_waitcnt lgkmcnt(6)
    v_mfma_f32_32x32x16_bf16 v[112:127], v[76:79], v[64:67], v[112:127]
    s_add_u32 s30, s30, 64
    s_add_u32 s31, s31, 64
    s_add_u32 s58, s58, 98304
    s_add_u32 s59, s59, 98304
    ds_read_b64_tr_b16 v[76:77], v9 offset:6144
    ds_read_b64_tr_b16 v[78:79], v9 offset:6400
    s_waitcnt lgkmcnt(6)
    v_mfma_f32_32x32x16_bf16 v[128:143], v[80:83], v[64:67], v[128:143]
    ds_read_b128 v[68:71], v3 offset:6144
    ds_read_b64_tr_b16 v[80:81], v4 offset:7168
    ds_read_b64_tr_b16 v[82:83], v4 offset:7424
    s_waitcnt lgkmcnt(7)
    v_mfma_f32_32x32x16_bf16 v[144:159], v[84:87], v[64:67], v[144:159]
    ds_read_b64_tr_b16 v[84:85], v5 offset:7168
    ds_read_b64_tr_b16 v[86:87], v5 offset:7424
    s_waitcnt lgkmcnt(7)
    v_mfma_f32_32x32x16_bf16 v[160:175], v[72:75], v[64:67], v[160:175]
    ds_read_b64_tr_b16 v[72:73], v6 offset:7168
    ds_read_b64_tr_b16 v[74:75], v6 offset:7424
    s_waitcnt lgkmcnt(7)
    v_mfma_f32_32x32x16_bf16 v[176:191], v[76:79], v[64:67], v[176:191]
    ds_read_b64_tr_b16 v[76:77], v7 offset:7168
    ds_read_b64_tr_b16 v[78:79], v7 offset:7424
    s_waitcnt lgkmcnt(6)
    v_mfma_f32_32x32x16_bf16 v[96:111], v[80:83], v[68:71], v[96:111]
    v_dot2_f32_bf16 v88, v68, s54, v88
    v_dot2_f32_bf16 v89, v68, v68, v89
    v_dot2_f32_bf16 v88, v69, s54, v88
    v_dot2_f32_bf16 v89, v69, v69, v89
    v_dot2_f32_bf16 v88, v70, s54, v88
    v_dot2_f32_bf16 v89, v70, v70, v89
    v_dot2_f32_bf16 v88, v71, s54, v88
    v_dot2_f32_bf16 v89, v71, v71, v89
    v_dot2_f32_bf16 v90, v80, s54, v90
    v_dot2_f32_bf16 v90, v81, s54, v90
    v_dot2_f32_bf16 v90, v82, s54, v90
    v_dot2_f32_bf16 v90, v83, s54, v90
    ds_read_b64_tr_b16 v[80:81], v8 offset:7168
    ds_read_b64_tr_b16 v[82:83], v8 offset:7424
    s_waitcnt lgkmcnt(6)
    v_mfma_f32_32x32x16_bf16 v[112:127], v[84:87], v[68:71], v[112:127]
    ds_read_b64_tr_b16 v[84:85], v9 offset:7168
    ds_read_b64_tr_b16 v[86:87], v9 offset:7424
    s_waitcnt lgkmcnt(6)
    v_mfma_f32_32x32x16_bf16 v[128:143], v[72:75], v[68:71], v[128:143]
    s_waitcnt vmcnt(8)
    s_barrier
    ds_read_b128 v[64:67], v2 offset:8192
    ds_read_b64_tr_b16 v[72:73], v4 offset:8192
    ds_read_b64_tr_b16 v[74:75], v4 offset:8448
    s_waitcnt lgkmcnt(7)
    v_mfma_f32_32x32x16_bf16 v[144:159], v[76:79], v[68:71], v[144:159]
    s_add_u32 m0, s33, 4096
    s_nop 0
    buffer_load_dwordx4 v14, s[4:7], s30 offen lds
    ds_read_b64_tr_b16 v[76:77], v5 offset:8192
    ds_read_b64_tr_b16 v[78:79], v5 offset:8448
    s_waitcnt lgkmcnt(7)
    v_mfma_f32_32x32x16_bf16 v[160:175], v[80:83], v[68:71], v[160:175]
    s_add_u32 m0, s33, 5120
    s_nop 0
    buffer_load_dwordx4 v14, s[4:7], s31 offen lds
    ds_read_b64_tr_b16 v[80:81], v6 offset:8192
    ds_read_b64_tr_b16 v[82:83], v6 offset:8448
    s_waitcnt lgkmcnt(7)
    v_mfma_f32_32x32x16_bf16 v[176:191], v[84:87], v[68:71], v[176:191]
    s_add_u32 m0, s62, 4096
    s_nop 0
    buffer_load_dwordx4 v15, s[8:11], s58 offen lds
    ds_read_b64_tr_b16 v[84:85], v7 offset:8192
    ds_read_b64_tr_b16 v[86:87], v7 offset:8448
    s_waitcnt lgkmcnt(6)
    v_mfma_f32_32x32x16_bf16 v[96:111], v[72:75], v[64:67], v[96:111]
    v_dot2_f32_bf16 v88, v64, s54, v88
    v_dot2_f32_bf16 v89, v64, v64, v89
    v_dot2_f32_bf16 v88, v65, s54, v88
    v_dot2_f32_bf16 v89, v65, v65, v89
    v_dot2_f32_bf16 v88, v66, s54, v88
    v_dot2_f32_bf16 v89, v66, v66, v89
    v_dot2_f32_bf16 v88, v67, s54, v88
    v_dot2_f32_bf16 v89, v67, v67, v89
    v_dot2_f32_bf16 v90, v72, s54, v90
    v_dot2_f32_bf16 v90, v73, s54, v90
    v_dot2_f32_bf16 v90, v74, s54, v90
    v_dot2_f32_bf16 v90, v75, s54, v90
    s_add_u32 m0, s63, 4096
    s_nop 0
    buffer_load_dwordx4 v16, s[8:11], s59 offen lds
    ds_read_b64_tr_b16 v[72:73], v8 offset:8192
    ds_read_b64_tr_b16 v[74:75], v8 offset:8448
    s_waitcnt lgkmcnt(6)
    v_mfma_f32_32x32x16_bf16 v[112:127], v[76:79], v[64:67], v[112:127]
    s_add_u32 s30, s30, 64
    s_add_u32 s31, s31, 64
    s_add_u32 s58, s58, 98304
    s_add_u32 s59, s59, 98304
    ds_read_b64_tr_b16 v[76:77], v9 offset:8192
    ds_read_b64_tr_b16 v[78:79], v9 offset:8448
    s_waitcnt lgkmcnt(6)
    v_mfma_f32_32x32x16_bf16 v[128:143], v[80:83], v[64:67], v[128:143]
    ds_read_b128 v[68:71], v3 offset:8192
    ds_read_b64_tr_b16 v[80:81], v4 offset:9216
    ds_read_b64_tr_b16 v[82:83], v4 offset:9472
    s_waitcnt lgkmcnt(7)
    v_mfma_f32_32x32x16_bf16 v[144:159], v[84:87], v[64:67], v[144:159]
    ds_read_b64_tr_b16 v[84:85], v5 offset:9216
    ds_read_b64_tr_b16 v[86:87], v5 offset:9472
    s_waitcnt lgkmcnt(7)
    v_mfma_f32_32x32x16_bf16 v[160:175], v[72:75], v[64:67], v[160:175]
    ds_read_b64_tr_b16 v[72:73], v6 offset:9216
    ds_read_b64_tr_b16 v[74:75], v6 offset:9472
    s_waitcnt lgkmcnt(7)
    v_mfma_f32_32x32x16_bf16 v[176:191], v[76:79], v[64:67], v[176:191]
    ds_read_b64_tr_b16 v[76:77], v7 offset:9216
    ds_read_b64_tr_b16 v[78:79], v7 offset:9472
    s_waitcnt lgkmcnt(6)
    v_mfma_f32_32x32x16_bf16 v[96:111], v[80:83], v[68:71], v[96:111]
    v_dot2_f32_bf16 v88, v68, s54, v88
    v_dot2_f32_bf16 v89, v68, v68, v89
    v_dot2_f32_bf16 v88, v69, s54, v88
    v_dot2_f32_bf16 v89, v69, v69, v89
    v_dot2_f32_bf16 v88, v70, s54, v88
    v_dot2_f32_bf16 v89, v70, v70, v89
    v_dot2_f32_bf16 v88, v71, s54, v88
    v_dot2_f32_bf16 v89, v71, v71, v89
    v_dot2_f32_bf16 v90, v80, s54, v90
    v_dot2_f32_bf16 v90, v81, s54, v90
    v_dot2_f32_bf16 v90, v82, s54, v90
    v_dot2_f32_bf16 v90, v83, s54, v90
    ds_read_b64_tr_b16 v[80:81], v8 offset:9216
    ds_read_b64_tr_b16 v[82:83], v8 offset:9472
    s_waitcnt lgkmcnt(6)
    v_mfma_f32_32x32x16_bf16 v[112:127], v[84:87], v[68:71], v[112:127]
    ds_read_b64_tr_b16 v[84:85], v9 offset:9216
    ds_read_b64_tr_b16 v[86:87], v9 offset:9472
    s_waitcnt lgkmcnt(6)
    v_mfma_f32_32x32x16_bf16 v[128:143], v[72:75], v[68:71], v[128:143]
    s_waitcnt vmcnt(8)
    s_barrier
    ds_read_b128 v[64:67], v2 offset:0
    ds_read_b64_tr_b16 v[72:73], v4 offset:0
    ds_read_b64_tr_b16 v[74:75], v4 offset:256
    s_waitcnt lgkmcnt(7)
    v_mfma_f32_32x32x16_bf16 v[144:159], v[76:79], v[68:71], v[144:159]
    s_add_u32 m0, s33, 6144
    s_nop 0
    buffer_load_dwordx4 v14, s[4:7], s30 offen lds
    ds_read_b64_tr_b16 v[76:77], v5 offset:0
    ds_read_b64_tr_b16 v[78:79], v5 offset:256
    s_waitcnt lgkmcnt(7)
    v_mfma_f32_32x32x16_bf16 v[160:175], v[80:83], v[68:71], v[160:175]
    s_add_u32 m0, s33, 7168
    s_nop 0
    buffer_load_dwordx4 v14, s[4:7], s31 offen lds
    ds_read_b64_tr_b16 v[80:81], v6 offset:0
    ds_read_b64_tr_b16 v[82:83], v6 offset:256
    s_waitcnt lgkmcnt(7)
    v_mfma_f32_32x32x16_bf16 v[176:191], v[84:87], v[68:71], v[176:191]
    s_add_u32 m0, s62, 6144
    s_nop 0
    buffer_load_dwordx4 v15, s[8:11], s58 offen lds
    ds_read_b64_tr_b16 v[84:85], v7 offset:0
    ds_read_b64_tr_b16 v[86:87], v7 offset:256
    s_waitcnt lgkmcnt(6)
    v_mfma_f32_32x32x16_bf16 v[96:111], v[72:75], v[64:67], v[96:111]
    v_dot2_f32_bf16 v88, v64, s54, v88
    v_dot2_f32_bf16 v89, v64, v64, v89
    v_dot2_f32_bf16 v88, v65, s54, v88
    v_dot2_f32_bf16 v89, v65, v65, v89
    v_dot2_f32_bf16 v88, v66, s54, v88
    v_dot2_f32_bf16 v89, v66, v66, v89
    v_dot2_f32_bf16 v88, v67, s54, v88
    v_dot2_f32_bf16 v89, v67, v67, v89
    v_dot2_f32_bf16 v90, v72, s54, v90
    v_dot2_f32_bf16 v90, v73, s54, v90
    v_dot2_f32_bf16 v90, v74, s54, v90
    v_dot2_f32_bf16 v90, v75, s54, v90
    s_add_u32 m0, s63, 6144
    s_nop 0
    buffer_load_dwordx4 v16, s[8:11], s59 offen lds
    ds_read_b64_tr_b16 v[72:73], v8 offset:0
    ds_read_b64_tr_b16 v[74:75], v8 offset:256
    s_waitcnt lgkmcnt(6)
    v_mfma_f32_32x32x16_bf16 v[112:127], v[76:79], v[64:67], v[112:127]
    s_add_u32 s30, s30, 64
    s_add_u32 s31, s31, 64
    s_add_u32 s58, s58, 98304
    s_add_u32 s59, s59, 98304
    ds_read_b64_tr_b16 v[76:77], v9 offset:0
    ds_read_b64_tr_b16 v[78:79], v9 offset:256
    s_waitcnt lgkmcnt(6)
    v_mfma_f32_32x32x16_bf16 v[128:143], v[80:83], v[64:67], v[128:143]
    ds_read_b128 v[68:71], v3 offset:0
    ds_read_b64_tr_b16 v[80:81], v4 offset:1024
    ds_read_b64_tr_b16 v[82:83], v4 offset:1280
    s_waitcnt lgkmcnt(7)
    v_mfma_f32_32x32x16_bf16 v[144:159], v[84:87], v[64:67], v[144:159]
    ds_read_b64_tr_b16 v[84:85], v5 offset:1024
    ds_read_b64_tr_b16 v[86:87], v5 offset:1280
    s_waitcnt lgkmcnt(7)
    v_mfma_f32_32x32x16_bf16 v[160:175], v[72:75], v[64:67], v[160:175]
    ds_read_b64_tr_b16 v[72:73], v6 offset:1024
    ds_read_b64_tr_b16 v[74:75], v6 offset:1280
    s_waitcnt lgkmcnt(7)
    v_mfma_f32_32x32x16_bf16 v[176:191], v[76:79], v[64:67], v[176:191]
    ds_read_b64_tr_b16 v[76:77], v7 offset:1024
    ds_read_b64_tr_b16 v[78:79], v7 offset:1280
    s_waitcnt lgkmcnt(6)
    v_mfma_f32_32x32x16_bf16 v[96:111], v[80:83], v[68:71], v[96:111]
    v_dot2_f32_bf16 v88, v68, s54, v88
    v_dot2_f32_bf16 v89, v68, v68, v89
    v_dot2_f32_bf16 v88, v69, s54, v88
    v_dot2_f32_bf16 v89, v69, v69, v89
    v_dot2_f32_bf16 v88, v70, s54, v88
    v_dot2_f32_bf16 v89, v70, v70, v89
    v_dot2_f32_bf16 v88, v71, s54, v88
    v_dot2_f32_bf16 v89, v71, v71, v89
    v_dot2_f32_bf16 v90, v80, s54, v90
    v_dot2_f32_bf16 v90, v81, s54, v90
    v_dot2_f32_bf16 v90, v82, s54, v90
    v_dot2_f32_bf16 v90, v83, s54, v90
    ds_read_b64_tr_b16 v[80:81], v8 offset:1024
    ds_read_b64_tr_b16 v[82:83], v8 offset:1280
    s_waitcnt lgkmcnt(6)
    v_mfma_f32_32x32x16_bf16 v[112:127], v[84:87], v[68:71], v[112:127]
    ds_read_b64_tr_b16 v[84:85], v9 offset:1024
    ds_read_b64_tr_b16 v[86:87], v9 offset:1280
    s_waitcnt lgkmcnt(6)
    v_mfma_f32_32x32x16_bf16 v[128:143], v[72:75], v[68:71], v[128:143]
    s_waitcnt vmcnt(8)
    s_barrier
    ds_read_b128 v[64:67], v2 offset:2048
    ds_read_b64_tr_b16 v[72:73], v4 offset:2048
    ds_read_b64_tr_b16 v[74:75], v4 offset:2304
    s_waitcnt lgkmcnt(7)
    v_mfma_f32_32x32x16_bf16 v[144:159], v[76:79], v[68:71], v[144:159]
    s_add_u32 m0, s33, 8192
    s_nop 0
    buffer_load_dwordx4 v14, s[4:7], s30 offen lds
    ds_read_b64_tr_b16 v[76:77], v5 offset:2048
    ds_read_b64_tr_b16 v[78:79], v5 offset:2304
    s_waitcnt lgkmcnt(7)
    v_mfma_f32_32x32x16_bf16 v[160:175], v[80:83], v[68:71], v[160:175]
    s_add_u32 m0, s33, 9216
    s_nop 0
    buffer_load_dwordx4 v14, s[4:7], s31 offen lds
    ds_read_b64_tr_b16 v[80:81], v6 offset:2048
    ds_read_b64_tr_b16 v[82:83], v6 offset:2304
    s_waitcnt lgkmcnt(7)
    v_mfma_f32_32x32x16_bf16 v[176:191], v[84:87], v[68:71], v[176:191]
    s_add_u32 m0, s62, 8192
    s_nop 0
    buffer_load_dwordx4 v15, s[8:11], s58 offen lds
    ds_read_b64_tr_b16 v[84:85], v7 offset:2048
    ds_read_b64_tr_b16 v[86:87], v7 offset:2304
    s_waitcnt lgkmcnt(6)
    v_mfma_f32_32x32x16_bf16 v[96:111], v[72:75], v[64:67], v[96:111]
    v_dot2_f32_bf16 v88, v64, s54, v88
    v_dot2_f32_bf16 v89, v64, v64, v89
    v_dot2_f32_bf16 v88, v65, s54, v88
    v_dot2_f32_bf16 v89, v65, v65, v89
    v_dot2_f32_bf16 v88, v66, s54, v88
    v_dot2_f32_bf16 v89, v66, v66, v89
    v_dot2_f32_bf16 v88, v67, s54, v88
    v_dot2_f32_bf16 v89, v67, v67, v89
    v_dot2_f32_bf16 v90, v72, s54, v90
    v_dot2_f32_bf16 v90, v73, s54, v90
    v_dot2_f32_bf16 v90, v74, s54, v90
    v_dot2_f32_bf16 v90, v75, s54, v90
    s_add_u32 m0, s63, 8192
    s_nop 0
    buffer_load_dwordx4 v16, s[8:11], s59 offen lds
    ds_read_b64_tr_b16 v[72:73], v8 offset:2048
    ds_read_b64_tr_b16 v[74:75], v8 offset:2304
    s_waitcnt lgkmcnt(6)
    v_mfma_f32_32x32x16_bf16 v[112:127], v[76:79], v[64:67], v[112:127]
    s_add_u32 s30, s30, 64
    s_add_u32 s31, s31, 64
    s_add_u32 s58, s58, 98304
    s_add_u32 s59, s59, 98304
    ds_read_b64_tr_b16 v[76:77], v9 offset:2048
    ds_read_b64_tr_b16 v[78:79], v9 offset:2304
    s_waitcnt lgkmcnt(6)
    v_mfma_f32_32x32x16_bf16 v[128:143], v[80:83], v[64:67], v[128:143]
    ds_read_b128 v[68:71], v3 offset:2048
    ds_read_b64_tr_b16 v[80:81], v4 offset:3072
    ds_read_b64_tr_b16 v[82:83], v4 offset:3328
    s_waitcnt lgkmcnt(7)
    v_mfma_f32_32x32x16_bf16 v[144:159], v[84:87], v[64:67], v[144:159]
    ds_read_b64_tr_b16 v[84:85], v5 offset:3072
    ds_read_b64_tr_b16 v[86:87], v5 offset:3328
    s_waitcnt lgkmcnt(7)
    v_mfma_f32_32x32x16_bf16 v[160:175], v[72:75], v[64:67], v[160:175]
    ds_read_b64_tr_b16 v[72:73], v6 offset:3072
    ds_read_b64_tr_b16 v[74:75], v6 offset:3328
    s_waitcnt lgkmcnt(7)
    v_mfma_f32_32x32x16_bf16 v[176:191], v[76:79], v[64:67], v[176:191]
    ds_read_b64_tr_b16 v[76:77], v7 offset:3072
    ds_read_b64_tr_b16 v[78:79], v7 offset:3328
    s_waitcnt lgkmcnt(6)
    v_mfma_f32_32x32x16_bf16 v[96:111], v[80:83], v[68:71], v[96:111]
    v_dot2_f32_bf16 v88, v68, s54, v88
    v_dot2_f32_bf16 v89, v68, v68, v89
    v_dot2_f32_bf16 v88, v69, s54, v88
    v_dot2_f32_bf16 v89, v69, v69, v89
    v_dot2_f32_bf16 v88, v70, s54, v88
    v_dot2_f32_bf16 v89, v70, v70, v89
    v_dot2_f32_bf16 v88, v71, s54, v88
    v_dot2_f32_bf16 v89, v71, v71, v89
    v_dot2_f32_bf16 v90, v80, s54, v90
    v_dot2_f32_bf16 v90, v81, s54, v90
    v_dot2_f32_bf16 v90, v82, s54, v90
    v_dot2_f32_bf16 v90, v83, s54, v90
    ds_read_b64_tr_b16 v[80:81], v8 offset:3072
    ds_read_b64_tr_b16 v[82:83], v8 offset:3328
    s_waitcnt lgkmcnt(6)
    v_mfma_f32_32x32x16_bf16 v[112:127], v[84:87], v[68:71], v[112:127]
    ds_read_b64_tr_b16 v[84:85], v9 offset:3072
    ds_read_b64_tr_b16 v[86:87], v9 offset:3328
    s_waitcnt lgkmcnt(6)
    v_mfma_f32_32x32x16_bf16 v[128:143], v[72:75], v[68:71], v[128:143]
    s_waitcnt vmcnt(8)
    s_barrier
    ds_read_b128 v[64:67], v2 offset:4096
    ds_read_b64_tr_b16 v[72:73], v4 offset:4096
    ds_read_b64_tr_b16 v[74:75], v4 offset:4352
    s_waitcnt lgkmcnt(7)
    v_mfma_f32_32x32x16_bf16 v[144:159], v[76:79], v[68:71], v[144:159]
    s_add_u32 m0, s33, 0
    s_nop 0
    buffer_load_dwordx4 v14, s[4:7], s30 offen lds
    ds_read_b64_tr_b16 v[76:77], v5 offset:4096
    ds_read_b64_tr_b16 v[78:79], v5 offset:4352
    s_waitcnt lgkmcnt(7)
    v_mfma_f32_32x32x16_bf16 v[160:175], v[80:83], v[68:71], v[160:175]
    s_add_u32 m0, s33, 1024
    s_nop 0
    buffer_load_dwordx4 v14, s[4:7], s31 offen lds
    ds_read_b64_tr_b16 v[80:81], v6 offset:4096
    ds_read_b64_tr_b16 v[82:83], v6 offset:4352
    s_waitcnt lgkmcnt(7)
    v_mfma_f32_32x32x16_bf16 v[176:191], v[84:87], v[68:71], v[176:191]
    s_add_u32 m0, s62, 0
    s_nop 0
    buffer_load_dwordx4 v15, s[8:11], s58 offen lds
    ds_read_b64_tr_b16 v[84:85], v7 offset:4096
    ds_read_b64_tr_b16 v[86:87], v7 offset:4352
    s_waitcnt lgkmcnt(6)
    v_mfma_f32_32x32x16_bf16 v[96:111], v[72:75], v[64:67], v[96:111]
    v_dot2_f32_bf16 v88, v64, s54, v88
    v_dot2_f32_bf16 v89, v64, v64, v89
    v_dot2_f32_bf16 v88, v65, s54, v88
    v_dot2_f32_bf16 v89, v65, v65, v89
    v_dot2_f32_bf16 v88, v66, s54, v88
    v_dot2_f32_bf16 v89, v66, v66, v89
    v_dot2_f32_bf16 v88, v67, s54, v88
    v_dot2_f32_bf16 v89, v67, v67, v89
    v_dot2_f32_bf16 v90, v72, s54, v90
    v_dot2_f32_bf16 v90, v73, s54, v90
    v_dot2_f32_bf16 v90, v74, s54, v90
    v_dot2_f32_bf16 v90, v75, s54, v90
    s_add_u32 m0, s63, 0
    s_nop 0
    buffer_load_dwordx4 v16, s[8:11], s59 offen lds
    ds_read_b64_tr_b16 v[72:73], v8 offset:4096
    ds_read_b64_tr_b16 v[74:75], v8 offset:4352
    s_waitcnt lgkmcnt(6)
    v_mfma_f32_32x32x16_bf16 v[112:127], v[76:79], v[64:67], v[112:127]
    s_add_u32 s30, s30, 64
    s_add_u32 s31, s31, 64
    s_add_u32 s58, s58, 98304
    s_add_u32 s59, s59, 98304
    ds_read_b64_tr_b16 v[76:77], v9 offset:4096
    ds_read_b64_tr_b16 v[78:79], v9 offset:4352
    s_waitcnt lgkmcnt(6)
    v_mfma_f32_32x32x16_bf16 v[128:143], v[80:83], v[64:67], v[128:143]
    ds_read_b128 v[68:71], v3 offset:4096
    ds_read_b64_tr_b16 v[80:81], v4 offset:5120
    ds_read_b64_tr_b16 v[82:83], v4 offset:5376
    s_waitcnt lgkmcnt(7)
    v_mfma_f32_32x32x16_bf16 v[144:159], v[84:87], v[64:67], v[144:159]
    ds_read_b64_tr_b16 v[84:85], v5 offset:5120
    ds_read_b64_tr_b16 v[86:87], v5 offset:5376
    s_waitcnt lgkmcnt(7)
    v_mfma_f32_32x32x16_bf16 v[160:175], v[72:75], v[64:67], v[160:175]
    ds_read_b64_tr_b16 v[72:73], v6 offset:5120
    ds_read_b64_tr_b16 v[74:75], v6 offset:5376
    s_waitcnt lgkmcnt(7)
    v_mfma_f32_32x32x16_bf16 v[176:191], v[76:79], v[64:67], v[176:191]
    ds_read_b64_tr_b16 v[76:77], v7 offset:5120
    ds_read_b64_tr_b16 v[78:79], v7 offset:5376
    s_waitcnt lgkmcnt(6)
    v_mfma_f32_32x32x16_bf16 v[96:111], v[80:83], v[68:71], v[96:111]
    v_dot2_f32_bf16 v88, v68, s54, v88
    v_dot2_f32_bf16 v89, v68, v68, v89
    v_dot2_f32_bf16 v88, v69, s54, v88
    v_dot2_f32_bf16 v89, v69, v69, v89
    v_dot2_f32_bf16 v88, v70, s54, v88
    v_dot2_f32_bf16 v89, v70, v70, v89
    v_dot2_f32_bf16 v88, v71, s54, v88
    v_dot2_f32_bf16 v89, v71, v71, v89
    v_dot2_f32_bf16 v90, v80, s54, v90
    v_dot2_f32_bf16 v90, v81, s54, v90
    v_dot2_f32_bf16 v90, v82, s54, v90
    v_dot2_f32_bf16 v90, v83, s54, v90
    ds_read_b64_tr_b16 v[80:81], v8 offset:5120
    ds_read_b64_tr_b16 v[82:83], v8 offset:5376
    s_waitcnt lgkmcnt(6)
    v_mfma_f32_32x32x16_bf16 v[112:127], v[84:87], v[68:71], v[112:127]
    ds_read_b64_tr_b16 v[84:85], v9 offset:5120
    ds_read_b64_tr_b16 v[86:87], v9 offset:5376
    s_waitcnt lgkmcnt(6)
    v_mfma_f32_32x32x16_bf16 v[128:143], v[72:75], v[68:71], v[128:143]
    s_waitcnt vmcnt(8)
    s_barrier
    ds_read_b128 v[64:67], v2 offset:6144
    ds_read_b64_tr_b16 v[72:73], v4 offset:6144
    ds_read_b64_tr_b16 v[74:75], v4 offset:6400
    s_waitcnt lgkmcnt(7)
    v_mfma_f32_32x32x16_bf16 v[144:159], v[76:79], v[68:71], v[144:159]
    s_add_u32 m0, s33, 2048
    s_nop 0
    buffer_load_dwordx4 v14, s[4:7], s30 offen lds
    ds_read_b64_tr_b16 v[76:77], v5 offset:6144
    ds_read_b64_tr_b16 v[78:79], v5 offset:6400
    s_waitcnt lgkmcnt(7)
    v_mfma_f32_32x32x16_bf16 v[160:175], v[80:83], v[68:71], v[160:175]
    s_add_u32 m0, s33, 3072
    s_nop 0
    buffer_load_dwordx4 v14, s[4:7], s31 offen lds
    ds_read_b64_tr_b16 v[80:81], v6 offset:6144
    ds_read_b64_tr_b16 v[82:83], v6 offset:6400
    s_waitcnt lgkmcnt(7)
    v_mfma_f32_32x32x16_bf16 v[176:191], v[84:87], v[68:71], v[176:191]
    s_add_u32 m0, s62, 2048
    s_nop 0
    buffer_load_dwordx4 v15, s[8:11], s58 offen lds
    ds_read_b64_tr_b16 v[84:85], v7 offset:6144
    ds_read_b64_tr_b16 v[86:87], v7 offset:6400
    s_waitcnt lgkmcnt(6)
    v_mfma_f32_32x32x16_bf16 v[96:111], v[72:75], v[64:67], v[96:111]
    v_dot2_f32_bf16 v88, v64, s54, v88
    v_dot2_f32_bf16 v89, v64, v64, v89
    v_dot2_f32_bf16 v88, v65, s54, v88
    v_dot2_f32_bf16 v89, v65, v65, v89
    v_dot2_f32_bf16 v88, v66, s54, v88
    v_dot2_f32_bf16 v89, v66, v66, v89
    v_dot2_f32_bf16 v88, v67, s54, v88
    v_dot2_f32_bf16 v89, v67, v67, v89
    v_dot2_f32_bf16 v90, v72, s54, v90
    v_dot2_f32_bf16 v90, v73, s54, v90
    v_dot2_f32_bf16 v90, v74, s54, v90
    v_dot2_f32_bf16 v90, v75, s54, v90
    s_add_u32 m0, s63, 2048
    s_nop 0
    buffer_load_dwordx4 v16, s[8:11], s59 offen lds
    ds_read_b64_tr_b16 v[72:73], v8 offset:6144
    ds_read_b64_tr_b16 v[74:75], v8 offset:6400
    s_waitcnt lgkmcnt(6)
    v_mfma_f32_32x32x16_bf16 v[112:127], v[76:79], v[64:67], v[112:127]
    s_add_u32 s30, s30, 64
    s_add_u32 s31, s31, 64
    s_add_u32 s58, s58, 98304
    s_add_u32 s59, s59, 98304
    ds_read_b64_tr_b16 v[76:77], v9 offset:6144
    ds_read_b64_tr_b16 v[78:79], v9 offset:6400
    s_waitcnt lgkmcnt(6)
    v_mfma_f32_32x32x16_bf16 v[128:143], v[80:83], v[64:67], v[128:143]
    ds_read_b128 v[68:71], v3 offset:6144
    ds_read_b64_tr_b16 v[80:81], v4 offset:7168
    ds_read_b64_tr_b16 v[82:83], v4 offset:7424
    s_waitcnt lgkmcnt(7)
    v_mfma_f32_32x32x16_bf16 v[144:159], v[84:87], v[64:67], v[144:159]
    ds_read_b64_tr_b16 v[84:85], v5 offset:7168
    ds_read_b64_tr_b16 v[86:87], v5 offset:7424
    s_waitcnt lgkmcnt(7)
    v_mfma_f32_32x32x16_bf16 v[160:175], v[72:75], v[64:67], v[160:175]
    ds_read_b64_tr_b16 v[72:73], v6 offset:7168
    ds_read_b64_tr_b16 v[74:75], v6 offset:7424
    s_waitcnt lgkmcnt(7)
    v_mfma_f32_32x32x16_bf16 v[176:191], v[76:79], v[64:67], v[176:191]
    ds_read_b64_tr_b16 v[76:77], v7 offset:7168
    ds_read_b64_tr_b16 v[78:79], v7 offset:7424
    s_waitcnt lgkmcnt(6)
    v_mfma_f32_32x32x16_bf16 v[96:111], v[80:83], v[68:71], v[96:111]
    v_dot2_f32_bf16 v88, v68, s54, v88
    v_dot2_f32_bf16 v89, v68, v68, v89
    v_dot2_f32_bf16 v88, v69, s54, v88
    v_dot2_f32_bf16 v89, v69, v69, v89
    v_dot2_f32_bf16 v88, v70, s54, v88
    v_dot2_f32_bf16 v89, v70, v70, v89
    v_dot2_f32_bf16 v88, v71, s54, v88
    v_dot2_f32_bf16 v89, v71, v71, v89
    v_dot2_f32_bf16 v90, v80, s54, v90
    v_dot2_f32_bf16 v90, v81, s54, v90
    v_dot2_f32_bf16 v90, v82, s54, v90
    v_dot2_f32_bf16 v90, v83, s54, v90
    ds_read_b64_tr_b16 v[80:81], v8 offset:7168
    ds_read_b64_tr_b16 v[82:83], v8 offset:7424
    s_waitcnt lgkmcnt(6)
    v_mfma_f32_32x32x16_bf16 v[112:127], v[84:87], v[68:71], v[112:127]
    ds_read_b64_tr_b16 v[84:85], v9 offset:7168
    ds_read_b64_tr_b16 v[86:87], v9 offset:7424
    s_waitcnt lgkmcnt(6)
    v_mfma_f32_32x32x16_bf16 v[128:143], v[72:75], v[68:71], v[128:143]
    s_waitcnt vmcnt(8)
    s_barrier
    ds_read_b128 v[64:67], v2 offset:8192
    ds_read_b64_tr_b16 v[72:73], v4 offset:8192
    ds_read_b64_tr_b16 v[74:75], v4 offset:8448
    s_waitcnt lgkmcnt(7)
    v_mfma_f32_32x32x16_bf16 v[144:159], v[76:79], v[68:71], v[144:159]
    s_add_u32 m0, s33, 4096
    s_nop 0
    buffer_load_dwordx4 v14, s[4:7], s30 offen lds
    ds_read_b64_tr_b16 v[76:77], v5 offset:8192
    ds_read_b64_tr_b16 v[78:79], v5 offset:8448
    s_waitcnt lgkmcnt(7)
    v_mfma_f32_32x32x16_bf16 v[160:175], v[80:83], v[68:71], v[160:175]
    s_add_u32 m0, s33, 5120
    s_nop 0
    buffer_load_dwordx4 v14, s[4:7], s31 offen lds
    ds_read_b64_tr_b16 v[80:81], v6 offset:8192
    ds_read_b64_tr_b16 v[82:83], v6 offset:8448
    s_waitcnt lgkmcnt(7)
    v_mfma_f32_32x32x16_bf16 v[176:191], v[84:87], v[68:71], v[176:191]
    s_add_u32 m0, s62, 4096
    s_nop 0
    buffer_load_dwordx4 v15, s[8:11], s58 offen lds
    ds_read_b64_tr_b16 v[84:85], v7 offset:8192
    ds_read_b64_tr_b16 v[86:87], v7 offset:8448
    s_waitcnt lgkmcnt(6)
    v_mfma_f32_32x32x16_bf16 v[96:111], v[72:75], v[64:67], v[96:111]
    v_dot2_f32_bf16 v88, v64, s54, v88
    v_dot2_f32_bf16 v89, v64, v64, v89
    v_dot2_f32_bf16 v88, v65, s54, v88
    v_dot2_f32_bf16 v89, v65, v65, v89
    v_dot2_f32_bf16 v88, v66, s54, v88
    v_dot2_f32_bf16 v89, v66, v66, v89
    v_dot2_f32_bf16 v88, v67, s54, v88
    v_dot2_f32_bf16 v89, v67, v67, v89
    v_dot2_f32_bf16 v90, v72, s54, v90
    v_dot2_f32_bf16 v90, v73, s54, v90
    v_dot2_f32_bf16 v90, v74, s54, v90
    v_dot2_f32_bf16 v90, v75, s54, v90
    s_add_u32 m0, s63, 4096
    s_nop 0
    buffer_load_dwordx4 v16, s[8:11], s59 offen lds
    ds_read_b64_tr_b16 v[72:73], v8 offset:8192
    ds_read_b64_tr_b16 v[74:75], v8 offset:8448
    s_waitcnt lgkmcnt(6)
    v_mfma_f32_32x32x16_bf16 v[112:127], v[76:79], v[64:67], v[112:127]
    s_add_u32 s30, s30, 64
    s_add_u32 s31, s31, 64
    s_add_u32 s58, s58, 98304
    s_add_u32 s59, s59, 98304
    ds_read_b64_tr_b16 v[76:77], v9 offset:8192
    ds_read_b64_tr_b16 v[78:79], v9 offset:8448
    s_waitcnt lgkmcnt(6)
    v_mfma_f32_32x32x16_bf16 v[128:143], v[80:83], v[64:67], v[128:143]
    ds_read_b128 v[68:71], v3 offset:8192
    ds_read_b64_tr_b16 v[80:81], v4 offset:9216
    ds_read_b64_tr_b16 v[82:83], v4 offset:9472
    s_waitcnt lgkmcnt(7)
    v_mfma_f32_32x32x16_bf16 v[144:159], v[84:87], v[64:67], v[144:159]
    ds_read_b64_tr_b16 v[84:85], v5 offset:9216
    ds_read_b64_tr_b16 v[86:87], v5 offset:9472
    s_waitcnt lgkmcnt(7)
    v_mfma_f32_32x32x16_bf16 v[160:175], v[72:75], v[64:67], v[160:175]
    ds_read_b64_tr_b16 v[72:73], v6 offset:9216
    ds_read_b64_tr_b16 v[74:75], v6 offset:9472
    s_waitcnt lgkmcnt(7)
    v_mfma_f32_32x32x16_bf16 v[176:191], v[76:79], v[64:67], v[176:191]
    ds_read_b64_tr_b16 v[76:77], v7 offset:9216
    ds_read_b64_tr_b16 v[78:79], v7 offset:9472
    s_waitcnt lgkmcnt(6)
    v_mfma_f32_32x32x16_bf16 v[96:111], v[80:83], v[68:71], v[96:111]
    v_dot2_f32_bf16 v88, v68, s54, v88
    v_dot2_f32_bf16 v89, v68, v68, v89
    v_dot2_f32_bf16 v88, v69, s54, v88
    v_dot2_f32_bf16 v89, v69, v69, v89
    v_dot2_f32_bf16 v88, v70, s54, v88
    v_dot2_f32_bf16 v89, v70, v70, v89
    v_dot2_f32_bf16 v88, v71, s54, v88
    v_dot2_f32_bf16 v89, v71, v71, v89
    v_dot2_f32_bf16 v90, v80, s54, v90
    v_dot2_f32_bf16 v90, v81, s54, v90
    v_dot2_f32_bf16 v90, v82, s54, v90
    v_dot2_f32_bf16 v90, v83, s54, v90
    ds_read_b64_tr_b16 v[80:81], v8 offset:9216
    ds_read_b64_tr_b16 v[82:83], v8 offset:9472
    s_waitcnt lgkmcnt(6)
    v_mfma_f32_32x32x16_bf16 v[112:127], v[84:87], v[68:71], v[112:127]
    ds_read_b64_tr_b16 v[84:85], v9 offset:9216
    ds_read_b64_tr_b16 v[86:87], v9 offset:9472
    s_waitcnt lgkmcnt(6)
    v_mfma_f32_32x32x16_bf16 v[128:143], v[72:75], v[68:71], v[128:143]
    s_waitcnt vmcnt(8)
    s_barrier
    ds_read_b128 v[64:67], v2 offset:0
    ds_read_b64_tr_b16 v[72:73], v4 offset:0
    ds_read_b64_tr_b16 v[74:75], v4 offset:256
    s_waitcnt lgkmcnt(7)
    v_mfma_f32_32x32x16_bf16 v[144:159], v[76:79], v[68:71], v[144:159]
    s_add_u32 m0, s33, 6144
    s_nop 0
    buffer_load_dwordx4 v14, s[4:7], s30 offen lds
    ds_read_b64_tr_b16 v[76:77], v5 offset:0
    ds_read_b64_tr_b16 v[78:79], v5 offset:256
    s_waitcnt lgkmcnt(7)
    v_mfma_f32_32x32x16_bf16 v[160:175], v[80:83], v[68:71], v[160:175]
    s_add_u32 m0, s33, 7168
    s_nop 0
    buffer_load_dwordx4 v14, s[4:7], s31 offen lds
    ds_read_b64_tr_b16 v[80:81], v6 offset:0
    ds_read_b64_tr_b16 v[82:83], v6 offset:256
    s_waitcnt lgkmcnt(7)
    v_mfma_f32_32x32x16_bf16 v[176:191], v[84:87], v[68:71], v[176:191]
    s_add_u32 m0, s62, 6144
    s_nop 0
    buffer_load_dwordx4 v15, s[8:11], s58 offen lds
    ds_read_b64_tr_b16 v[84:85], v7 offset:0
    ds_read_b64_tr_b16 v[86:87], v7 offset:256
    s_waitcnt lgkmcnt(6)
    v_mfma_f32_32x32x16_bf16 v[96:111], v[72:75], v[64:67], v[96:111]
    v_dot2_f32_bf16 v88, v64, s54, v88
    v_dot2_f32_bf16 v89, v64, v64, v89
    v_dot2_f32_bf16 v88, v65, s54, v88
    v_dot2_f32_bf16 v89, v65, v65, v89
    v_dot2_f32_bf16 v88, v66, s54, v88
    v_dot2_f32_bf16 v89, v66, v66, v89
    v_dot2_f32_bf16 v88, v67, s54, v88
    v_dot2_f32_bf16 v89, v67, v67, v89
    v_dot2_f32_bf16 v90, v72, s54, v90
    v_dot2_f32_bf16 v90, v73, s54, v90
    v_dot2_f32_bf16 v90, v74, s54, v90
    v_dot2_f32_bf16 v90, v75, s54, v90
    s_add_u32 m0, s63, 6144
    s_nop 0
    buffer_load_dwordx4 v16, s[8:11], s59 offen lds
    ds_read_b64_tr_b16 v[72:73], v8 offset:0
    ds_read_b64_tr_b16 v[74:75], v8 offset:256
    s_waitcnt lgkmcnt(6)
    v_mfma_f32_32x32x16_bf16 v[112:127], v[76:79], v[64:67], v[112:127]
    s_add_u32 s30, s30, 64
    s_add_u32 s31, s31, 64
    s_add_u32 s58, s58, 98304
    s_add_u32 s59, s59, 98304
    ds_read_b64_tr_b16 v[76:77], v9 offset:0
    ds_read_b64_tr_b16 v[78:79], v9 offset:256
    s_waitcnt lgkmcnt(6)
    v_mfma_f32_32x32x16_bf16 v[128:143], v[80:83], v[64:67], v[128:143]
    ds_read_b128 v[68:71], v3 offset:0
    ds_read_b64_tr_b16 v[80:81], v4 offset:1024
    ds_read_b64_tr_b16 v[82:83], v4 offset:1280
    s_waitcnt lgkmcnt(7)
    v_mfma_f32_32x32x16_bf16 v[144:159], v[84:87], v[64:67], v[144:159]
    ds_read_b64_tr_b16 v[84:85], v5 offset:1024
    ds_read_b64_tr_b16 v[86:87], v5 offset:1280
    s_waitcnt lgkmcnt(7)
    v_mfma_f32_32x32x16_bf16 v[160:175], v[72:75], v[64:67], v[160:175]
    ds_read_b64_tr_b16 v[72:73], v6 offset:1024
    ds_read_b64_tr_b16 v[74:75], v6 offset:1280
    s_waitcnt lgkmcnt(7)
    v_mfma_f32_32x32x16_bf16 v[176:191], v[76:79], v[64:67], v[176:191]
    ds_read_b64_tr_b16 v[76:77], v7 offset:1024
    ds_read_b64_tr_b16 v[78:79], v7 offset:1280
    s_waitcnt lgkmcnt(6)
    v_mfma_f32_32x32x16_bf16 v[96:111], v[80:83], v[68:71], v[96:111]
    v_dot2_f32_bf16 v88, v68, s54, v88
    v_dot2_f32_bf16 v89, v68, v68, v89
    v_dot2_f32_bf16 v88, v69, s54, v88
    v_dot2_f32_bf16 v89, v69, v69, v89
    v_dot2_f32_bf16 v88, v70, s54, v88
    v_dot2_f32_bf16 v89, v70, v70, v89
    v_dot2_f32_bf16 v88, v71, s54, v88
    v_dot2_f32_bf16 v89, v71, v71, v89
    v_dot2_f32_bf16 v90, v80, s54, v90
    v_dot2_f32_bf16 v90, v81, s54, v90
    v_dot2_f32_bf16 v90, v82, s54, v90
    v_dot2_f32_bf16 v90, v83, s54, v90
    ds_read_b64_tr_b16 v[80:81], v8 offset:1024
    ds_read_b64_tr_b16 v[82:83], v8 offset:1280
    s_waitcnt lgkmcnt(6)
    v_mfma_f32_32x32x16_bf16 v[112:127], v[84:87], v[68:71], v[112:127]
    ds_read_b64_tr_b16 v[84:85], v9 offset:1024
    ds_read_b64_tr_b16 v[86:87], v9 offset:1280
    s_waitcnt lgkmcnt(6)
    v_mfma_f32_32x32x16_bf16 v[128:143], v[72:75], v[68:71], v[128:143]
    s_waitcnt vmcnt(8)
    s_barrier
    ds_read_b128 v[64:67], v2 offset:2048
    ds_read_b64_tr_b16 v[72:73], v4 offset:2048
    ds_read_b64_tr_b16 v[74:75], v4 offset:2304
    s_waitcnt lgkmcnt(7)
    v_mfma_f32_32x32x16_bf16 v[144:159], v[76:79], v[68:71], v[144:159]
    s_add_u32 m0, s33, 8192
    s_nop 0
    buffer_load_dwordx4 v14, s[4:7], s30 offen lds
    ds_read_b64_tr_b16 v[76:77], v5 offset:2048
    ds_read_b64_tr_b16 v[78:79], v5 offset:2304
    s_waitcnt lgkmcnt(7)
    v_mfma_f32_32x32x16_bf16 v[160:175], v[80:83], v[68:71], v[160:175]
    s_add_u32 m0, s33, 9216
    s_nop 0
    buffer_load_dwordx4 v14, s[4:7], s31 offen lds
    ds_read_b64_tr_b16 v[80:81], v6 offset:2048
    ds_read_b64_tr_b16 v[82:83], v6 offset:2304
    s_waitcnt lgkmcnt(7)
    v_mfma_f32_32x32x16_bf16 v[176:191], v[84:87], v[68:71], v[176:191]
    s_add_u32 m0, s62, 8192
    s_nop 0
    buffer_load_dwordx4 v15, s[8:11], s58 offen lds
    ds_read_b64_tr_b16 v[84:85], v7 offset:2048
    ds_read_b64_tr_b16 v[86:87], v7 offset:2304
    s_waitcnt lgkmcnt(6)
    v_mfma_f32_32x32x16_bf16 v[96:111], v[72:75], v[64:67], v[96:111]
    v_dot2_f32_bf16 v88, v64, s54, v88
    v_dot2_f32_bf16 v89, v64, v64, v89
    v_dot2_f32_bf16 v88, v65, s54, v88
    v_dot2_f32_bf16 v89, v65, v65, v89
    v_dot2_f32_bf16 v88, v66, s54, v88
    v_dot2_f32_bf16 v89, v66, v66, v89
    v_dot2_f32_bf16 v88, v67, s54, v88
    v_dot2_f32_bf16 v89, v67, v67, v89
    v_dot2_f32_bf16 v90, v72, s54, v90
    v_dot2_f32_bf16 v90, v73, s54, v90
    v_dot2_f32_bf16 v90, v74, s54, v90
    v_dot2_f32_bf16 v90, v75, s54, v90
    s_add_u32 m0, s63, 8192
    s_nop 0
    buffer_load_dwordx4 v16, s[8:11], s59 offen lds
    ds_read_b64_tr_b16 v[72:73], v8 offset:2048
    ds_read_b64_tr_b16 v[74:75], v8 offset:2304
    s_waitcnt lgkmcnt(6)
    v_mfma_f32_32x32x16_bf16 v[112:127], v[76:79], v[64:67], v[112:127]
    s_add_u32 s30, s30, 64
    s_add_u32 s31, s31, 64
    s_add_u32 s58, s58, 98304
    s_add_u32 s59, s59, 98304
    ds_read_b64_tr_b16 v[76:77], v9 offset:2048
    ds_read_b64_tr_b16 v[78:79], v9 offset:2304
    s_waitcnt lgkmcnt(6)
    v_mfma_f32_32x32x16_bf16 v[128:143], v[80:83], v[64:67], v[128:143]
    ds_read_b128 v[68:71], v3 offset:2048
    ds_read_b64_tr_b16 v[80:81], v4 offset:3072
    ds_read_b64_tr_b16 v[82:83], v4 offset:3328
    s_waitcnt lgkmcnt(7)
    v_mfma_f32_32x32x16_bf16 v[144:159], v[84:87], v[64:67], v[144:159]
    ds_read_b64_tr_b16 v[84:85], v5 offset:3072
    ds_read_b64_tr_b16 v[86:87], v5 offset:3328
    s_waitcnt lgkmcnt(7)
    v_mfma_f32_32x32x16_bf16 v[160:175], v[72:75], v[64:67], v[160:175]
    ds_read_b64_tr_b16 v[72:73], v6 offset:3072
    ds_read_b64_tr_b16 v[74:75], v6 offset:3328
    s_waitcnt lgkmcnt(7)
    v_mfma_f32_32x32x16_bf16 v[176:191], v[76:79], v[64:67], v[176:191]
    ds_read_b64_tr_b16 v[76:77], v7 offset:3072
    ds_read_b64_tr_b16 v[78:79], v7 offset:3328
    s_waitcnt lgkmcnt(6)
    v_mfma_f32_32x32x16_bf16 v[96:111], v[80:83], v[68:71], v[96:111]
    v_dot2_f32_bf16 v88, v68, s54, v88
    v_dot2_f32_bf16 v89, v68, v68, v89
    v_dot2_f32_bf16 v88, v69, s54, v88
    v_dot2_f32_bf16 v89, v69, v69, v89
    v_dot2_f32_bf16 v88, v70, s54, v88
    v_dot2_f32_bf16 v89, v70, v70, v89
    v_dot2_f32_bf16 v88, v71, s54, v88
    v_dot2_f32_bf16 v89, v71, v71, v89
    v_dot2_f32_bf16 v90, v80, s54, v90
    v_dot2_f32_bf16 v90, v81, s54, v90
    v_dot2_f32_bf16 v90, v82, s54, v90
    v_dot2_f32_bf16 v90, v83, s54, v90
    ds_read_b64_tr_b16 v[80:81], v8 offset:3072
    ds_read_b64_tr_b16 v[82:83], v8 offset:3328
    s_waitcnt lgkmcnt(6)
    v_mfma_f32_32x32x16_bf16 v[112:127], v[84:87], v[68:71], v[112:127]
    ds_read_b64_tr_b16 v[84:85], v9 offset:3072
    ds_read_b64_tr_b16 v[86:87], v9 offset:3328
    s_waitcnt lgkmcnt(6)
    v_mfma_f32_32x32x16_bf16 v[128:143], v[72:75], v[68:71], v[128:143]
    s_waitcnt vmcnt(8)
    s_barrier
    ds_read_b128 v[64:67], v2 offset:4096
    ds_read_b64_tr_b16 v[72:73], v4 offset:4096
    ds_read_b64_tr_b16 v[74:75], v4 offset:4352
    s_waitcnt lgkmcnt(7)
    v_mfma_f32_32x32x16_bf16 v[144:159], v[76:79], v[68:71], v[144:159]
    s_add_u32 m0, s33, 0
    s_nop 0
    buffer_load_dwordx4 v14, s[4:7], s30 offen lds
    ds_read_b64_tr_b16 v[76:77], v5 offset:4096
    ds_read_b64_tr_b16 v[78:79], v5 offset:4352
    s_waitcnt lgkmcnt(7)
    v_mfma_f32_32x32x16_bf16 v[160:175], v[80:83], v[68:71], v[160:175]
    s_add_u32 m0, s33, 1024
    s_nop 0
    buffer_load_dwordx4 v14, s[4:7], s31 offen lds
    ds_read_b64_tr_b16 v[80:81], v6 offset:4096
    ds_read_b64_tr_b16 v[82:83], v6 offset:4352
    s_waitcnt lgkmcnt(7)
    v_mfma_f32_32x32x16_bf16 v[176:191], v[84:87], v[68:71], v[176:191]
    s_add_u32 m0, s62, 0
    s_nop 0
    buffer_load_dwordx4 v15, s[8:11], s58 offen lds
    ds_read_b64_tr_b16 v[84:85], v7 offset:4096
    ds_read_b64_tr_b16 v[86:87], v7 offset:4352
    s_waitcnt lgkmcnt(6)
    v_mfma_f32_32x32x16_bf16 v[96:111], v[72:75], v[64:67], v[96:111]
    v_dot2_f32_bf16 v88, v64, s54, v88
    v_dot2_f32_bf16 v89, v64, v64, v89
    v_dot2_f32_bf16 v88, v65, s54, v88
    v_dot2_f32_bf16 v89, v65, v65, v89
    v_dot2_f32_bf16 v88, v66, s54, v88
    v_dot2_f32_bf16 v89, v66, v66, v89
    v_dot2_f32_bf16 v88, v67, s54, v88
    v_dot2_f32_bf16 v89, v67, v67, v89
    v_dot2_f32_bf16 v90, v72, s54, v90
    v_dot2_f32_bf16 v90, v73, s54, v90
    v_dot2_f32_bf16 v90, v74, s54, v90
    v_dot2_f32_bf16 v90, v75, s54, v90
    s_add_u32 m0, s63, 0
    s_nop 0
    buffer_load_dwordx4 v16, s[8:11], s59 offen lds
    ds_read_b64_tr_b16 v[72:73], v8 offset:4096
    ds_read_b64_tr_b16 v[74:75], v8 offset:4352
    s_waitcnt lgkmcnt(6)
    v_mfma_f32_32x32x16_bf16 v[112:127], v[76:79], v[64:67], v[112:127]
    s_add_u32 s30, s30, 64
    s_add_u32 s31, s31, 64
    s_add_u32 s58, s58, 98304
    s_add_u32 s59, s59, 98304
    ds_read_b64_tr_b16 v[76:77], v9 offset:4096
    ds_read_b64_tr_b16 v[78:79], v9 offset:4352
    s_waitcnt lgkmcnt(6)
    v_mfma_f32_32x32x16_bf16 v[128:143], v[80:83], v[64:67], v[128:143]
    ds_read_b128 v[68:71], v3 offset:4096
    ds_read_b64_tr_b16 v[80:81], v4 offset:5120
    ds_read_b64_tr_b16 v[82:83], v4 offset:5376
    s_waitcnt lgkmcnt(7)
    v_mfma_f32_32x32x16_bf16 v[144:159], v[84:87], v[64:67], v[144:159]
    ds_read_b64_tr_b16 v[84:85], v5 offset:5120
    ds_read_b64_tr_b16 v[86:87], v5 offset:5376
    s_waitcnt lgkmcnt(7)
    v_mfma_f32_32x32x16_bf16 v[160:175], v[72:75], v[64:67], v[160:175]
    ds_read_b64_tr_b16 v[72:73], v6 offset:5120
    ds_read_b64_tr_b16 v[74:75], v6 offset:5376
    s_waitcnt lgkmcnt(7)
    v_mfma_f32_32x32x16_bf16 v[176:191], v[76:79], v[64:67], v[176:191]
    ds_read_b64_tr_b16 v[76:77], v7 offset:5120
    ds_read_b64_tr_b16 v[78:79], v7 offset:5376
    s_waitcnt lgkmcnt(6)
    v_mfma_f32_32x32x16_bf16 v[96:111], v[80:83], v[68:71], v[96:111]
    v_dot2_f32_bf16 v88, v68, s54, v88
    v_dot2_f32_bf16 v89, v68, v68, v89
    v_dot2_f32_bf16 v88, v69, s54, v88
    v_dot2_f32_bf16 v89, v69, v69, v89
    v_dot2_f32_bf16 v88, v70, s54, v88
    v_dot2_f32_bf16 v89, v70, v70, v89
    v_dot2_f32_bf16 v88, v71, s54, v88
    v_dot2_f32_bf16 v89, v71, v71, v89
    v_dot2_f32_bf16 v90, v80, s54, v90
    v_dot2_f32_bf16 v90, v81, s54, v90
    v_dot2_f32_bf16 v90, v82, s54, v90
    v_dot2_f32_bf16 v90, v83, s54, v90
    ds_read_b64_tr_b16 v[80:81], v8 offset:5120
    ds_read_b64_tr_b16 v[82:83], v8 offset:5376
    s_waitcnt lgkmcnt(6)
    v_mfma_f32_32x32x16_bf16 v[112:127], v[84:87], v[68:71], v[112:127]
    ds_read_b64_tr_b16 v[84:85], v9 offset:5120
    ds_read_b64_tr_b16 v[86:87], v9 offset:5376
    s_waitcnt lgkmcnt(6)
    v_mfma_f32_32x32x16_bf16 v[128:143], v[72:75], v[68:71], v[128:143]
    s_waitcnt vmcnt(8)
    s_barrier
    ds_read_b128 v[64:67], v2 offset:6144
    ds_read_b64_tr_b16 v[72:73], v4 offset:6144
    ds_read_b64_tr_b16 v[74:75], v4 offset:6400
    s_waitcnt lgkmcnt(7)
    v_mfma_f32_32x32x16_bf16 v[144:159], v[76:79], v[68:71], v[144:159]
    ds_read_b64_tr_b16 v[76:77], v5 offset:6144
    ds_read_b64_tr_b16 v[78:79], v5 offset:6400
    s_waitcnt lgkmcnt(7)
    v_mfma_f32_32x32x16_bf16 v[160:175], v[80:83], v[68:71], v[160:175]
    ds_read_b64_tr_b16 v[80:81], v6 offset:6144
    ds_read_b64_tr_b16 v[82:83], v6 offset:6400
    s_waitcnt lgkmcnt(7)
    v_mfma_f32_32x32x16_bf16 v[176:191], v[84:87], v[68:71], v[176:191]
    ds_read_b64_tr_b16 v[84:85], v7 offset:6144
    ds_read_b64_tr_b16 v[86:87], v7 offset:6400
    s_waitcnt lgkmcnt(6)
    v_mfma_f32_32x32x16_bf16 v[96:111], v[72:75], v[64:67], v[96:111]
    v_dot2_f32_bf16 v88, v64, s54, v88
    v_dot2_f32_bf16 v89, v64, v64, v89
    v_dot2_f32_bf16 v88, v65, s54, v88
    v_dot2_f32_bf16 v89, v65, v65, v89
    v_dot2_f32_bf16 v88, v66, s54, v88
    v_dot2_f32_bf16 v89, v66, v66, v89
    v_dot2_f32_bf16 v88, v67, s54, v88
    v_dot2_f32_bf16 v89, v67, v67, v89
    v_dot2_f32_bf16 v90, v72, s54, v90
    v_dot2_f32_bf16 v90, v73, s54, v90
    v_dot2_f32_bf16 v90, v74, s54, v90
    v_dot2_f32_bf16 v90, v75, s54, v90
    ds_read_b64_tr_b16 v[72:73], v8 offset:6144
    ds_read_b64_tr_b16 v[74:75], v8 offset:6400
    s_waitcnt lgkmcnt(6)
    v_mfma_f32_32x32x16_bf16 v[112:127], v[76:79], v[64:67], v[112:127]
    ds_read_b64_tr_b16 v[76:77], v9 offset:6144
    ds_read_b64_tr_b16 v[78:79], v9 offset:6400
    s_waitcnt lgkmcnt(6)
    v_mfma_f32_32x32x16_bf16 v[128:143], v[80:83], v[64:67], v[128:143]
    ds_read_b128 v[68:71], v3 offset:6144
    ds_read_b64_tr_b16 v[80:81], v4 offset:7168
    ds_read_b64_tr_b16 v[82:83], v4 offset:7424
    s_waitcnt lgkmcnt(7)
    v_mfma_f32_32x32x16_bf16 v[144:159], v[84:87], v[64:67], v[144:159]
    ds_read_b64_tr_b16 v[84:85], v5 offset:7168
    ds_read_b64_tr_b16 v[86:87], v5 offset:7424
    s_waitcnt lgkmcnt(7)
    v_mfma_f32_32x32x16_bf16 v[160:175], v[72:75], v[64:67], v[160:175]
    ds_read_b64_tr_b16 v[72:73], v6 offset:7168
    ds_read_b64_tr_b16 v[74:75], v6 offset:7424
    s_waitcnt lgkmcnt(7)
    v_mfma_f32_32x32x16_bf16 v[176:191], v[76:79], v[64:67], v[176:191]
    ds_read_b64_tr_b16 v[76:77], v7 offset:7168
    ds_read_b64_tr_b16 v[78:79], v7 offset:7424
    s_waitcnt lgkmcnt(6)
    v_mfma_f32_32x32x16_bf16 v[96:111], v[80:83], v[68:71], v[96:111]
    v_dot2_f32_bf16 v88, v68, s54, v88
    v_dot2_f32_bf16 v89, v68, v68, v89
    v_dot2_f32_bf16 v88, v69, s54, v88
    v_dot2_f32_bf16 v89, v69, v69, v89
    v_dot2_f32_bf16 v88, v70, s54, v88
    v_dot2_f32_bf16 v89, v70, v70, v89
    v_dot2_f32_bf16 v88, v71, s54, v88
    v_dot2_f32_bf16 v89, v71, v71, v89
    v_dot2_f32_bf16 v90, v80, s54, v90
    v_dot2_f32_bf16 v90, v81, s54, v90
    v_dot2_f32_bf16 v90, v82, s54, v90
    v_dot2_f32_bf16 v90, v83, s54, v90
    ds_read_b64_tr_b16 v[80:81], v8 offset:7168
    ds_read_b64_tr_b16 v[82:83], v8 offset:7424
    s_waitcnt lgkmcnt(6)
    v_mfma_f32_32x32x16_bf16 v[112:127], v[84:87], v[68:71], v[112:127]
    ds_read_b64_tr_b16 v[84:85], v9 offset:7168
    ds_read_b64_tr_b16 v[86:87], v9 offset:7424
    s_waitcnt lgkmcnt(6)
    v_mfma_f32_32x32x16_bf16 v[128:143], v[72:75], v[68:71], v[128:143]
    s_waitcnt vmcnt(4)
    s_barrier
    ds_read_b128 v[64:67], v2 offset:8192
    ds_read_b64_tr_b16 v[72:73], v4 offset:8192
    ds_read_b64_tr_b16 v[74:75], v4 offset:8448
    s_waitcnt lgkmcnt(7)
    v_mfma_f32_32x32x16_bf16 v[144:159], v[76:79], v[68:71], v[144:159]
    ds_read_b64_tr_b16 v[76:77], v5 offset:8192
    ds_read_b64_tr_b16 v[78:79], v5 offset:8448
    s_waitcnt lgkmcnt(7)
    v_mfma_f32_32x32x16_bf16 v[160:175], v[80:83], v[68:71], v[160:175]
    ds_read_b64_tr_b16 v[80:81], v6 offset:8192
    ds_read_b64_tr_b16 v[82:83], v6 offset:8448
    s_waitcnt lgkmcnt(7)
    v_mfma_f32_32x32x16_bf16 v[176:191], v[84:87], v[68:71], v[176:191]
    ds_read_b64_tr_b16 v[84:85], v7 offset:8192
    ds_read_b64_tr_b16 v[86:87], v7 offset:8448
    s_waitcnt lgkmcnt(6)
    v_mfma_f32_32x32x16_bf16 v[96:111], v[72:75], v[64:67], v[96:111]
    v_dot2_f32_bf16 v88, v64, s54, v88
    v_dot2_f32_bf16 v89, v64, v64, v89
    v_dot2_f32_bf16 v88, v65, s54, v88
    v_dot2_f32_bf16 v89, v65, v65, v89
    v_dot2_f32_bf16 v88, v66, s54, v88
    v_dot2_f32_bf16 v89, v66, v66, v89
    v_dot2_f32_bf16 v88, v67, s54, v88
    v_dot2_f32_bf16 v89, v67, v67, v89
    v_dot2_f32_bf16 v90, v72, s54, v90
    v_dot2_f32_bf16 v90, v73, s54, v90
    v_dot2_f32_bf16 v90, v74, s54, v90
    v_dot2_f32_bf16 v90, v75, s54, v90
    ds_read_b64_tr_b16 v[72:73], v8 offset:8192
    ds_read_b64_tr_b16 v[74:75], v8 offset:8448
    s_waitcnt lgkmcnt(6)
    v_mfma_f32_32x32x16_bf16 v[112:127], v[76:79], v[64:67], v[112:127]
    ds_read_b64_tr_b16 v[76:77], v9 offset:8192
    ds_read_b64_tr_b16 v[78:79], v9 offset:8448
    s_waitcnt lgkmcnt(6)
    v_mfma_f32_32x32x16_bf16 v[128:143], v[80:83], v[64:67], v[128:143]
    ds_read_b128 v[68:71], v3 offset:8192
    ds_read_b64_tr_b16 v[80:81], v4 offset:9216
    ds_read_b64_tr_b16 v[82:83], v4 offset:9472
    s_waitcnt lgkmcnt(7)
    v_mfma_f32_32x32x16_bf16 v[144:159], v[84:87], v[64:67], v[144:159]
    ds_read_b64_tr_b16 v[84:85], v5 offset:9216
    ds_read_b64_tr_b16 v[86:87], v5 offset:9472
    s_waitcnt lgkmcnt(7)
    v_mfma_f32_32x32x16_bf16 v[160:175], v[72:75], v[64:67], v[160:175]
    ds_read_b64_tr_b16 v[72:73], v6 offset:9216
    ds_read_b64_tr_b16 v[74:75], v6 offset:9472
    s_waitcnt lgkmcnt(7)
    v_mfma_f32_32x32x16_bf16 v[176:191], v[76:79], v[64:67], v[176:191]
    ds_read_b64_tr_b16 v[76:77], v7 offset:9216
    ds_read_b64_tr_b16 v[78:79], v7 offset:9472
    s_waitcnt lgkmcnt(6)
    v_mfma_f32_32x32x16_bf16 v[96:111], v[80:83], v[68:71], v[96:111]
    v_dot2_f32_bf16 v88, v68, s54, v88
    v_dot2_f32_bf16 v89, v68, v68, v89
    v_dot2_f32_bf16 v88, v69, s54, v88
    v_dot2_f32_bf16 v89, v69, v69, v89
    v_dot2_f32_bf16 v88, v70, s54, v88
    v_dot2_f32_bf16 v89, v70, v70, v89
    v_dot2_f32_bf16 v88, v71, s54, v88
    v_dot2_f32_bf16 v89, v71, v71, v89
    v_dot2_f32_bf16 v90, v80, s54, v90
    v_dot2_f32_bf16 v90, v81, s54, v90
    v_dot2_f32_bf16 v90, v82, s54, v90
    v_dot2_f32_bf16 v90, v83, s54, v90
    ds_read_b64_tr_b16 v[80:81], v8 offset:9216
    ds_read_b64_tr_b16 v[82:83], v8 offset:9472
    s_waitcnt lgkmcnt(6)
    v_mfma_f32_32x32x16_bf16 v[112:127], v[84:87], v[68:71], v[112:127]
    ds_read_b64_tr_b16 v[84:85], v9 offset:9216
    ds_read_b64_tr_b16 v[86:87], v9 offset:9472
    s_waitcnt lgkmcnt(6)
    v_mfma_f32_32x32x16_bf16 v[128:143], v[72:75], v[68:71], v[128:143]
    s_waitcnt vmcnt(0)
    s_barrier
    ds_read_b128 v[64:67], v2 offset:0
    ds_read_b64_tr_b16 v[72:73], v4 offset:0
    ds_read_b64_tr_b16 v[74:75], v4 offset:256
    s_waitcnt lgkmcnt(7)
    v_mfma_f32_32x32x16_bf16 v[144:159], v[76:79], v[68:71], v[144:159]
    ds_read_b64_tr_b16 v[76:77], v5 offset:0
    ds_read_b64_tr_b16 v[78:79], v5 offset:256
    s_waitcnt lgkmcnt(7)
    v_mfma_f32_32x32x16_bf16 v[160:175], v[80:83], v[68:71], v[160:175]
    ds_read_b64_tr_b16 v[80:81], v6 offset:0
    ds_read_b64_tr_b16 v[82:83], v6 offset:256
    s_waitcnt lgkmcnt(7)
    v_mfma_f32_32x32x16_bf16 v[176:191], v[84:87], v[68:71], v[176:191]
    ds_read_b64_tr_b16 v[84:85], v7 offset:0
    ds_read_b64_tr_b16 v[86:87], v7 offset:256
    s_waitcnt lgkmcnt(6)
    v_mfma_f32_32x32x16_bf16 v[96:111], v[72:75], v[64:67], v[96:111]
    v_dot2_f32_bf16 v88, v64, s54, v88
    v_dot2_f32_bf16 v89, v64, v64, v89
    v_dot2_f32_bf16 v88, v65, s54, v88
    v_dot2_f32_bf16 v89, v65, v65, v89
    v_dot2_f32_bf16 v88, v66, s54, v88
    v_dot2_f32_bf16 v89, v66, v66, v89
    v_dot2_f32_bf16 v88, v67, s54, v88
    v_dot2_f32_bf16 v89, v67, v67, v89
    v_dot2_f32_bf16 v90, v72, s54, v90
    v_dot2_f32_bf16 v90, v73, s54, v90
    v_dot2_f32_bf16 v90, v74, s54, v90
    v_dot2_f32_bf16 v90, v75, s54, v90
    ds_read_b64_tr_b16 v[72:73], v8 offset:0
    ds_read_b64_tr_b16 v[74:75], v8 offset:256
    s_waitcnt lgkmcnt(6)
    v_mfma_f32_32x32x16_bf16 v[112:127], v[76:79], v[64:67], v[112:127]
    ds_read_b64_tr_b16 v[76:77], v9 offset:0
    ds_read_b64_tr_b16 v[78:79], v9 offset:256
    s_waitcnt lgkmcnt(6)
    v_mfma_f32_32x32x16_bf16 v[128:143], v[80:83], v[64:67], v[128:143]
    ds_read_b128 v[68:71], v3 offset:0
    ds_read_b64_tr_b16 v[80:81], v4 offset:1024
    ds_read_b64_tr_b16 v[82:83], v4 offset:1280
    s_waitcnt lgkmcnt(7)
    v_mfma_f32_32x32x16_bf16 v[144:159], v[84:87], v[64:67], v[144:159]
    ds_read_b64_tr_b16 v[84:85], v5 offset:1024
    ds_read_b64_tr_b16 v[86:87], v5 offset:1280
    s_waitcnt lgkmcnt(7)
    v_mfma_f32_32x32x16_bf16 v[160:175], v[72:75], v[64:67], v[160:175]
    ds_read_b64_tr_b16 v[72:73], v6 offset:1024
    ds_read_b64_tr_b16 v[74:75], v6 offset:1280
    s_waitcnt lgkmcnt(7)
    v_mfma_f32_32x32x16_bf16 v[176:191], v[76:79], v[64:67], v[176:191]
    ds_read_b64_tr_b16 v[76:77], v7 offset:1024
    ds_read_b64_tr_b16 v[78:79], v7 offset:1280
    s_waitcnt lgkmcnt(6)
    v_mfma_f32_32x32x16_bf16 v[96:111], v[80:83], v[68:71], v[96:111]
    v_dot2_f32_bf16 v88, v68, s54, v88
    v_dot2_f32_bf16 v89, v68, v68, v89
    v_dot2_f32_bf16 v88, v69, s54, v88
    v_dot2_f32_bf16 v89, v69, v69, v89
    v_dot2_f32_bf16 v88, v70, s54, v88
    v_dot2_f32_bf16 v89, v70, v70, v89
    v_dot2_f32_bf16 v88, v71, s54, v88
    v_dot2_f32_bf16 v89, v71, v71, v89
    v_dot2_f32_bf16 v90, v80, s54, v90
    v_dot2_f32_bf16 v90, v81, s54, v90
    v_dot2_f32_bf16 v90, v82, s54, v90
    v_dot2_f32_bf16 v90, v83, s54, v90
    ds_read_b64_tr_b16 v[80:81], v8 offset:1024
    ds_read_b64_tr_b16 v[82:83], v8 offset:1280
    s_waitcnt lgkmcnt(6)
    v_mfma_f32_32x32x16_bf16 v[112:127], v[84:87], v[68:71], v[112:127]
    ds_read_b64_tr_b16 v[84:85], v9 offset:1024
    ds_read_b64_tr_b16 v[86:87], v9 offset:1280
    s_waitcnt lgkmcnt(6)
    v_mfma_f32_32x32x16_bf16 v[128:143], v[72:75], v[68:71], v[128:143]
    s_waitcnt lgkmcnt(4)
    v_mfma_f32_32x32x16_bf16 v[144:159], v[76:79], v[68:71], v[144:159]
    s_waitcnt lgkmcnt(2)
    v_mfma_f32_32x32x16_bf16 v[160:175], v[80:83], v[68:71], v[160:175]
    s_waitcnt lgkmcnt(0)
    v_mfma_f32_32x32x16_bf16 v[176:191], v[84:87], v[68:71], v[176:191]
    v_mov_b32 v21, v88
    v_mov_b32 v22, v88
    s_nop 1
    v_permlane32_swap_b32 v21, v22
    v_add_f32 v88, v21, v22
    v_mov_b32 v21, v89
    v_mov_b32 v22, v89
    s_nop 1
    v_permlane32_swap_b32 v21, v22
    v_add_f32 v89, v21, v22
    v_mov_b32 v21, v90
    v_mov_b32 v22, v90
    s_nop 1
    v_permlane32_swap_b32 v21, v22
    v_add_f32 v90, v21, v22
    v_mul_f32 v23, 0x3b000000, v88
    v_mul_f32 v24, 0x3b000000, v89
    v_fma_f32 v24, -v23, v23, v24
    v_add_f32 v24, 0x3727c5ac, v24
    v_rsq_f32 v25, v24
    s_waitcnt lgkmcnt(0)
    s_barrier
    v_lshlrev_b32 v21, 2, v20
    s_lshl_b32 s48, s36, 7
    v_add_u32 v22, s48, v21
    ds_write_b32 v22, v90
    s_waitcnt lgkmcnt(0)
    s_barrier
    s_lshl_b32 s48, s36, 7
    v_add_u32 v22, s48, v21
    ds_read_b32 v32, v22
    s_lshl_b32 s48, s37, 7
    v_add_u32 v22, s48, v21
    ds_read_b32 v33, v22
    s_lshl_b32 s48, s38, 7
    v_add_u32 v22, s48, v21
    ds_read_b32 v34, v22
    s_lshl_b32 s48, s39, 7
    v_add_u32 v22, s48, v21
    ds_read_b32 v35, v22
    s_lshl_b32 s48, s40, 7
    v_add_u32 v22, s48, v21
    ds_read_b32 v36, v22
    s_lshl_b32 s48, s41, 7
    v_add_u32 v22, s48, v21
    ds_read_b32 v37, v22
    v_mov_b32 v46, 0
    v_mov_b32 v47, 0
    v_mov_b32 v50, 0
    v_mov_b32 v51, 0
    v_sub_f32 v21, 0, v23
    v_cndmask_b32 v21, v21, 0, s[50:51]
    v_cvt_pk_bf16_f32 v44, v21, v21
    v_lshlrev_b32 v22, 16, v44
    v_sub_f32 v22, v21, v22
    v_cvt_pk_bf16_f32 v44, v21, v22
    v_mov_b32 v45, v44
    s_waitcnt lgkmcnt(5)
    v_cndmask_b32 v21, v32, 0, s[50:51]
    v_cvt_pk_bf16_f32 v48, v21, v21
    v_lshlrev_b32 v22, 16, v48
    v_sub_f32 v22, v21, v22
    v_cvt_pk_bf16_f32 v49, v22, v22
    s_nop 1
    v_mfma_f32_32x32x16_bf16 v[96:111], v[48:51], v[44:47], v[96:111]
    s_waitcnt lgkmcnt(4)
    v_cndmask_b32 v21, v33, 0, s[50:51]
    v_cvt_pk_bf16_f32 v48, v21, v21
    v_lshlrev_b32 v22, 16, v48
    v_sub_f32 v22, v21, v22
    v_cvt_pk_bf16_f32 v49, v22, v22
    s_nop 1
    v_mfma_f32_32x32x16_bf16 v[112:127], v[48:51], v[44:47], v[112:127]
    s_waitcnt lgkmcnt(3)
    v_cndmask_b32 v21, v34, 0, s[50:51]
    v_cvt_pk_bf16_f32 v48, v21, v21
    v_lshlrev_b32 v22, 16, v48
    v_sub_f32 v22, v21, v22
    v_cvt_pk_bf16_f32 v49, v22, v22
    s_nop 1
    v_mfma_f32_32x32x16_bf16 v[128:143], v[48:51], v[44:47], v[128:143]
    s_waitcnt lgkmcnt(2)
    v_cndmask_b32 v21, v35, 0, s[50:51]
    v_cvt_pk_bf16_f32 v48, v21, v21
    v_lshlrev_b32 v22, 16, v48
    v_sub_f32 v22, v21, v22
    v_cvt_pk_bf16_f32 v49, v22, v22
    s_nop 1
    v_mfma_f32_32x32x16_bf16 v[144:159], v[48:51], v[44:47], v[144:159]
    s_waitcnt lgkmcnt(1)
    v_cndmask_b32 v21, v36, 0, s[50:51]
    v_cvt_pk_bf16_f32 v48, v21, v21
    v_lshlrev_b32 v22, 16, v48
    v_sub_f32 v22, v21, v22
    v_cvt_pk_bf16_f32 v49, v22, v22
    s_nop 1
    v_mfma_f32_32x32x16_bf16 v[160:175], v[48:51], v[44:47], v[160:175]
    s_waitcnt lgkmcnt(0)
    v_cndmask_b32 v21, v37, 0, s[50:51]
    v_cvt_pk_bf16_f32 v48, v21, v21
    v_lshlrev_b32 v22, 16, v48
    v_sub_f32 v22, v21, v22
    v_cvt_pk_bf16_f32 v49, v22, v22
    s_nop 1
    v_mfma_f32_32x32x16_bf16 v[176:191], v[48:51], v[44:47], v[176:191]
    v_mov_b32 v52, v25
    v_mov_b32 v53, v25
    v_lshlrev_b32 v26, 5, v20
    v_lshrrev_b32 v21, 5, v1
    v_lshl_add_u32 v26, v21, 4, v26
    s_lshl_b32 s48, s16, 10
    v_add_u32 v26, s48, v26
    s_lshl_b32 s46, s17, 13
    v_pk_mul_f32 v[96:97], v[96:97], v[52:53]
    v_pk_mul_f32 v[98:99], v[98:99], v[52:53]
    v_pk_mul_f32 v[100:101], v[100:101], v[52:53]
    v_pk_mul_f32 v[102:103], v[102:103], v[52:53]
    v_pk_mul_f32 v[104:105], v[104:105], v[52:53]
    v_pk_mul_f32 v[106:107], v[106:107], v[52:53]
    v_pk_mul_f32 v[108:109], v[108:109], v[52:53]
    v_pk_mul_f32 v[110:111], v[110:111], v[52:53]
    v_cvt_pk_bf16_f32 v56, v96, v97
    v_cvt_pk_bf16_f32 v57, v98, v99
    v_cvt_pk_bf16_f32 v58, v100, v101
    v_cvt_pk_bf16_f32 v59, v102, v103
    v_cvt_pk_bf16_f32 v60, v104, v105
    v_cvt_pk_bf16_f32 v61, v106, v107
    v_cvt_pk_bf16_f32 v62, v108, v109
    v_cvt_pk_bf16_f32 v63, v110, v111
    s_add_u32 s47, s35, s36
    s_lshl_b32 s48, s47, 17
    s_add_u32 s48, s48, s46
    s_cmp_gt_u32 s47, 31
    s_cselect_b32 s48, 0x6000000, s48
    s_add_u32 s49, s48, 65536
    buffer_store_dwordx4 v[56:59], v26, s[12:15], s48 offen
    buffer_store_dwordx4 v[60:63], v26, s[12:15], s49 offen
    v_pk_mul_f32 v[112:113], v[112:113], v[52:53]
    v_pk_mul_f32 v[114:115], v[114:115], v[52:53]
    v_pk_mul_f32 v[116:117], v[116:117], v[52:53]
    v_pk_mul_f32 v[118:119], v[118:119], v[52:53]
    v_pk_mul_f32 v[120:121], v[120:121], v[52:53]
    v_pk_mul_f32 v[122:123], v[122:123], v[52:53]
    v_pk_mul_f32 v[124:125], v[124:125], v[52:53]
    v_pk_mul_f32 v[126:127], v[126:127], v[52:53]
    v_cvt_pk_bf16_f32 v32, v112, v113
    v_cvt_pk_bf16_f32 v33, v114, v115
    v_cvt_pk_bf16_f32 v34, v116, v117
    v_cvt_pk_bf16_f32 v35, v118, v119
    v_cvt_pk_bf16_f32 v36, v120, v121
    v_cvt_pk_bf16_f32 v37, v122, v123
    v_cvt_pk_bf16_f32 v38, v124, v125
    v_cvt_pk_bf16_f32 v39, v126, v127
    s_add_u32 s47, s35, s37
    s_lshl_b32 s48, s47, 17
    s_add_u32 s48, s48, s46
    s_cmp_gt_u32 s47, 31
    s_cselect_b32 s48, 0x6000000, s48
    s_add_u32 s49, s48, 65536
    buffer_store_dwordx4 v[32:35], v26, s[12:15], s48 offen
    buffer_store_dwordx4 v[36:39], v26, s[12:15], s49 offen
    v_pk_mul_f32 v[128:129], v[128:129], v[52:53]
    v_pk_mul_f32 v[130:131], v[130:131], v[52:53]
    v_pk_mul_f32 v[132:133], v[132:133], v[52:53]
    v_pk_mul_f32 v[134:135], v[134:135], v[52:53]
    v_pk_mul_f32 v[136:137], v[136:137], v[52:53]
    v_pk_mul_f32 v[138:139], v[138:139], v[52:53]
    v_pk_mul_f32 v[140:141], v[140:141], v[52:53]
    v_pk_mul_f32 v[142:143], v[142:143], v[52:53]
    v_cvt_pk_bf16_f32 v56, v128, v129
    v_cvt_pk_bf16_f32 v57, v130, v131
    v_cvt_pk_bf16_f32 v58, v132, v133
    v_cvt_pk_bf16_f32 v59, v134, v135
    v_cvt_pk_bf16_f32 v60, v136, v137
    v_cvt_pk_bf16_f32 v61, v138, v139
    v_cvt_pk_bf16_f32 v62, v140, v141
    v_cvt_pk_bf16_f32 v63, v142, v143
    s_add_u32 s47, s35, s38
    s_lshl_b32 s48, s47, 17
    s_add_u32 s48, s48, s46
    s_cmp_gt_u32 s47, 31
    s_cselect_b32 s48, 0x6000000, s48
    s_add_u32 s49, s48, 65536
    buffer_store_dwordx4 v[56:59], v26, s[12:15], s48 offen
    buffer_store_dwordx4 v[60:63], v26, s[12:15], s49 offen
    v_pk_mul_f32 v[144:145], v[144:145], v[52:53]
    v_pk_mul_f32 v[146:147], v[146:147], v[52:53]
    v_pk_mul_f32 v[148:149], v[148:149], v[52:53]
    v_pk_mul_f32 v[150:151], v[150:151], v[52:53]
    v_pk_mul_f32 v[152:153], v[152:153], v[52:53]
    v_pk_mul_f32 v[154:155], v[154:155], v[52:53]
    v_pk_mul_f32 v[156:157], v[156:157], v[52:53]
    v_pk_mul_f32 v[158:159], v[158:159], v[52:53]
    v_cvt_pk_bf16_f32 v32, v144, v145
    v_cvt_pk_bf16_f32 v33, v146, v147
    v_cvt_pk_bf16_f32 v34, v148, v149
    v_cvt_pk_bf16_f32 v35, v150, v151
    v_cvt_pk_bf16_f32 v36, v152, v153
    v_cvt_pk_bf16_f32 v37, v154, v155
    v_cvt_pk_bf16_f32 v38, v156, v157
    v_cvt_pk_bf16_f32 v39, v158, v159
    s_add_u32 s47, s35, s39
    s_lshl_b32 s48, s47, 17
    s_add_u32 s48, s48, s46
    s_cmp_gt_u32 s47, 31
    s_cselect_b32 s48, 0x6000000, s48
    s_add_u32 s49, s48, 65536
    buffer_store_dwordx4 v[32:35], v26, s[12:15], s48 offen
    buffer_store_dwordx4 v[36:39], v26, s[12:15], s49 offen
    v_pk_mul_f32 v[160:161], v[160:161], v[52:53]
    v_pk_mul_f32 v[162:163], v[162:163], v[52:53]
    v_pk_mul_f32 v[164:165], v[164:165], v[52:53]
    v_pk_mul_f32 v[166:167], v[166:167], v[52:53]
    v_pk_mul_f32 v[168:169], v[168:169], v[52:53]
    v_pk_mul_f32 v[170:171], v[170:171], v[52:53]
    v_pk_mul_f32 v[172:173], v[172:173], v[52:53]
    v_pk_mul_f32 v[174:175], v[174:175], v[52:53]
    v_cvt_pk_bf16_f32 v56, v160, v161
    v_cvt_pk_bf16_f32 v57, v162, v163
    v_cvt_pk_bf16_f32 v58, v164, v165
    v_cvt_pk_bf16_f32 v59, v166, v167
    v_cvt_pk_bf16_f32 v60, v168, v169
    v_cvt_pk_bf16_f32 v61, v170, v171
    v_cvt_pk_bf16_f32 v62, v172, v173
    v_cvt_pk_bf16_f32 v63, v174, v175
    s_add_u32 s47, s35, s40
    s_lshl_b32 s48, s47, 17
    s_add_u32 s48, s48, s46
    s_cmp_gt_u32 s47, 31
    s_cselect_b32 s48, 0x6000000, s48
    s_add_u32 s49, s48, 65536
    buffer_store_dwordx4 v[56:59], v26, s[12:15], s48 offen
    buffer_store_dwordx4 v[60:63], v26, s[12:15], s49 offen
    v_pk_mul_f32 v[176:177], v[176:177], v[52:53]
    v_pk_mul_f32 v[178:179], v[178:179], v[52:53]
    v_pk_mul_f32 v[180:181], v[180:181], v[52:53]
    v_pk_mul_f32 v[182:183], v[182:183], v[52:53]
    v_pk_mul_f32 v[184:185], v[184:185], v[52:53]
    v_pk_mul_f32 v[186:187], v[186:187], v[52:53]
    v_pk_mul_f32 v[188:189], v[188:189], v[52:53]
    v_pk_mul_f32 v[190:191], v[190:191], v[52:53]
    v_cvt_pk_bf16_f32 v32, v176, v177
    v_cvt_pk_bf16_f32 v33, v178, v179
    v_cvt_pk_bf16_f32 v34, v180, v181
    v_cvt_pk_bf16_f32 v35, v182, v183
    v_cvt_pk_bf16_f32 v36, v184, v185
    v_cvt_pk_bf16_f32 v37, v186, v187
    v_cvt_pk_bf16_f32 v38, v188, v189
    v_cvt_pk_bf16_f32 v39, v190, v191
    s_add_u32 s47, s35, s41
    s_lshl_b32 s48, s47, 17
    s_add_u32 s48, s48, s46
    s_cmp_gt_u32 s47, 31
    s_cselect_b32 s48, 0x6000000, s48
    s_add_u32 s49, s48, 65536
    buffer_store_dwordx4 v[32:35], v26, s[12:15], s48 offen
    buffer_store_dwordx4 v[36:39], v26, s[12:15], s49 offen
    s_endpgm
L_k1_v:
    s_lshr_b32 s46, s16, 2
    s_and_b32 s47, s16, 3
    s_mov_b32 s8, s22
    s_mov_b32 s9, s23
    s_mov_b32 s10, 0x180000
    s_mov_b32 s11, 0x00020000
    s_sub_u32 s35, s18, 6
    s_lshl_b32 s35, s35, 2
    s_add_u32 s35, s35, 32
    s_and_b32 s19, s16, 3
    s_add_u32 s52, s35, s47
    s_min_u32 s52, s52, 47
    s_lshl_b32 s52, s52, 6
    s_mul_i32 s62, s47, 10240
    s_lshl_b32 s48, s46, 10
    s_add_u32 s62, s62, s48
    s_add_u32 s62, s62, 81920
    s_mul_i32 s58, s46, 49152
    s_add_u32 s36, s19, 0
    s_cmp_ge_u32 s36, 4
    s_cselect_b32 s48, 4, 0
    s_sub_u32 s36, s36, s48
    s_add_u32 s37, s19, 1
    s_cmp_ge_u32 s37, 4
    s_cselect_b32 s48, 4, 0
    s_sub_u32 s37, s37, s48
    s_add_u32 s38, s19, 2
    s_cmp_ge_u32 s38, 4
    s_cselect_b32 s48, 4, 0
    s_sub_u32 s38, s38, s48
    s_add_u32 s39, s19, 3
    s_cmp_ge_u32 s39, 4
    s_cselect_b32 s48, 4, 0
    s_sub_u32 s39, s39, s48
    s_lshl_b32 s30, s17, 18
    s_add_u32 s31, s30, 16384
    s_mul_i32 s33, s16, 10240
    v_lshrrev_b32 v21, 2, v1
    v_lshlrev_b32 v21, 10, v21
    s_lshl_b32 s48, s16, 15
    v_add_u32 v14, s48, v21
    v_lshrrev_b32 v21, 4, v1
    v_xor_b32 v21, v21, v1
    v_and_b32 v21, 3, v21
    v_lshl_add_u32 v14, v21, 4, v14
    v_lshrrev_b32 v21, 2, v1
    s_movk_i32 s48, 3072
    v_mul_lo_u32 v21, v21, s48
    v_and_b32 v22, 3, v1
    v_lshl_add_u32 v21, v22, 4, v21
    v_add_u32 v15, s52, v21
    v_lshrrev_b32 v21, 5, v1
    v_bfe_u32 v22, v1, 2, 2
    v_lshlrev_b32 v23, 6, v20
    v_add_u32 v23, s33, v23
    v_add_u32 v24, 0, v21
    v_xor_b32 v24, v24, v22
    v_lshl_add_u32 v2, v24, 4, v23
    v_add_u32 v24, 2, v21
    v_xor_b32 v24, v24, v22
    v_lshl_add_u32 v3, v24, 4, v23
    v_lshrrev_b32 v21, 5, v1
    v_bfe_u32 v22, v1, 2, 2
    v_lshl_add_u32 v21, v21, 3, v22
    v_lshlrev_b32 v21, 6, v21
    v_bfe_u32 v22, v1, 4, 1
    v_lshl_add_u32 v21, v22, 5, v21
    v_and_b32 v22, 3, v1
    v_lshl_add_u32 v21, v22, 3, v21
    s_mul_i32 s48, s36, 10240
    s_add_u32 s48, s48, 81920
    v_add_u32 v4, s48, v21
    s_mul_i32 s48, s37, 10240
    s_add_u32 s48, s48, 81920
    v_add_u32 v5, s48, v21
    s_mul_i32 s48, s38, 10240
    s_add_u32 s48, s48, 81920
    v_add_u32 v6, s48, v21
    s_mul_i32 s48, s39, 10240
    s_add_u32 s48, s48, 81920
    v_add_u32 v7, s48, v21
    v_mov_b32 v88, 0
    v_mov_b32 v89, 0
    v_mov_b32 v90, 0
    v_mov_b32 v91, 0
    s_mov_b32 s54, 0x3f803f80
    s_add_u32 m0, s33, 0
    s_nop 0
    buffer_load_dwordx4 v14, s[4:7], s30 offen lds
    s_add_u32 m0, s33, 1024
    s_nop 0
    buffer_load_dwordx4 v14, s[4:7], s31 offen lds
    s_add_u32 m0, s62, 0
    s_nop 0
    buffer_load_dwordx4 v15, s[8:11], s58 offen lds
    s_add_u32 s30, s30, 64
    s_add_u32 s31, s31, 64
    s_add_u32 s58, s58, 98304
    s_add_u32 m0, s33, 2048
    s_nop 0
    buffer_load_dwordx4 v14, s[4:7], s30 offen lds
    s_add_u32 m0, s33, 3072
    s_nop 0
    buffer_load_dwordx4 v14, s[4:7], s31 offen lds
    s_add_u32 m0, s62, 2048
    s_nop 0
    buffer_load_dwordx4 v15, s[8:11], s58 offen lds
    s_add_u32 s30, s30, 64
    s_add_u32 s31, s31, 64
    s_add_u32 s58, s58, 98304
    s_add_u32 m0, s33, 4096
    s_nop 0
    buffer_load_dwordx4 v14, s[4:7], s30 offen lds
    s_add_u32 m0, s33, 5120
    s_nop 0
    buffer_load_dwordx4 v14, s[4:7], s31 offen lds
    s_add_u32 m0, s62, 4096
    s_nop 0
    buffer_load_dwordx4 v15, s[8:11], s58 offen lds
    s_add_u32 s30, s30, 64
    s_add_u32 s31, s31, 64
    s_add_u32 s58, s58, 98304
    s_waitcnt vmcnt(6)
    s_barrier
    ds_read_b128 v[64:67], v2 offset:0
    ds_read_b64_tr_b16 v[72:73], v4 offset:0
    ds_read_b64_tr_b16 v[74:75], v4 offset:256
    ds_read_b64_tr_b16 v[76:77], v5 offset:0
    ds_read_b64_tr_b16 v[78:79], v5 offset:256
    ds_read_b64_tr_b16 v[80:81], v6 offset:0
    ds_read_b64_tr_b16 v[82:83], v6 offset:256
    ds_read_b64_tr_b16 v[84:85], v7 offset:0
    ds_read_b64_tr_b16 v[86:87], v7 offset:256
    s_waitcnt lgkmcnt(6)
    v_mfma_f32_32x32x16_bf16 v[96:111], v[64:67], v[72:75], 0
    v_dot2_f32_bf16 v88, v64, s54, v88
    v_dot2_f32_bf16 v89, v64, v64, v89
    v_dot2_f32_bf16 v88, v65, s54, v88
    v_dot2_f32_bf16 v89, v65, v65, v89
    v_dot2_f32_bf16 v88, v66, s54, v88
    v_dot2_f32_bf16 v89, v66, v66, v89
    v_dot2_f32_bf16 v88, v67, s54, v88
    v_dot2_f32_bf16 v89, v67, v67, v89
    v_dot2_f32_bf16 v90, v72, s54, v90
    v_dot2_f32_bf16 v90, v73, s54, v90
    v_dot2_f32_bf16 v90, v74, s54, v90
    v_dot2_f32_bf16 v90, v75, s54, v90
    s_add_u32 m0, s33, 6144
    s_nop 0
    buffer_load_dwordx4 v14, s[4:7], s30 offen lds
    ds_read_b128 v[68:71], v3 offset:0
    ds_read_b64_tr_b16 v[72:73], v4 offset:1024
    ds_read_b64_tr_b16 v[74:75], v4 offset:1280
    s_waitcnt lgkmcnt(7)
    v_mfma_f32_32x32x16_bf16 v[112:127], v[64:67], v[76:79], 0
    s_add_u32 m0, s33, 7168
    s_nop 0
    buffer_load_dwordx4 v14, s[4:7], s31 offen lds
    ds_read_b64_tr_b16 v[76:77], v5 offset:1024
    ds_read_b64_tr_b16 v[78:79], v5 offset:1280
    s_waitcnt lgkmcnt(7)
    v_mfma_f32_32x32x16_bf16 v[128:143], v[64:67], v[80:83], 0
    s_add_u32 m0, s62, 6144
    s_nop 0
    buffer_load_dwordx4 v15, s[8:11], s58 offen lds
    ds_read_b64_tr_b16 v[80:81], v6 offset:1024
    ds_read_b64_tr_b16 v[82:83], v6 offset:1280
    s_waitcnt lgkmcnt(7)
    v_mfma_f32_32x32x16_bf16 v[144:159], v[64:67], v[84:87], 0
    s_add_u32 s30, s30, 64
    s_add_u32 s31, s31, 64
    s_add_u32 s58, s58, 98304
    ds_read_b64_tr_b16 v[84:85], v7 offset:1024
    ds_read_b64_tr_b16 v[86:87], v7 offset:1280
    s_waitcnt lgkmcnt(6)
    v_mfma_f32_32x32x16_bf16 v[96:111], v[68:71], v[72:75], v[96:111]
    v_dot2_f32_bf16 v88, v68, s54, v88
    v_dot2_f32_bf16 v89, v68, v68, v89
    v_dot2_f32_bf16 v88, v69, s54, v88
    v_dot2_f32_bf16 v89, v69, v69, v89
    v_dot2_f32_bf16 v88, v70, s54, v88
    v_dot2_f32_bf16 v89, v70, v70, v89
    v_dot2_f32_bf16 v88, v71, s54, v88
    v_dot2_f32_bf16 v89, v71, v71, v89
    v_dot2_f32_bf16 v90, v72, s54, v90
    v_dot2_f32_bf16 v90, v73, s54, v90
    v_dot2_f32_bf16 v90, v74, s54, v90
    v_dot2_f32_bf16 v90, v75, s54, v90
    s_waitcnt vmcnt(6)
    s_barrier
    ds_read_b128 v[64:67], v2 offset:2048
    ds_read_b64_tr_b16 v[72:73], v4 offset:2048
    ds_read_b64_tr_b16 v[74:75], v4 offset:2304
    s_waitcnt lgkmcnt(7)
    v_mfma_f32_32x32x16_bf16 v[112:127], v[68:71], v[76:79], v[112:127]
    s_add_u32 m0, s33, 8192
    s_nop 0
    buffer_load_dwordx4 v14, s[4:7], s30 offen lds
    ds_read_b64_tr_b16 v[76:77], v5 offset:2048
    ds_read_b64_tr_b16 v[78:79], v5 offset:2304
    s_waitcnt lgkmcnt(7)
    v_mfma_f32_32x32x16_bf16 v[128:143], v[68:71], v[80:83], v[128:143]
    s_add_u32 m0, s33, 9216
    s_nop 0
    buffer_load_dwordx4 v14, s[4:7], s31 offen lds
    ds_read_b64_tr_b16 v[80:81], v6 offset:2048
    ds_read_b64_tr_b16 v[82:83], v6 offset:2304
    s_waitcnt lgkmcnt(7)
    v_mfma_f32_32x32x16_bf16 v[144:159], v[68:71], v[84:87], v[144:159]
    s_add_u32 m0, s62, 8192
    s_nop 0
    buffer_load_dwordx4 v15, s[8:11], s58 offen lds
    ds_read_b64_tr_b16 v[84:85], v7 offset:2048
    ds_read_b64_tr_b16 v[86:87], v7 offset:2304
    s_waitcnt lgkmcnt(6)
    v_mfma_f32_32x32x16_bf16 v[96:111], v[64:67], v[72:75], v[96:111]
    v_dot2_f32_bf16 v88, v64, s54, v88
    v_dot2_f32_bf16 v89, v64, v64, v89
    v_dot2_f32_bf16 v88, v65, s54, v88
    v_dot2_f32_bf16 v89, v65, v65, v89
    v_dot2_f32_bf16 v88, v66, s54, v88
    v_dot2_f32_bf16 v89, v66, v66, v89
    v_dot2_f32_bf16 v88, v67, s54, v88
    v_dot2_f32_bf16 v89, v67, v67, v89
    v_dot2_f32_bf16 v90, v72, s54, v90
    v_dot2_f32_bf16 v90, v73, s54, v90
    v_dot2_f32_bf16 v90, v74, s54, v90
    v_dot2_f32_bf16 v90, v75, s54, v90
    s_add_u32 s30, s30, 64
    s_add_u32 s31, s31, 64
    s_add_u32 s58, s58, 98304
    ds_read_b128 v[68:71], v3 offset:2048
    ds_read_b64_tr_b16 v[72:73], v4 offset:3072
    ds_read_b64_tr_b16 v[74:75], v4 offset:3328
    s_waitcnt lgkmcnt(7)
    v_mfma_f32_32x32x16_bf16 v[112:127], v[64:67], v[76:79], v[112:127]
    ds_read_b64_tr_b16 v[76:77], v5 offset:3072
    ds_read_b64_tr_b16 v[78:79], v5 offset:3328
    s_waitcnt lgkmcnt(7)
    v_mfma_f32_32x32x16_bf16 v[128:143], v[64:67], v[80:83], v[128:143]
    ds_read_b64_tr_b16 v[80:81], v6 offset:3072
    ds_read_b64_tr_b16 v[82:83], v6 offset:3328
    s_waitcnt lgkmcnt(7)
    v_mfma_f32_32x32x16_bf16 v[144:159], v[64:67], v[84:87], v[144:159]
    ds_read_b64_tr_b16 v[84:85], v7 offset:3072
    ds_read_b64_tr_b16 v[86:87], v7 offset:3328
    s_waitcnt lgkmcnt(6)
    v_mfma_f32_32x32x16_bf16 v[96:111], v[68:71], v[72:75], v[96:111]
    v_dot2_f32_bf16 v88, v68, s54, v88
    v_dot2_f32_bf16 v89, v68, v68, v89
    v_dot2_f32_bf16 v88, v69, s54, v88
    v_dot2_f32_bf16 v89, v69, v69, v89
    v_dot2_f32_bf16 v88, v70, s54, v88
    v_dot2_f32_bf16 v89, v70, v70, v89
    v_dot2_f32_bf16 v88, v71, s54, v88
    v_dot2_f32_bf16 v89, v71, v71, v89
    v_dot2_f32_bf16 v90, v72, s54, v90
    v_dot2_f32_bf16 v90, v73, s54, v90
    v_dot2_f32_bf16 v90, v74, s54, v90
    v_dot2_f32_bf16 v90, v75, s54, v90
    s_waitcnt vmcnt(6)
    s_barrier
    ds_read_b128 v[64:67], v2 offset:4096
    ds_read_b64_tr_b16 v[72:73], v4 offset:4096
    ds_read_b64_tr_b16 v[74:75], v4 offset:4352
    s_waitcnt lgkmcnt(7)
    v_mfma_f32_32x32x16_bf16 v[112:127], v[68:71], v[76:79], v[112:127]
    s_add_u32 m0, s33, 0
    s_nop 0
    buffer_load_dwordx4 v14, s[4:7], s30 offen lds
    ds_read_b64_tr_b16 v[76:77], v5 offset:4096
    ds_read_b64_tr_b16 v[78:79], v5 offset:4352
    s_waitcnt lgkmcnt(7)
    v_mfma_f32_32x32x16_bf16 v[128:143], v[68:71], v[80:83], v[128:143]
    s_add_u32 m0, s33, 1024
    s_nop 0
    buffer_load_dwordx4 v14, s[4:7], s31 offen lds
    ds_read_b64_tr_b16 v[80:81], v6 offset:4096
    ds_read_b64_tr_b16 v[82:83], v6 offset:4352
    s_waitcnt lgkmcnt(7)
    v_mfma_f32_32x32x16_bf16 v[144:159], v[68:71], v[84:87], v[144:159]
    s_add_u32 m0, s62, 0
    s_nop 0
    buffer_load_dwordx4 v15, s[8:11], s58 offen lds
    ds_read_b64_tr_b16 v[84:85], v7 offset:4096
    ds_read_b64_tr_b16 v[86:87], v7 offset:4352
    s_waitcnt lgkmcnt(6)
    v_mfma_f32_32x32x16_bf16 v[96:111], v[64:67], v[72:75], v[96:111]
    v_dot2_f32_bf16 v88, v64, s54, v88
    v_dot2_f32_bf16 v89, v64, v64, v89
    v_dot2_f32_bf16 v88, v65, s54, v88
    v_dot2_f32_bf16 v89, v65, v65, v89
    v_dot2_f32_bf16 v88, v66, s54, v88
    v_dot2_f32_bf16 v89, v66, v66, v89
    v_dot2_f32_bf16 v88, v67, s54, v88
    v_dot2_f32_bf16 v89, v67, v67, v89
    v_dot2_f32_bf16 v90, v72, s54, v90
    v_dot2_f32_bf16 v90, v73, s54, v90
    v_dot2_f32_bf16 v90, v74, s54, v90
    v_dot2_f32_bf16 v90, v75, s54, v90
    s_add_u32 s30, s30, 64
    s_add_u32 s31, s31, 64
    s_add_u32 s58, s58, 98304
    ds_read_b128 v[68:71], v3 offset:4096
    ds_read_b64_tr_b16 v[72:73], v4 offset:5120
    ds_read_b64_tr_b16 v[74:75], v4 offset:5376
    s_waitcnt lgkmcnt(7)
    v_mfma_f32_32x32x16_bf16 v[112:127], v[64:67], v[76:79], v[112:127]
    ds_read_b64_tr_b16 v[76:77], v5 offset:5120
    ds_read_b64_tr_b16 v[78:79], v5 offset:5376
    s_waitcnt lgkmcnt(7)
    v_mfma_f32_32x32x16_bf16 v[128:143], v[64:67], v[80:83], v[128:143]
    ds_read_b64_tr_b16 v[80:81], v6 offset:5120
    ds_read_b64_tr_b16 v[82:83], v6 offset:5376
    s_waitcnt lgkmcnt(7)
    v_mfma_f32_32x32x16_bf16 v[144:159], v[64:67], v[84:87], v[144:159]
    ds_read_b64_tr_b16 v[84:85], v7 offset:5120
    ds_read_b64_tr_b16 v[86:87], v7 offset:5376
    s_waitcnt lgkmcnt(6)
    v_mfma_f32_32x32x16_bf16 v[96:111], v[68:71], v[72:75], v[96:111]
    v_dot2_f32_bf16 v88, v68, s54, v88
    v_dot2_f32_bf16 v89, v68, v68, v89
    v_dot2_f32_bf16 v88, v69, s54, v88
    v_dot2_f32_bf16 v89, v69, v69, v89
    v_dot2_f32_bf16 v88, v70, s54, v88
    v_dot2_f32_bf16 v89, v70, v70, v89
    v_dot2_f32_bf16 v88, v71, s54, v88
    v_dot2_f32_bf16 v89, v71, v71, v89
    v_dot2_f32_bf16 v90, v72, s54, v90
    v_dot2_f32_bf16 v90, v73, s54, v90
    v_dot2_f32_bf16 v90, v74, s54, v90
    v_dot2_f32_bf16 v90, v75, s54, v90
    s_waitcnt vmcnt(6)
    s_barrier
    ds_read_b128 v[64:67], v2 offset:6144
    ds_read_b64_tr_b16 v[72:73], v4 offset:6144
    ds_read_b64_tr_b16 v[74:75], v4 offset:6400
    s_waitcnt lgkmcnt(7)
    v_mfma_f32_32x32x16_bf16 v[112:127], v[68:71], v[76:79], v[112:127]
    s_add_u32 m0, s33, 2048
    s_nop 0
    buffer_load_dwordx4 v14, s[4:7], s30 offen lds
    ds_read_b64_tr_b16 v[76:77], v5 offset:6144
    ds_read_b64_tr_b16 v[78:79], v5 offset:6400
    s_waitcnt lgkmcnt(7)
    v_mfma_f32_32x32x16_bf16 v[128:143], v[68:71], v[80:83], v[128:143]
    s_add_u32 m0, s33, 3072
    s_nop 0
    buffer_load_dwordx4 v14, s[4:7], s31 offen lds
    ds_read_b64_tr_b16 v[80:81], v6 offset:6144
    ds_read_b64_tr_b16 v[82:83], v6 offset:6400
    s_waitcnt lgkmcnt(7)
    v_mfma_f32_32x32x16_bf16 v[144:159], v[68:71], v[84:87], v[144:159]
    s_add_u32 m0, s62, 2048
    s_nop 0
    buffer_load_dwordx4 v15, s[8:11], s58 offen lds
    ds_read_b64_tr_b16 v[84:85], v7 offset:6144
    ds_read_b64_tr_b16 v[86:87], v7 offset:6400
    s_waitcnt lgkmcnt(6)
    v_mfma_f32_32x32x16_bf16 v[96:111], v[64:67], v[72:75], v[96:111]
    v_dot2_f32_bf16 v88, v64, s54, v88
    v_dot2_f32_bf16 v89, v64, v64, v89
    v_dot2_f32_bf16 v88, v65, s54, v88
    v_dot2_f32_bf16 v89, v65, v65, v89
    v_dot2_f32_bf16 v88, v66, s54, v88
    v_dot2_f32_bf16 v89, v66, v66, v89
    v_dot2_f32_bf16 v88, v67, s54, v88
    v_dot2_f32_bf16 v89, v67, v67, v89
    v_dot2_f32_bf16 v90, v72, s54, v90
    v_dot2_f32_bf16 v90, v73, s54, v90
    v_dot2_f32_bf16 v90, v74, s54, v90
    v_dot2_f32_bf16 v90, v75, s54, v90
    s_add_u32 s30, s30, 64
    s_add_u32 s31, s31, 64
    s_add_u32 s58, s58, 98304
    ds_read_b128 v[68:71], v3 offset:6144
    ds_read_b64_tr_b16 v[72:73], v4 offset:7168
    ds_read_b64_tr_b16 v[74:75], v4 offset:7424
    s_waitcnt lgkmcnt(7)
    v_mfma_f32_32x32x16_bf16 v[112:127], v[64:67], v[76:79], v[112:127]
    ds_read_b64_tr_b16 v[76:77], v5 offset:7168
    ds_read_b64_tr_b16 v[78:79], v5 offset:7424
    s_waitcnt lgkmcnt(7)
    v_mfma_f32_32x32x16_bf16 v[128:143], v[64:67], v[80:83], v[128:143]
    ds_read_b64_tr_b16 v[80:81], v6 offset:7168
    ds_read_b64_tr_b16 v[82:83], v6 offset:7424
    s_waitcnt lgkmcnt(7)
    v_mfma_f32_32x32x16_bf16 v[144:159], v[64:67], v[84:87], v[144:159]
    ds_read_b64_tr_b16 v[84:85], v7 offset:7168
    ds_read_b64_tr_b16 v[86:87], v7 offset:7424
    s_waitcnt lgkmcnt(6)
    v_mfma_f32_32x32x16_bf16 v[96:111], v[68:71], v[72:75], v[96:111]
    v_dot2_f32_bf16 v88, v68, s54, v88
    v_dot2_f32_bf16 v89, v68, v68, v89
    v_dot2_f32_bf16 v88, v69, s54, v88
    v_dot2_f32_bf16 v89, v69, v69, v89
    v_dot2_f32_bf16 v88, v70, s54, v88
    v_dot2_f32_bf16 v89, v70, v70, v89
    v_dot2_f32_bf16 v88, v71, s54, v88
    v_dot2_f32_bf16 v89, v71, v71, v89
    v_dot2_f32_bf16 v90, v72, s54, v90
    v_dot2_f32_bf16 v90, v73, s54, v90
    v_dot2_f32_bf16 v90, v74, s54, v90
    v_dot2_f32_bf16 v90, v75, s54, v90
    s_waitcnt vmcnt(6)
    s_barrier
    ds_read_b128 v[64:67], v2 offset:8192
    ds_read_b64_tr_b16 v[72:73], v4 offset:8192
    ds_read_b64_tr_b16 v[74:75], v4 offset:8448
    s_waitcnt lgkmcnt(7)
    v_mfma_f32_32x32x16_bf16 v[112:127], v[68:71], v[76:79], v[112:127]
    s_add_u32 m0, s33, 4096
    s_nop 0
    buffer_load_dwordx4 v14, s[4:7], s30 offen lds
    ds_read_b64_tr_b16 v[76:77], v5 offset:8192
    ds_read_b64_tr_b16 v[78:79], v5 offset:8448
    s_waitcnt lgkmcnt(7)
    v_mfma_f32_32x32x16_bf16 v[128:143], v[68:71], v[80:83], v[128:143]
    s_add_u32 m0, s33, 5120
    s_nop 0
    buffer_load_dwordx4 v14, s[4:7], s31 offen lds
    ds_read_b64_tr_b16 v[80:81], v6 offset:8192
    ds_read_b64_tr_b16 v[82:83], v6 offset:8448
    s_waitcnt lgkmcnt(7)
    v_mfma_f32_32x32x16_bf16 v[144:159], v[68:71], v[84:87], v[144:159]
    s_add_u32 m0, s62, 4096
    s_nop 0
    buffer_load_dwordx4 v15, s[8:11], s58 offen lds
    ds_read_b64_tr_b16 v[84:85], v7 offset:8192
    ds_read_b64_tr_b16 v[86:87], v7 offset:8448
    s_waitcnt lgkmcnt(6)
    v_mfma_f32_32x32x16_bf16 v[96:111], v[64:67], v[72:75], v[96:111]
    v_dot2_f32_bf16 v88, v64, s54, v88
    v_dot2_f32_bf16 v89, v64, v64, v89
    v_dot2_f32_bf16 v88, v65, s54, v88
    v_dot2_f32_bf16 v89, v65, v65, v89
    v_dot2_f32_bf16 v88, v66, s54, v88
    v_dot2_f32_bf16 v89, v66, v66, v89
    v_dot2_f32_bf16 v88, v67, s54, v88
    v_dot2_f32_bf16 v89, v67, v67, v89
    v_dot2_f32_bf16 v90, v72, s54, v90
    v_dot2_f32_bf16 v90, v73, s54, v90
    v_dot2_f32_bf16 v90, v74, s54, v90
    v_dot2_f32_bf16 v90, v75, s54, v90
    s_add_u32 s30, s30, 64
    s_add_u32 s31, s31, 64
    s_add_u32 s58, s58, 98304
    ds_read_b128 v[68:71], v3 offset:8192
    ds_read_b64_tr_b16 v[72:73], v4 offset:9216
    ds_read_b64_tr_b16 v[74:75], v4 offset:9472
    s_waitcnt lgkmcnt(7)
    v_mfma_f32_32x32x16_bf16 v[112:127], v[64:67], v[76:79], v[112:127]
    ds_read_b64_tr_b16 v[76:77], v5 offset:9216
    ds_read_b64_tr_b16 v[78:79], v5 offset:9472
    s_waitcnt lgkmcnt(7)
    v_mfma_f32_32x32x16_bf16 v[128:143], v[64:67], v[80:83], v[128:143]
    ds_read_b64_tr_b16 v[80:81], v6 offset:9216
    ds_read_b64_tr_b16 v[82:83], v6 offset:9472
    s_waitcnt lgkmcnt(7)
    v_mfma_f32_32x32x16_bf16 v[144:159], v[64:67], v[84:87], v[144:159]
    ds_read_b64_tr_b16 v[84:85], v7 offset:9216
    ds_read_b64_tr_b16 v[86:87], v7 offset:9472
    s_waitcnt lgkmcnt(6)
    v_mfma_f32_32x32x16_bf16 v[96:111], v[68:71], v[72:75], v[96:111]
    v_dot2_f32_bf16 v88, v68, s54, v88
    v_dot2_f32_bf16 v89, v68, v68, v89
    v_dot2_f32_bf16 v88, v69, s54, v88
    v_dot2_f32_bf16 v89, v69, v69, v89
    v_dot2_f32_bf16 v88, v70, s54, v88
    v_dot2_f32_bf16 v89, v70, v70, v89
    v_dot2_f32_bf16 v88, v71, s54, v88
    v_dot2_f32_bf16 v89, v71, v71, v89
    v_dot2_f32_bf16 v90, v72, s54, v90
    v_dot2_f32_bf16 v90, v73, s54, v90
    v_dot2_f32_bf16 v90, v74, s54, v90
    v_dot2_f32_bf16 v90, v75, s54, v90
    s_waitcnt vmcnt(6)
    s_barrier
    ds_read_b128 v[64:67], v2 offset:0
    ds_read_b64_tr_b16 v[72:73], v4 offset:0
    ds_read_b64_tr_b16 v[74:75], v4 offset:256
    s_waitcnt lgkmcnt(7)
    v_mfma_f32_32x32x16_bf16 v[112:127], v[68:71], v[76:79], v[112:127]
    s_add_u32 m0, s33, 6144
    s_nop 0
    buffer_load_dwordx4 v14, s[4:7], s30 offen lds
    ds_read_b64_tr_b16 v[76:77], v5 offset:0
    ds_read_b64_tr_b16 v[78:79], v5 offset:256
    s_waitcnt lgkmcnt(7)
    v_mfma_f32_32x32x16_bf16 v[128:143], v[68:71], v[80:83], v[128:143]
    s_add_u32 m0, s33, 7168
    s_nop 0
    buffer_load_dwordx4 v14, s[4:7], s31 offen lds
    ds_read_b64_tr_b16 v[80:81], v6 offset:0
    ds_read_b64_tr_b16 v[82:83], v6 offset:256
    s_waitcnt lgkmcnt(7)
    v_mfma_f32_32x32x16_bf16 v[144:159], v[68:71], v[84:87], v[144:159]
    s_add_u32 m0, s62, 6144
    s_nop 0
    buffer_load_dwordx4 v15, s[8:11], s58 offen lds
    ds_read_b64_tr_b16 v[84:85], v7 offset:0
    ds_read_b64_tr_b16 v[86:87], v7 offset:256
    s_waitcnt lgkmcnt(6)
    v_mfma_f32_32x32x16_bf16 v[96:111], v[64:67], v[72:75], v[96:111]
    v_dot2_f32_bf16 v88, v64, s54, v88
    v_dot2_f32_bf16 v89, v64, v64, v89
    v_dot2_f32_bf16 v88, v65, s54, v88
    v_dot2_f32_bf16 v89, v65, v65, v89
    v_dot2_f32_bf16 v88, v66, s54, v88
    v_dot2_f32_bf16 v89, v66, v66, v89
    v_dot2_f32_bf16 v88, v67, s54, v88
    v_dot2_f32_bf16 v89, v67, v67, v89
    v_dot2_f32_bf16 v90, v72, s54, v90
    v_dot2_f32_bf16 v90, v73, s54, v90
    v_dot2_f32_bf16 v90, v74, s54, v90
    v_dot2_f32_bf16 v90, v75, s54, v90
    s_add_u32 s30, s30, 64
    s_add_u32 s31, s31, 64
    s_add_u32 s58, s58, 98304
    ds_read_b128 v[68:71], v3 offset:0
    ds_read_b64_tr_b16 v[72:73], v4 offset:1024
    ds_read_b64_tr_b16 v[74:75], v4 offset:1280
    s_waitcnt lgkmcnt(7)
    v_mfma_f32_32x32x16_bf16 v[112:127], v[64:67], v[76:79], v[112:127]
    ds_read_b64_tr_b16 v[76:77], v5 offset:1024
    ds_read_b64_tr_b16 v[78:79], v5 offset:1280
    s_waitcnt lgkmcnt(7)
    v_mfma_f32_32x32x16_bf16 v[128:143], v[64:67], v[80:83], v[128:143]
    ds_read_b64_tr_b16 v[80:81], v6 offset:1024
    ds_read_b64_tr_b16 v[82:83], v6 offset:1280
    s_waitcnt lgkmcnt(7)
    v_mfma_f32_32x32x16_bf16 v[144:159], v[64:67], v[84:87], v[144:159]
    ds_read_b64_tr_b16 v[84:85], v7 offset:1024
    ds_read_b64_tr_b16 v[86:87], v7 offset:1280
    s_waitcnt lgkmcnt(6)
    v_mfma_f32_32x32x16_bf16 v[96:111], v[68:71], v[72:75], v[96:111]
    v_dot2_f32_bf16 v88, v68, s54, v88
    v_dot2_f32_bf16 v89, v68, v68, v89
    v_dot2_f32_bf16 v88, v69, s54, v88
    v_dot2_f32_bf16 v89, v69, v69, v89
    v_dot2_f32_bf16 v88, v70, s54, v88
    v_dot2_f32_bf16 v89, v70, v70, v89
    v_dot2_f32_bf16 v88, v71, s54, v88
    v_dot2_f32_bf16 v89, v71, v71, v89
    v_dot2_f32_bf16 v90, v72, s54, v90
    v_dot2_f32_bf16 v90, v73, s54, v90
    v_dot2_f32_bf16 v90, v74, s54, v90
    v_dot2_f32_bf16 v90, v75, s54, v90
    s_waitcnt vmcnt(6)
    s_barrier
    ds_read_b128 v[64:67], v2 offset:2048
    ds_read_b64_tr_b16 v[72:73], v4 offset:2048
    ds_read_b64_tr_b16 v[74:75], v4 offset:2304
    s_waitcnt lgkmcnt(7)
    v_mfma_f32_32x32x16_bf16 v[112:127], v[68:71], v[76:79], v[112:127]
    s_add_u32 m0, s33, 8192
    s_nop 0
    buffer_load_dwordx4 v14, s[4:7], s30 offen lds
    ds_read_b64_tr_b16 v[76:77], v5 offset:2048
    ds_read_b64_tr_b16 v[78:79], v5 offset:2304
    s_waitcnt lgkmcnt(7)
    v_mfma_f32_32x32x16_bf16 v[128:143], v[68:71], v[80:83], v[128:143]
    s_add_u32 m0, s33, 9216
    s_nop 0
    buffer_load_dwordx4 v14, s[4:7], s31 offen lds
    ds_read_b64_tr_b16 v[80:81], v6 offset:2048
    ds_read_b64_tr_b16 v[82:83], v6 offset:2304
    s_waitcnt lgkmcnt(7)
    v_mfma_f32_32x32x16_bf16 v[144:159], v[68:71], v[84:87], v[144:159]
    s_add_u32 m0, s62, 8192
    s_nop 0
    buffer_load_dwordx4 v15, s[8:11], s58 offen lds
    ds_read_b64_tr_b16 v[84:85], v7 offset:2048
    ds_read_b64_tr_b16 v[86:87], v7 offset:2304
    s_waitcnt lgkmcnt(6)
    v_mfma_f32_32x32x16_bf16 v[96:111], v[64:67], v[72:75], v[96:111]
    v_dot2_f32_bf16 v88, v64, s54, v88
    v_dot2_f32_bf16 v89, v64, v64, v89
    v_dot2_f32_bf16 v88, v65, s54, v88
    v_dot2_f32_bf16 v89, v65, v65, v89
    v_dot2_f32_bf16 v88, v66, s54, v88
    v_dot2_f32_bf16 v89, v66, v66, v89
    v_dot2_f32_bf16 v88, v67, s54, v88
    v_dot2_f32_bf16 v89, v67, v67, v89
    v_dot2_f32_bf16 v90, v72, s54, v90
    v_dot2_f32_bf16 v90, v73, s54, v90
    v_dot2_f32_bf16 v90, v74, s54, v90
    v_dot2_f32_bf16 v90, v75, s54, v90
    s_add_u32 s30, s30, 64
    s_add_u32 s31, s31, 64
    s_add_u32 s58, s58, 98304
    ds_read_b128 v[68:71], v3 offset:2048
    ds_read_b64_tr_b16 v[72:73], v4 offset:3072
    ds_read_b64_tr_b16 v[74:75], v4 offset:3328
    s_waitcnt lgkmcnt(7)
    v_mfma_f32_32x32x16_bf16 v[112:127], v[64:67], v[76:79], v[112:127]
    ds_read_b64_tr_b16 v[76:77], v5 offset:3072
    ds_read_b64_tr_b16 v[78:79], v5 offset:3328
    s_waitcnt lgkmcnt(7)
    v_mfma_f32_32x32x16_bf16 v[128:143], v[64:67], v[80:83], v[128:143]
    ds_read_b64_tr_b16 v[80:81], v6 offset:3072
    ds_read_b64_tr_b16 v[82:83], v6 offset:3328
    s_waitcnt lgkmcnt(7)
    v_mfma_f32_32x32x16_bf16 v[144:159], v[64:67], v[84:87], v[144:159]
    ds_read_b64_tr_b16 v[84:85], v7 offset:3072
    ds_read_b64_tr_b16 v[86:87], v7 offset:3328
    s_waitcnt lgkmcnt(6)
    v_mfma_f32_32x32x16_bf16 v[96:111], v[68:71], v[72:75], v[96:111]
    v_dot2_f32_bf16 v88, v68, s54, v88
    v_dot2_f32_bf16 v89, v68, v68, v89
    v_dot2_f32_bf16 v88, v69, s54, v88
    v_dot2_f32_bf16 v89, v69, v69, v89
    v_dot2_f32_bf16 v88, v70, s54, v88
    v_dot2_f32_bf16 v89, v70, v70, v89
    v_dot2_f32_bf16 v88, v71, s54, v88
    v_dot2_f32_bf16 v89, v71, v71, v89
    v_dot2_f32_bf16 v90, v72, s54, v90
    v_dot2_f32_bf16 v90, v73, s54, v90
    v_dot2_f32_bf16 v90, v74, s54, v90
    v_dot2_f32_bf16 v90, v75, s54, v90
    s_waitcnt vmcnt(6)
    s_barrier
    ds_read_b128 v[64:67], v2 offset:4096
    ds_read_b64_tr_b16 v[72:73], v4 offset:4096
    ds_read_b64_tr_b16 v[74:75], v4 offset:4352
    s_waitcnt lgkmcnt(7)
    v_mfma_f32_32x32x16_bf16 v[112:127], v[68:71], v[76:79], v[112:127]
    s_add_u32 m0, s33, 0
    s_nop 0
    buffer_load_dwordx4 v14, s[4:7], s30 offen lds
    ds_read_b64_tr_b16 v[76:77], v5 offset:4096
    ds_read_b64_tr_b16 v[78:79], v5 offset:4352
    s_waitcnt lgkmcnt(7)
    v_mfma_f32_32x32x16_bf16 v[128:143], v[68:71], v[80:83], v[128:143]
    s_add_u32 m0, s33, 1024
    s_nop 0
    buffer_load_dwordx4 v14, s[4:7], s31 offen lds
    ds_read_b64_tr_b16 v[80:81], v6 offset:4096
    ds_read_b64_tr_b16 v[82:83], v6 offset:4352
    s_waitcnt lgkmcnt(7)
    v_mfma_f32_32x32x16_bf16 v[144:159], v[68:71], v[84:87], v[144:159]
    s_add_u32 m0, s62, 0
    s_nop 0
    buffer_load_dwordx4 v15, s[8:11], s58 offen lds
    ds_read_b64_tr_b16 v[84:85], v7 offset:4096
    ds_read_b64_tr_b16 v[86:87], v7 offset:4352
    s_waitcnt lgkmcnt(6)
    v_mfma_f32_32x32x16_bf16 v[96:111], v[64:67], v[72:75], v[96:111]
    v_dot2_f32_bf16 v88, v64, s54, v88
    v_dot2_f32_bf16 v89, v64, v64, v89
    v_dot2_f32_bf16 v88, v65, s54, v88
    v_dot2_f32_bf16 v89, v65, v65, v89
    v_dot2_f32_bf16 v88, v66, s54, v88
    v_dot2_f32_bf16 v89, v66, v66, v89
    v_dot2_f32_bf16 v88, v67, s54, v88
    v_dot2_f32_bf16 v89, v67, v67, v89
    v_dot2_f32_bf16 v90, v72, s54, v90
    v_dot2_f32_bf16 v90, v73, s54, v90
    v_dot2_f32_bf16 v90, v74, s54, v90
    v_dot2_f32_bf16 v90, v75, s54, v90
    s_add_u32 s30, s30, 64
    s_add_u32 s31, s31, 64
    s_add_u32 s58, s58, 98304
    ds_read_b128 v[68:71], v3 offset:4096
    ds_read_b64_tr_b16 v[72:73], v4 offset:5120
    ds_read_b64_tr_b16 v[74:75], v4 offset:5376
    s_waitcnt lgkmcnt(7)
    v_mfma_f32_32x32x16_bf16 v[112:127], v[64:67], v[76:79], v[112:127]
    ds_read_b64_tr_b16 v[76:77], v5 offset:5120
    ds_read_b64_tr_b16 v[78:79], v5 offset:5376
    s_waitcnt lgkmcnt(7)
    v_mfma_f32_32x32x16_bf16 v[128:143], v[64:67], v[80:83], v[128:143]
    ds_read_b64_tr_b16 v[80:81], v6 offset:5120
    ds_read_b64_tr_b16 v[82:83], v6 offset:5376
    s_waitcnt lgkmcnt(7)
    v_mfma_f32_32x32x16_bf16 v[144:159], v[64:67], v[84:87], v[144:159]
    ds_read_b64_tr_b16 v[84:85], v7 offset:5120
    ds_read_b64_tr_b16 v[86:87], v7 offset:5376
    s_waitcnt lgkmcnt(6)
    v_mfma_f32_32x32x16_bf16 v[96:111], v[68:71], v[72:75], v[96:111]
    v_dot2_f32_bf16 v88, v68, s54, v88
    v_dot2_f32_bf16 v89, v68, v68, v89
    v_dot2_f32_bf16 v88, v69, s54, v88
    v_dot2_f32_bf16 v89, v69, v69, v89
    v_dot2_f32_bf16 v88, v70, s54, v88
    v_dot2_f32_bf16 v89, v70, v70, v89
    v_dot2_f32_bf16 v88, v71, s54, v88
    v_dot2_f32_bf16 v89, v71, v71, v89
    v_dot2_f32_bf16 v90, v72, s54, v90
    v_dot2_f32_bf16 v90, v73, s54, v90
    v_dot2_f32_bf16 v90, v74, s54, v90
    v_dot2_f32_bf16 v90, v75, s54, v90
    s_waitcnt vmcnt(6)
    s_barrier
    ds_read_b128 v[64:67], v2 offset:6144
    ds_read_b64_tr_b16 v[72:73], v4 offset:6144
    ds_read_b64_tr_b16 v[74:75], v4 offset:6400
    s_waitcnt lgkmcnt(7)
    v_mfma_f32_32x32x16_bf16 v[112:127], v[68:71], v[76:79], v[112:127]
    s_add_u32 m0, s33, 2048
    s_nop 0
    buffer_load_dwordx4 v14, s[4:7], s30 offen lds
    ds_read_b64_tr_b16 v[76:77], v5 offset:6144
    ds_read_b64_tr_b16 v[78:79], v5 offset:6400
    s_waitcnt lgkmcnt(7)
    v_mfma_f32_32x32x16_bf16 v[128:143], v[68:71], v[80:83], v[128:143]
    s_add_u32 m0, s33, 3072
    s_nop 0
    buffer_load_dwordx4 v14, s[4:7], s31 offen lds
    ds_read_b64_tr_b16 v[80:81], v6 offset:6144
    ds_read_b64_tr_b16 v[82:83], v6 offset:6400
    s_waitcnt lgkmcnt(7)
    v_mfma_f32_32x32x16_bf16 v[144:159], v[68:71], v[84:87], v[144:159]
    s_add_u32 m0, s62, 2048
    s_nop 0
    buffer_load_dwordx4 v15, s[8:11], s58 offen lds
    ds_read_b64_tr_b16 v[84:85], v7 offset:6144
    ds_read_b64_tr_b16 v[86:87], v7 offset:6400
    s_waitcnt lgkmcnt(6)
    v_mfma_f32_32x32x16_bf16 v[96:111], v[64:67], v[72:75], v[96:111]
    v_dot2_f32_bf16 v88, v64, s54, v88
    v_dot2_f32_bf16 v89, v64, v64, v89
    v_dot2_f32_bf16 v88, v65, s54, v88
    v_dot2_f32_bf16 v89, v65, v65, v89
    v_dot2_f32_bf16 v88, v66, s54, v88
    v_dot2_f32_bf16 v89, v66, v66, v89
    v_dot2_f32_bf16 v88, v67, s54, v88
    v_dot2_f32_bf16 v89, v67, v67, v89
    v_dot2_f32_bf16 v90, v72, s54, v90
    v_dot2_f32_bf16 v90, v73, s54, v90
    v_dot2_f32_bf16 v90, v74, s54, v90
    v_dot2_f32_bf16 v90, v75, s54, v90
    s_add_u32 s30, s30, 64
    s_add_u32 s31, s31, 64
    s_add_u32 s58, s58, 98304
    ds_read_b128 v[68:71], v3 offset:6144
    ds_read_b64_tr_b16 v[72:73], v4 offset:7168
    ds_read_b64_tr_b16 v[74:75], v4 offset:7424
    s_waitcnt lgkmcnt(7)
    v_mfma_f32_32x32x16_bf16 v[112:127], v[64:67], v[76:79], v[112:127]
    ds_read_b64_tr_b16 v[76:77], v5 offset:7168
    ds_read_b64_tr_b16 v[78:79], v5 offset:7424
    s_waitcnt lgkmcnt(7)
    v_mfma_f32_32x32x16_bf16 v[128:143], v[64:67], v[80:83], v[128:143]
    ds_read_b64_tr_b16 v[80:81], v6 offset:7168
    ds_read_b64_tr_b16 v[82:83], v6 offset:7424
    s_waitcnt lgkmcnt(7)
    v_mfma_f32_32x32x16_bf16 v[144:159], v[64:67], v[84:87], v[144:159]
    ds_read_b64_tr_b16 v[84:85], v7 offset:7168
    ds_read_b64_tr_b16 v[86:87], v7 offset:7424
    s_waitcnt lgkmcnt(6)
    v_mfma_f32_32x32x16_bf16 v[96:111], v[68:71], v[72:75], v[96:111]
    v_dot2_f32_bf16 v88, v68, s54, v88
    v_dot2_f32_bf16 v89, v68, v68, v89
    v_dot2_f32_bf16 v88, v69, s54, v88
    v_dot2_f32_bf16 v89, v69, v69, v89
    v_dot2_f32_bf16 v88, v70, s54, v88
    v_dot2_f32_bf16 v89, v70, v70, v89
    v_dot2_f32_bf16 v88, v71, s54, v88
    v_dot2_f32_bf16 v89, v71, v71, v89
    v_dot2_f32_bf16 v90, v72, s54, v90
    v_dot2_f32_bf16 v90, v73, s54, v90
    v_dot2_f32_bf16 v90, v74, s54, v90
    v_dot2_f32_bf16 v90, v75, s54, v90
    s_waitcnt vmcnt(6)
    s_barrier
    ds_read_b128 v[64:67], v2 offset:8192
    ds_read_b64_tr_b16 v[72:73], v4 offset:8192
    ds_read_b64_tr_b16 v[74:75], v4 offset:8448
    s_waitcnt lgkmcnt(7)
    v_mfma_f32_32x32x16_bf16 v[112:127], v[68:71], v[76:79], v[112:127]
    s_add_u32 m0, s33, 4096
    s_nop 0
    buffer_load_dwordx4 v14, s[4:7], s30 offen lds
    ds_read_b64_tr_b16 v[76:77], v5 offset:8192
    ds_read_b64_tr_b16 v[78:79], v5 offset:8448
    s_waitcnt lgkmcnt(7)
    v_mfma_f32_32x32x16_bf16 v[128:143], v[68:71], v[80:83], v[128:143]
    s_add_u32 m0, s33, 5120
    s_nop 0
    buffer_load_dwordx4 v14, s[4:7], s31 offen lds
    ds_read_b64_tr_b16 v[80:81], v6 offset:8192
    ds_read_b64_tr_b16 v[82:83], v6 offset:8448
    s_waitcnt lgkmcnt(7)
    v_mfma_f32_32x32x16_bf16 v[144:159], v[68:71], v[84:87], v[144:159]
    s_add_u32 m0, s62, 4096
    s_nop 0
    buffer_load_dwordx4 v15, s[8:11], s58 offen lds
    ds_read_b64_tr_b16 v[84:85], v7 offset:8192
    ds_read_b64_tr_b16 v[86:87], v7 offset:8448
    s_waitcnt lgkmcnt(6)
    v_mfma_f32_32x32x16_bf16 v[96:111], v[64:67], v[72:75], v[96:111]
    v_dot2_f32_bf16 v88, v64, s54, v88
    v_dot2_f32_bf16 v89, v64, v64, v89
    v_dot2_f32_bf16 v88, v65, s54, v88
    v_dot2_f32_bf16 v89, v65, v65, v89
    v_dot2_f32_bf16 v88, v66, s54, v88
    v_dot2_f32_bf16 v89, v66, v66, v89
    v_dot2_f32_bf16 v88, v67, s54, v88
    v_dot2_f32_bf16 v89, v67, v67, v89
    v_dot2_f32_bf16 v90, v72, s54, v90
    v_dot2_f32_bf16 v90, v73, s54, v90
    v_dot2_f32_bf16 v90, v74, s54, v90
    v_dot2_f32_bf16 v90, v75, s54, v90
    s_add_u32 s30, s30, 64
    s_add_u32 s31, s31, 64
    s_add_u32 s58, s58, 98304
    ds_read_b128 v[68:71], v3 offset:8192
    ds_read_b64_tr_b16 v[72:73], v4 offset:9216
    ds_read_b64_tr_b16 v[74:75], v4 offset:9472
    s_waitcnt lgkmcnt(7)
    v_mfma_f32_32x32x16_bf16 v[112:127], v[64:67], v[76:79], v[112:127]
    ds_read_b64_tr_b16 v[76:77], v5 offset:9216
    ds_read_b64_tr_b16 v[78:79], v5 offset:9472
    s_waitcnt lgkmcnt(7)
    v_mfma_f32_32x32x16_bf16 v[128:143], v[64:67], v[80:83], v[128:143]
    ds_read_b64_tr_b16 v[80:81], v6 offset:9216
    ds_read_b64_tr_b16 v[82:83], v6 offset:9472
    s_waitcnt lgkmcnt(7)
    v_mfma_f32_32x32x16_bf16 v[144:159], v[64:67], v[84:87], v[144:159]
    ds_read_b64_tr_b16 v[84:85], v7 offset:9216
    ds_read_b64_tr_b16 v[86:87], v7 offset:9472
    s_waitcnt lgkmcnt(6)
    v_mfma_f32_32x32x16_bf16 v[96:111], v[68:71], v[72:75], v[96:111]
    v_dot2_f32_bf16 v88, v68, s54, v88
    v_dot2_f32_bf16 v89, v68, v68, v89
    v_dot2_f32_bf16 v88, v69, s54, v88
    v_dot2_f32_bf16 v89, v69, v69, v89
    v_dot2_f32_bf16 v88, v70, s54, v88
    v_dot2_f32_bf16 v89, v70, v70, v89
    v_dot2_f32_bf16 v88, v71, s54, v88
    v_dot2_f32_bf16 v89, v71, v71, v89
    v_dot2_f32_bf16 v90, v72, s54, v90
    v_dot2_f32_bf16 v90, v73, s54, v90
    v_dot2_f32_bf16 v90, v74, s54, v90
    v_dot2_f32_bf16 v90, v75, s54, v90
    s_waitcnt vmcnt(6)
    s_barrier
    ds_read_b128 v[64:67], v2 offset:0
    ds_read_b64_tr_b16 v[72:73], v4 offset:0
    ds_read_b64_tr_b16 v[74:75], v4 offset:256
    s_waitcnt lgkmcnt(7)
    v_mfma_f32_32x32x16_bf16 v[112:127], v[68:71], v[76:79], v[112:127]
    s_add_u32 m0, s33, 6144
    s_nop 0
    buffer_load_dwordx4 v14, s[4:7], s30 offen lds
    ds_read_b64_tr_b16 v[76:77], v5 offset:0
    ds_read_b64_tr_b16 v[78:79], v5 offset:256
    s_waitcnt lgkmcnt(7)
    v_mfma_f32_32x32x16_bf16 v[128:143], v[68:71], v[80:83], v[128:143]
    s_add_u32 m0, s33, 7168
    s_nop 0
    buffer_load_dwordx4 v14, s[4:7], s31 offen lds
    ds_read_b64_tr_b16 v[80:81], v6 offset:0
    ds_read_b64_tr_b16 v[82:83], v6 offset:256
    s_waitcnt lgkmcnt(7)
    v_mfma_f32_32x32x16_bf16 v[144:159], v[68:71], v[84:87], v[144:159]
    s_add_u32 m0, s62, 6144
    s_nop 0
    buffer_load_dwordx4 v15, s[8:11], s58 offen lds
    ds_read_b64_tr_b16 v[84:85], v7 offset:0
    ds_read_b64_tr_b16 v[86:87], v7 offset:256
    s_waitcnt lgkmcnt(6)
    v_mfma_f32_32x32x16_bf16 v[96:111], v[64:67], v[72:75], v[96:111]
    v_dot2_f32_bf16 v88, v64, s54, v88
    v_dot2_f32_bf16 v89, v64, v64, v89
    v_dot2_f32_bf16 v88, v65, s54, v88
    v_dot2_f32_bf16 v89, v65, v65, v89
    v_dot2_f32_bf16 v88, v66, s54, v88
    v_dot2_f32_bf16 v89, v66, v66, v89
    v_dot2_f32_bf16 v88, v67, s54, v88
    v_dot2_f32_bf16 v89, v67, v67, v89
    v_dot2_f32_bf16 v90, v72, s54, v90
    v_dot2_f32_bf16 v90, v73, s54, v90
    v_dot2_f32_bf16 v90, v74, s54, v90
    v_dot2_f32_bf16 v90, v75, s54, v90
    s_add_u32 s30, s30, 64
    s_add_u32 s31, s31, 64
    s_add_u32 s58, s58, 98304
    ds_read_b128 v[68:71], v3 offset:0
    ds_read_b64_tr_b16 v[72:73], v4 offset:1024
    ds_read_b64_tr_b16 v[74:75], v4 offset:1280
    s_waitcnt lgkmcnt(7)
    v_mfma_f32_32x32x16_bf16 v[112:127], v[64:67], v[76:79], v[112:127]
    ds_read_b64_tr_b16 v[76:77], v5 offset:1024
    ds_read_b64_tr_b16 v[78:79], v5 offset:1280
    s_waitcnt lgkmcnt(7)
    v_mfma_f32_32x32x16_bf16 v[128:143], v[64:67], v[80:83], v[128:143]
    ds_read_b64_tr_b16 v[80:81], v6 offset:1024
    ds_read_b64_tr_b16 v[82:83], v6 offset:1280
    s_waitcnt lgkmcnt(7)
    v_mfma_f32_32x32x16_bf16 v[144:159], v[64:67], v[84:87], v[144:159]
    ds_read_b64_tr_b16 v[84:85], v7 offset:1024
    ds_read_b64_tr_b16 v[86:87], v7 offset:1280
    s_waitcnt lgkmcnt(6)
    v_mfma_f32_32x32x16_bf16 v[96:111], v[68:71], v[72:75], v[96:111]
    v_dot2_f32_bf16 v88, v68, s54, v88
    v_dot2_f32_bf16 v89, v68, v68, v89
    v_dot2_f32_bf16 v88, v69, s54, v88
    v_dot2_f32_bf16 v89, v69, v69, v89
    v_dot2_f32_bf16 v88, v70, s54, v88
    v_dot2_f32_bf16 v89, v70, v70, v89
    v_dot2_f32_bf16 v88, v71, s54, v88
    v_dot2_f32_bf16 v89, v71, v71, v89
    v_dot2_f32_bf16 v90, v72, s54, v90
    v_dot2_f32_bf16 v90, v73, s54, v90
    v_dot2_f32_bf16 v90, v74, s54, v90
    v_dot2_f32_bf16 v90, v75, s54, v90
    s_waitcnt vmcnt(6)
    s_barrier
    ds_read_b128 v[64:67], v2 offset:2048
    ds_read_b64_tr_b16 v[72:73], v4 offset:2048
    ds_read_b64_tr_b16 v[74:75], v4 offset:2304
    s_waitcnt lgkmcnt(7)
    v_mfma_f32_32x32x16_bf16 v[112:127], v[68:71], v[76:79], v[112:127]
    s_add_u32 m0, s33, 8192
    s_nop 0
    buffer_load_dwordx4 v14, s[4:7], s30 offen lds
    ds_read_b64_tr_b16 v[76:77], v5 offset:2048
    ds_read_b64_tr_b16 v[78:79], v5 offset:2304
    s_waitcnt lgkmcnt(7)
    v_mfma_f32_32x32x16_bf16 v[128:143], v[68:71], v[80:83], v[128:143]
    s_add_u32 m0, s33, 9216
    s_nop 0
    buffer_load_dwordx4 v14, s[4:7], s31 offen lds
    ds_read_b64_tr_b16 v[80:81], v6 offset:2048
    ds_read_b64_tr_b16 v[82:83], v6 offset:2304
    s_waitcnt lgkmcnt(7)
    v_mfma_f32_32x32x16_bf16 v[144:159], v[68:71], v[84:87], v[144:159]
    s_add_u32 m0, s62, 8192
    s_nop 0
    buffer_load_dwordx4 v15, s[8:11], s58 offen lds
    ds_read_b64_tr_b16 v[84:85], v7 offset:2048
    ds_read_b64_tr_b16 v[86:87], v7 offset:2304
    s_waitcnt lgkmcnt(6)
    v_mfma_f32_32x32x16_bf16 v[96:111], v[64:67], v[72:75], v[96:111]
    v_dot2_f32_bf16 v88, v64, s54, v88
    v_dot2_f32_bf16 v89, v64, v64, v89
    v_dot2_f32_bf16 v88, v65, s54, v88
    v_dot2_f32_bf16 v89, v65, v65, v89
    v_dot2_f32_bf16 v88, v66, s54, v88
    v_dot2_f32_bf16 v89, v66, v66, v89
    v_dot2_f32_bf16 v88, v67, s54, v88
    v_dot2_f32_bf16 v89, v67, v67, v89
    v_dot2_f32_bf16 v90, v72, s54, v90
    v_dot2_f32_bf16 v90, v73, s54, v90
    v_dot2_f32_bf16 v90, v74, s54, v90
    v_dot2_f32_bf16 v90, v75, s54, v90
    s_add_u32 s30, s30, 64
    s_add_u32 s31, s31, 64
    s_add_u32 s58, s58, 98304
    ds_read_b128 v[68:71], v3 offset:2048
    ds_read_b64_tr_b16 v[72:73], v4 offset:3072
    ds_read_b64_tr_b16 v[74:75], v4 offset:3328
    s_waitcnt lgkmcnt(7)
    v_mfma_f32_32x32x16_bf16 v[112:127], v[64:67], v[76:79], v[112:127]
    ds_read_b64_tr_b16 v[76:77], v5 offset:3072
    ds_read_b64_tr_b16 v[78:79], v5 offset:3328
    s_waitcnt lgkmcnt(7)
    v_mfma_f32_32x32x16_bf16 v[128:143], v[64:67], v[80:83], v[128:143]
    ds_read_b64_tr_b16 v[80:81], v6 offset:3072
    ds_read_b64_tr_b16 v[82:83], v6 offset:3328
    s_waitcnt lgkmcnt(7)
    v_mfma_f32_32x32x16_bf16 v[144:159], v[64:67], v[84:87], v[144:159]
    ds_read_b64_tr_b16 v[84:85], v7 offset:3072
    ds_read_b64_tr_b16 v[86:87], v7 offset:3328
    s_waitcnt lgkmcnt(6)
    v_mfma_f32_32x32x16_bf16 v[96:111], v[68:71], v[72:75], v[96:111]
    v_dot2_f32_bf16 v88, v68, s54, v88
    v_dot2_f32_bf16 v89, v68, v68, v89
    v_dot2_f32_bf16 v88, v69, s54, v88
    v_dot2_f32_bf16 v89, v69, v69, v89
    v_dot2_f32_bf16 v88, v70, s54, v88
    v_dot2_f32_bf16 v89, v70, v70, v89
    v_dot2_f32_bf16 v88, v71, s54, v88
    v_dot2_f32_bf16 v89, v71, v71, v89
    v_dot2_f32_bf16 v90, v72, s54, v90
    v_dot2_f32_bf16 v90, v73, s54, v90
    v_dot2_f32_bf16 v90, v74, s54, v90
    v_dot2_f32_bf16 v90, v75, s54, v90
    s_waitcnt vmcnt(6)
    s_barrier
    ds_read_b128 v[64:67], v2 offset:4096
    ds_read_b64_tr_b16 v[72:73], v4 offset:4096
    ds_read_b64_tr_b16 v[74:75], v4 offset:4352
    s_waitcnt lgkmcnt(7)
    v_mfma_f32_32x32x16_bf16 v[112:127], v[68:71], v[76:79], v[112:127]
    s_add_u32 m0, s33, 0
    s_nop 0
    buffer_load_dwordx4 v14, s[4:7], s30 offen lds
    ds_read_b64_tr_b16 v[76:77], v5 offset:4096
    ds_read_b64_tr_b16 v[78:79], v5 offset:4352
    s_waitcnt lgkmcnt(7)
    v_mfma_f32_32x32x16_bf16 v[128:143], v[68:71], v[80:83], v[128:143]
    s_add_u32 m0, s33, 1024
    s_nop 0
    buffer_load_dwordx4 v14, s[4:7], s31 offen lds
    ds_read_b64_tr_b16 v[80:81], v6 offset:4096
    ds_read_b64_tr_b16 v[82:83], v6 offset:4352
    s_waitcnt lgkmcnt(7)
    v_mfma_f32_32x32x16_bf16 v[144:159], v[68:71], v[84:87], v[144:159]
    s_add_u32 m0, s62, 0
    s_nop 0
    buffer_load_dwordx4 v15, s[8:11], s58 offen lds
    ds_read_b64_tr_b16 v[84:85], v7 offset:4096
    ds_read_b64_tr_b16 v[86:87], v7 offset:4352
    s_waitcnt lgkmcnt(6)
    v_mfma_f32_32x32x16_bf16 v[96:111], v[64:67], v[72:75], v[96:111]
    v_dot2_f32_bf16 v88, v64, s54, v88
    v_dot2_f32_bf16 v89, v64, v64, v89
    v_dot2_f32_bf16 v88, v65, s54, v88
    v_dot2_f32_bf16 v89, v65, v65, v89
    v_dot2_f32_bf16 v88, v66, s54, v88
    v_dot2_f32_bf16 v89, v66, v66, v89
    v_dot2_f32_bf16 v88, v67, s54, v88
    v_dot2_f32_bf16 v89, v67, v67, v89
    v_dot2_f32_bf16 v90, v72, s54, v90
    v_dot2_f32_bf16 v90, v73, s54, v90
    v_dot2_f32_bf16 v90, v74, s54, v90
    v_dot2_f32_bf16 v90, v75, s54, v90
    s_add_u32 s30, s30, 64
    s_add_u32 s31, s31, 64
    s_add_u32 s58, s58, 98304
    ds_read_b128 v[68:71], v3 offset:4096
    ds_read_b64_tr_b16 v[72:73], v4 offset:5120
    ds_read_b64_tr_b16 v[74:75], v4 offset:5376
    s_waitcnt lgkmcnt(7)
    v_mfma_f32_32x32x16_bf16 v[112:127], v[64:67], v[76:79], v[112:127]
    ds_read_b64_tr_b16 v[76:77], v5 offset:5120
    ds_read_b64_tr_b16 v[78:79], v5 offset:5376
    s_waitcnt lgkmcnt(7)
    v_mfma_f32_32x32x16_bf16 v[128:143], v[64:67], v[80:83], v[128:143]
    ds_read_b64_tr_b16 v[80:81], v6 offset:5120
    ds_read_b64_tr_b16 v[82:83], v6 offset:5376
    s_waitcnt lgkmcnt(7)
    v_mfma_f32_32x32x16_bf16 v[144:159], v[64:67], v[84:87], v[144:159]
    ds_read_b64_tr_b16 v[84:85], v7 offset:5120
    ds_read_b64_tr_b16 v[86:87], v7 offset:5376
    s_waitcnt lgkmcnt(6)
    v_mfma_f32_32x32x16_bf16 v[96:111], v[68:71], v[72:75], v[96:111]
    v_dot2_f32_bf16 v88, v68, s54, v88
    v_dot2_f32_bf16 v89, v68, v68, v89
    v_dot2_f32_bf16 v88, v69, s54, v88
    v_dot2_f32_bf16 v89, v69, v69, v89
    v_dot2_f32_bf16 v88, v70, s54, v88
    v_dot2_f32_bf16 v89, v70, v70, v89
    v_dot2_f32_bf16 v88, v71, s54, v88
    v_dot2_f32_bf16 v89, v71, v71, v89
    v_dot2_f32_bf16 v90, v72, s54, v90
    v_dot2_f32_bf16 v90, v73, s54, v90
    v_dot2_f32_bf16 v90, v74, s54, v90
    v_dot2_f32_bf16 v90, v75, s54, v90
    s_waitcnt vmcnt(6)
    s_barrier
    ds_read_b128 v[64:67], v2 offset:6144
    ds_read_b64_tr_b16 v[72:73], v4 offset:6144
    ds_read_b64_tr_b16 v[74:75], v4 offset:6400
    s_waitcnt lgkmcnt(7)
    v_mfma_f32_32x32x16_bf16 v[112:127], v[68:71], v[76:79], v[112:127]
    ds_read_b64_tr_b16 v[76:77], v5 offset:6144
    ds_read_b64_tr_b16 v[78:79], v5 offset:6400
    s_waitcnt lgkmcnt(7)
    v_mfma_f32_32x32x16_bf16 v[128:143], v[68:71], v[80:83], v[128:143]
    ds_read_b64_tr_b16 v[80:81], v6 offset:6144
    ds_read_b64_tr_b16 v[82:83], v6 offset:6400
    s_waitcnt lgkmcnt(7)
    v_mfma_f32_32x32x16_bf16 v[144:159], v[68:71], v[84:87], v[144:159]
    ds_read_b64_tr_b16 v[84:85], v7 offset:6144
    ds_read_b64_tr_b16 v[86:87], v7 offset:6400
    s_waitcnt lgkmcnt(6)
    v_mfma_f32_32x32x16_bf16 v[96:111], v[64:67], v[72:75], v[96:111]
    v_dot2_f32_bf16 v88, v64, s54, v88
    v_dot2_f32_bf16 v89, v64, v64, v89
    v_dot2_f32_bf16 v88, v65, s54, v88
    v_dot2_f32_bf16 v89, v65, v65, v89
    v_dot2_f32_bf16 v88, v66, s54, v88
    v_dot2_f32_bf16 v89, v66, v66, v89
    v_dot2_f32_bf16 v88, v67, s54, v88
    v_dot2_f32_bf16 v89, v67, v67, v89
    v_dot2_f32_bf16 v90, v72, s54, v90
    v_dot2_f32_bf16 v90, v73, s54, v90
    v_dot2_f32_bf16 v90, v74, s54, v90
    v_dot2_f32_bf16 v90, v75, s54, v90
    ds_read_b128 v[68:71], v3 offset:6144
    ds_read_b64_tr_b16 v[72:73], v4 offset:7168
    ds_read_b64_tr_b16 v[74:75], v4 offset:7424
    s_waitcnt lgkmcnt(7)
    v_mfma_f32_32x32x16_bf16 v[112:127], v[64:67], v[76:79], v[112:127]
    ds_read_b64_tr_b16 v[76:77], v5 offset:7168
    ds_read_b64_tr_b16 v[78:79], v5 offset:7424
    s_waitcnt lgkmcnt(7)
    v_mfma_f32_32x32x16_bf16 v[128:143], v[64:67], v[80:83], v[128:143]
    ds_read_b64_tr_b16 v[80:81], v6 offset:7168
    ds_read_b64_tr_b16 v[82:83], v6 offset:7424
    s_waitcnt lgkmcnt(7)
    v_mfma_f32_32x32x16_bf16 v[144:159], v[64:67], v[84:87], v[144:159]
    ds_read_b64_tr_b16 v[84:85], v7 offset:7168
    ds_read_b64_tr_b16 v[86:87], v7 offset:7424
    s_waitcnt lgkmcnt(6)
    v_mfma_f32_32x32x16_bf16 v[96:111], v[68:71], v[72:75], v[96:111]
    v_dot2_f32_bf16 v88, v68, s54, v88
    v_dot2_f32_bf16 v89, v68, v68, v89
    v_dot2_f32_bf16 v88, v69, s54, v88
    v_dot2_f32_bf16 v89, v69, v69, v89
    v_dot2_f32_bf16 v88, v70, s54, v88
    v_dot2_f32_bf16 v89, v70, v70, v89
    v_dot2_f32_bf16 v88, v71, s54, v88
    v_dot2_f32_bf16 v89, v71, v71, v89
    v_dot2_f32_bf16 v90, v72, s54, v90
    v_dot2_f32_bf16 v90, v73, s54, v90
    v_dot2_f32_bf16 v90, v74, s54, v90
    v_dot2_f32_bf16 v90, v75, s54, v90
    s_waitcnt vmcnt(3)
    s_barrier
    ds_read_b128 v[64:67], v2 offset:8192
    ds_read_b64_tr_b16 v[72:73], v4 offset:8192
    ds_read_b64_tr_b16 v[74:75], v4 offset:8448
    s_waitcnt lgkmcnt(7)
    v_mfma_f32_32x32x16_bf16 v[112:127], v[68:71], v[76:79], v[112:127]
    ds_read_b64_tr_b16 v[76:77], v5 offset:8192
    ds_read_b64_tr_b16 v[78:79], v5 offset:8448
    s_waitcnt lgkmcnt(7)
    v_mfma_f32_32x32x16_bf16 v[128:143], v[68:71], v[80:83], v[128:143]
    ds_read_b64_tr_b16 v[80:81], v6 offset:8192
    ds_read_b64_tr_b16 v[82:83], v6 offset:8448
    s_waitcnt lgkmcnt(7)
    v_mfma_f32_32x32x16_bf16 v[144:159], v[68:71], v[84:87], v[144:159]
    ds_read_b64_tr_b16 v[84:85], v7 offset:8192
    ds_read_b64_tr_b16 v[86:87], v7 offset:8448
    s_waitcnt lgkmcnt(6)
    v_mfma_f32_32x32x16_bf16 v[96:111], v[64:67], v[72:75], v[96:111]
    v_dot2_f32_bf16 v88, v64, s54, v88
    v_dot2_f32_bf16 v89, v64, v64, v89
    v_dot2_f32_bf16 v88, v65, s54, v88
    v_dot2_f32_bf16 v89, v65, v65, v89
    v_dot2_f32_bf16 v88, v66, s54, v88
    v_dot2_f32_bf16 v89, v66, v66, v89
    v_dot2_f32_bf16 v88, v67, s54, v88
    v_dot2_f32_bf16 v89, v67, v67, v89
    v_dot2_f32_bf16 v90, v72, s54, v90
    v_dot2_f32_bf16 v90, v73, s54, v90
    v_dot2_f32_bf16 v90, v74, s54, v90
    v_dot2_f32_bf16 v90, v75, s54, v90
    ds_read_b128 v[68:71], v3 offset:8192
    ds_read_b64_tr_b16 v[72:73], v4 offset:9216
    ds_read_b64_tr_b16 v[74:75], v4 offset:9472
    s_waitcnt lgkmcnt(7)
    v_mfma_f32_32x32x16_bf16 v[112:127], v[64:67], v[76:79], v[112:127]
    ds_read_b64_tr_b16 v[76:77], v5 offset:9216
    ds_read_b64_tr_b16 v[78:79], v5 offset:9472
    s_waitcnt lgkmcnt(7)
    v_mfma_f32_32x32x16_bf16 v[128:143], v[64:67], v[80:83], v[128:143]
    ds_read_b64_tr_b16 v[80:81], v6 offset:9216
    ds_read_b64_tr_b16 v[82:83], v6 offset:9472
    s_waitcnt lgkmcnt(7)
    v_mfma_f32_32x32x16_bf16 v[144:159], v[64:67], v[84:87], v[144:159]
    ds_read_b64_tr_b16 v[84:85], v7 offset:9216
    ds_read_b64_tr_b16 v[86:87], v7 offset:9472
    s_waitcnt lgkmcnt(6)
    v_mfma_f32_32x32x16_bf16 v[96:111], v[68:71], v[72:75], v[96:111]
    v_dot2_f32_bf16 v88, v68, s54, v88
    v_dot2_f32_bf16 v89, v68, v68, v89
    v_dot2_f32_bf16 v88, v69, s54, v88
    v_dot2_f32_bf16 v89, v69, v69, v89
    v_dot2_f32_bf16 v88, v70, s54, v88
    v_dot2_f32_bf16 v89, v70, v70, v89
    v_dot2_f32_bf16 v88, v71, s54, v88
    v_dot2_f32_bf16 v89, v71, v71, v89
    v_dot2_f32_bf16 v90, v72, s54, v90
    v_dot2_f32_bf16 v90, v73, s54, v90
    v_dot2_f32_bf16 v90, v74, s54, v90
    v_dot2_f32_bf16 v90, v75, s54, v90
    s_waitcnt vmcnt(0)
    s_barrier
    ds_read_b128 v[64:67], v2 offset:0
    ds_read_b64_tr_b16 v[72:73], v4 offset:0
    ds_read_b64_tr_b16 v[74:75], v4 offset:256
    s_waitcnt lgkmcnt(7)
    v_mfma_f32_32x32x16_bf16 v[112:127], v[68:71], v[76:79], v[112:127]
    ds_read_b64_tr_b16 v[76:77], v5 offset:0
    ds_read_b64_tr_b16 v[78:79], v5 offset:256
    s_waitcnt lgkmcnt(7)
    v_mfma_f32_32x32x16_bf16 v[128:143], v[68:71], v[80:83], v[128:143]
    ds_read_b64_tr_b16 v[80:81], v6 offset:0
    ds_read_b64_tr_b16 v[82:83], v6 offset:256
    s_waitcnt lgkmcnt(7)
    v_mfma_f32_32x32x16_bf16 v[144:159], v[68:71], v[84:87], v[144:159]
    ds_read_b64_tr_b16 v[84:85], v7 offset:0
    ds_read_b64_tr_b16 v[86:87], v7 offset:256
    s_waitcnt lgkmcnt(6)
    v_mfma_f32_32x32x16_bf16 v[96:111], v[64:67], v[72:75], v[96:111]
    v_dot2_f32_bf16 v88, v64, s54, v88
    v_dot2_f32_bf16 v89, v64, v64, v89
    v_dot2_f32_bf16 v88, v65, s54, v88
    v_dot2_f32_bf16 v89, v65, v65, v89
    v_dot2_f32_bf16 v88, v66, s54, v88
    v_dot2_f32_bf16 v89, v66, v66, v89
    v_dot2_f32_bf16 v88, v67, s54, v88
    v_dot2_f32_bf16 v89, v67, v67, v89
    v_dot2_f32_bf16 v90, v72, s54, v90
    v_dot2_f32_bf16 v90, v73, s54, v90
    v_dot2_f32_bf16 v90, v74, s54, v90
    v_dot2_f32_bf16 v90, v75, s54, v90
    ds_read_b128 v[68:71], v3 offset:0
    ds_read_b64_tr_b16 v[72:73], v4 offset:1024
    ds_read_b64_tr_b16 v[74:75], v4 offset:1280
    s_waitcnt lgkmcnt(7)
    v_mfma_f32_32x32x16_bf16 v[112:127], v[64:67], v[76:79], v[112:127]
    ds_read_b64_tr_b16 v[76:77], v5 offset:1024
    ds_read_b64_tr_b16 v[78:79], v5 offset:1280
    s_waitcnt lgkmcnt(7)
    v_mfma_f32_32x32x16_bf16 v[128:143], v[64:67], v[80:83], v[128:143]
    ds_read_b64_tr_b16 v[80:81], v6 offset:1024
    ds_read_b64_tr_b16 v[82:83], v6 offset:1280
    s_waitcnt lgkmcnt(7)
    v_mfma_f32_32x32x16_bf16 v[144:159], v[64:67], v[84:87], v[144:159]
    ds_read_b64_tr_b16 v[84:85], v7 offset:1024
    ds_read_b64_tr_b16 v[86:87], v7 offset:1280
    s_waitcnt lgkmcnt(6)
    v_mfma_f32_32x32x16_bf16 v[96:111], v[68:71], v[72:75], v[96:111]
    v_dot2_f32_bf16 v88, v68, s54, v88
    v_dot2_f32_bf16 v89, v68, v68, v89
    v_dot2_f32_bf16 v88, v69, s54, v88
    v_dot2_f32_bf16 v89, v69, v69, v89
    v_dot2_f32_bf16 v88, v70, s54, v88
    v_dot2_f32_bf16 v89, v70, v70, v89
    v_dot2_f32_bf16 v88, v71, s54, v88
    v_dot2_f32_bf16 v89, v71, v71, v89
    v_dot2_f32_bf16 v90, v72, s54, v90
    v_dot2_f32_bf16 v90, v73, s54, v90
    v_dot2_f32_bf16 v90, v74, s54, v90
    v_dot2_f32_bf16 v90, v75, s54, v90
    s_waitcnt lgkmcnt(4)
    v_mfma_f32_32x32x16_bf16 v[112:127], v[68:71], v[76:79], v[112:127]
    s_waitcnt lgkmcnt(2)
    v_mfma_f32_32x32x16_bf16 v[128:143], v[68:71], v[80:83], v[128:143]
    s_waitcnt lgkmcnt(0)
    v_mfma_f32_32x32x16_bf16 v[144:159], v[68:71], v[84:87], v[144:159]
    v_mov_b32 v21, v88
    v_mov_b32 v22, v88
    s_nop 1
    v_permlane32_swap_b32 v21, v22
    v_add_f32 v88, v21, v22
    v_mov_b32 v21, v89
    v_mov_b32 v22, v89
    s_nop 1
    v_permlane32_swap_b32 v21, v22
    v_add_f32 v89, v21, v22
    v_mov_b32 v21, v90
    v_mov_b32 v22, v90
    s_nop 1
    v_permlane32_swap_b32 v21, v22
    v_add_f32 v90, v21, v22
    v_mul_f32 v23, 0x3b000000, v88
    v_mul_f32 v24, 0x3b000000, v89
    v_fma_f32 v24, -v23, v23, v24
    v_add_f32 v24, 0x3727c5ac, v24
    v_rsq_f32 v25, v24
    s_waitcnt lgkmcnt(0)
    s_barrier
    v_lshlrev_b32 v21, 2, v20
    s_lshl_b32 s48, s36, 7
    v_add_u32 v22, s48, v21
    ds_write_b32 v22, v90
    s_waitcnt lgkmcnt(0)
    s_barrier
    s_lshl_b32 s48, s36, 7
    v_add_u32 v22, s48, v21
    ds_read_b32 v32, v22
    s_lshl_b32 s48, s37, 7
    v_add_u32 v22, s48, v21
    ds_read_b32 v33, v22
    s_lshl_b32 s48, s38, 7
    v_add_u32 v22, s48, v21
    ds_read_b32 v34, v22
    s_lshl_b32 s48, s39, 7
    v_add_u32 v22, s48, v21
    ds_read_b32 v35, v22
    v_mov_b32 v46, 0
    v_mov_b32 v47, 0
    v_mov_b32 v50, 0
    v_mov_b32 v51, 0
    v_sub_f32 v21, 0, v23
    v_cndmask_b32 v21, v21, 0, s[50:51]
    v_cvt_pk_bf16_f32 v44, v21, v21
    v_lshlrev_b32 v22, 16, v44
    v_sub_f32 v22, v21, v22
    v_cvt_pk_bf16_f32 v44, v21, v22
    v_mov_b32 v45, v44
    s_waitcnt lgkmcnt(3)
    v_cndmask_b32 v21, v32, 0, s[50:51]
    v_cvt_pk_bf16_f32 v48, v21, v21
    v_lshlrev_b32 v22, 16, v48
    v_sub_f32 v22, v21, v22
    v_cvt_pk_bf16_f32 v49, v22, v22
    s_nop 1
    v_mfma_f32_32x32x16_bf16 v[96:111], v[44:47], v[48:51], v[96:111]
    s_waitcnt lgkmcnt(2)
    v_cndmask_b32 v21, v33, 0, s[50:51]
    v_cvt_pk_bf16_f32 v48, v21, v21
    v_lshlrev_b32 v22, 16, v48
    v_sub_f32 v22, v21, v22
    v_cvt_pk_bf16_f32 v49, v22, v22
    s_nop 1
    v_mfma_f32_32x32x16_bf16 v[112:127], v[44:47], v[48:51], v[112:127]
    s_waitcnt lgkmcnt(1)
    v_cndmask_b32 v21, v34, 0, s[50:51]
    v_cvt_pk_bf16_f32 v48, v21, v21
    v_lshlrev_b32 v22, 16, v48
    v_sub_f32 v22, v21, v22
    v_cvt_pk_bf16_f32 v49, v22, v22
    s_nop 1
    v_mfma_f32_32x32x16_bf16 v[128:143], v[44:47], v[48:51], v[128:143]
    s_waitcnt lgkmcnt(0)
    v_cndmask_b32 v21, v35, 0, s[50:51]
    v_cvt_pk_bf16_f32 v48, v21, v21
    v_lshlrev_b32 v22, 16, v48
    v_sub_f32 v22, v21, v22
    v_cvt_pk_bf16_f32 v49, v22, v22
    s_nop 1
    v_mfma_f32_32x32x16_bf16 v[144:159], v[44:47], v[48:51], v[144:159]
    v_lshrrev_b32 v21, 5, v1
    v_lshlrev_b32 v21, 4, v21
    v_add_u32 v22, 0, v21
    ds_bpermute_b32 v32, v22, v25
    v_add_u32 v22, 4, v21
    ds_bpermute_b32 v33, v22, v25
    v_add_u32 v22, 8, v21
    ds_bpermute_b32 v34, v22, v25
    v_add_u32 v22, 12, v21
    ds_bpermute_b32 v35, v22, v25
    v_add_u32 v22, 32, v21
    ds_bpermute_b32 v36, v22, v25
    v_add_u32 v22, 36, v21
    ds_bpermute_b32 v37, v22, v25
    v_add_u32 v22, 40, v21
    ds_bpermute_b32 v38, v22, v25
    v_add_u32 v22, 44, v21
    ds_bpermute_b32 v39, v22, v25
    v_add_u32 v22, 64, v21
    ds_bpermute_b32 v40, v22, v25
    v_add_u32 v22, 68, v21
    ds_bpermute_b32 v41, v22, v25
    v_add_u32 v22, 72, v21
    ds_bpermute_b32 v42, v22, v25
    v_add_u32 v22, 76, v21
    ds_bpermute_b32 v43, v22, v25
    v_add_u32 v22, 96, v21
    ds_bpermute_b32 v44, v22, v25
    v_add_u32 v22, 100, v21
    ds_bpermute_b32 v45, v22, v25
    v_add_u32 v22, 104, v21
    ds_bpermute_b32 v46, v22, v25
    v_add_u32 v22, 108, v21
    ds_bpermute_b32 v47, v22, v25
    v_lshrrev_b32 v26, 4, v20
    v_lshlrev_b32 v26, 16, v26
    v_and_b32 v22, 15, v20
    v_lshl_add_u32 v26, v22, 5, v26
    v_add_u32 v26, v21, v26
    s_lshl_b32 s46, s17, 4
    s_lshl_b32 s47, s16, 1
    s_add_u32 s46, s46, s47
    s_lshl_b32 s46, s46, 9
    s_add_u32 s46, s46, 0x400000
    s_waitcnt lgkmcnt(14)
    v_pk_mul_f32 v[96:97], v[96:97], v[32:33]
    s_waitcnt lgkmcnt(12)
    v_pk_mul_f32 v[98:99], v[98:99], v[34:35]
    s_waitcnt lgkmcnt(10)
    v_pk_mul_f32 v[100:101], v[100:101], v[36:37]
    s_waitcnt lgkmcnt(8)
    v_pk_mul_f32 v[102:103], v[102:103], v[38:39]
    s_waitcnt lgkmcnt(6)
    v_pk_mul_f32 v[104:105], v[104:105], v[40:41]
    s_waitcnt lgkmcnt(4)
    v_pk_mul_f32 v[106:107], v[106:107], v[42:43]
    s_waitcnt lgkmcnt(2)
    v_pk_mul_f32 v[108:109], v[108:109], v[44:45]
    s_waitcnt lgkmcnt(0)
    v_pk_mul_f32 v[110:111], v[110:111], v[46:47]
    v_cvt_pk_bf16_f32 v56, v96, v97
    v_cvt_pk_bf16_f32 v57, v98, v99
    v_cvt_pk_bf16_f32 v58, v100, v101
    v_cvt_pk_bf16_f32 v59, v102, v103
    v_cvt_pk_bf16_f32 v60, v104, v105
    v_cvt_pk_bf16_f32 v61, v106, v107
    v_cvt_pk_bf16_f32 v62, v108, v109
    v_cvt_pk_bf16_f32 v63, v110, v111
    s_add_u32 s47, s35, s36
    s_sub_u32 s47, s47, 32
    s_lshl_b32 s48, s47, 17
    s_add_u32 s48, s48, s46
    s_add_u32 s49, s48, 512
    buffer_store_dwordx4 v[56:59], v26, s[12:15], s48 offen
    buffer_store_dwordx4 v[60:63], v26, s[12:15], s49 offen
    v_pk_mul_f32 v[112:113], v[112:113], v[32:33]
    v_pk_mul_f32 v[114:115], v[114:115], v[34:35]
    v_pk_mul_f32 v[116:117], v[116:117], v[36:37]
    v_pk_mul_f32 v[118:119], v[118:119], v[38:39]
    v_pk_mul_f32 v[120:121], v[120:121], v[40:41]
    v_pk_mul_f32 v[122:123], v[122:123], v[42:43]
    v_pk_mul_f32 v[124:125], v[124:125], v[44:45]
    v_pk_mul_f32 v[126:127], v[126:127], v[46:47]
    v_cvt_pk_bf16_f32 v48, v112, v113
    v_cvt_pk_bf16_f32 v49, v114, v115
    v_cvt_pk_bf16_f32 v50, v116, v117
    v_cvt_pk_bf16_f32 v51, v118, v119
    v_cvt_pk_bf16_f32 v52, v120, v121
    v_cvt_pk_bf16_f32 v53, v122, v123
    v_cvt_pk_bf16_f32 v54, v124, v125
    v_cvt_pk_bf16_f32 v55, v126, v127
    s_add_u32 s47, s35, s37
    s_sub_u32 s47, s47, 32
    s_lshl_b32 s48, s47, 17
    s_add_u32 s48, s48, s46
    s_add_u32 s49, s48, 512
    buffer_store_dwordx4 v[48:51], v26, s[12:15], s48 offen
    buffer_store_dwordx4 v[52:55], v26, s[12:15], s49 offen
    v_pk_mul_f32 v[128:129], v[128:129], v[32:33]
    v_pk_mul_f32 v[130:131], v[130:131], v[34:35]
    v_pk_mul_f32 v[132:133], v[132:133], v[36:37]
    v_pk_mul_f32 v[134:135], v[134:135], v[38:39]
    v_pk_mul_f32 v[136:137], v[136:137], v[40:41]
    v_pk_mul_f32 v[138:139], v[138:139], v[42:43]
    v_pk_mul_f32 v[140:141], v[140:141], v[44:45]
    v_pk_mul_f32 v[142:143], v[142:143], v[46:47]
    v_cvt_pk_bf16_f32 v56, v128, v129
    v_cvt_pk_bf16_f32 v57, v130, v131
    v_cvt_pk_bf16_f32 v58, v132, v133
    v_cvt_pk_bf16_f32 v59, v134, v135
    v_cvt_pk_bf16_f32 v60, v136, v137
    v_cvt_pk_bf16_f32 v61, v138, v139
    v_cvt_pk_bf16_f32 v62, v140, v141
    v_cvt_pk_bf16_f32 v63, v142, v143
    s_add_u32 s47, s35, s38
    s_sub_u32 s47, s47, 32
    s_lshl_b32 s48, s47, 17
    s_add_u32 s48, s48, s46
    s_add_u32 s49, s48, 512
    buffer_store_dwordx4 v[56:59], v26, s[12:15], s48 offen
    buffer_store_dwordx4 v[60:63], v26, s[12:15], s49 offen
    v_pk_mul_f32 v[144:145], v[144:145], v[32:33]
    v_pk_mul_f32 v[146:147], v[146:147], v[34:35]
    v_pk_mul_f32 v[148:149], v[148:149], v[36:37]
    v_pk_mul_f32 v[150:151], v[150:151], v[38:39]
    v_pk_mul_f32 v[152:153], v[152:153], v[40:41]
    v_pk_mul_f32 v[154:155], v[154:155], v[42:43]
    v_pk_mul_f32 v[156:157], v[156:157], v[44:45]
    v_pk_mul_f32 v[158:159], v[158:159], v[46:47]
    v_cvt_pk_bf16_f32 v48, v144, v145
    v_cvt_pk_bf16_f32 v49, v146, v147
    v_cvt_pk_bf16_f32 v50, v148, v149
    v_cvt_pk_bf16_f32 v51, v150, v151
    v_cvt_pk_bf16_f32 v52, v152, v153
    v_cvt_pk_bf16_f32 v53, v154, v155
    v_cvt_pk_bf16_f32 v54, v156, v157
    v_cvt_pk_bf16_f32 v55, v158, v159
    s_add_u32 s47, s35, s39
    s_sub_u32 s47, s47, 32
    s_lshl_b32 s48, s47, 17
    s_add_u32 s48, s48, s46
    s_add_u32 s49, s48, 512
    buffer_store_dwordx4 v[48:51], v26, s[12:15], s48 offen
    buffer_store_dwordx4 v[52:55], v26, s[12:15], s49 offen
    s_endpgm
L_k1_ffn:
    s_lshr_b32 s46, s16, 2
    s_and_b32 s47, s16, 3
    s_cmp_lt_u32 s47, 2
    s_cselect_b32 s8, s24, s26
    s_cselect_b32 s9, s25, s27
    s_mov_b32 s10, 0x158000
    s_mov_b32 s11, 0x00020000
    s_sub_u32 s35, s18, 10
    s_lshl_b32 s35, s35, 1
    s_and_b32 s48, s47, 1
    s_add_u32 s52, s35, s48
    s_min_u32 s52, s52, 42
    s_lshl_b32 s52, s52, 6
    s_and_b32 s19, s16, 1
    s_mul_i32 s62, s47, 10240
    s_lshl_b32 s48, s46, 10
    s_add_u32 s62, s62, s48
    s_add_u32 s62, s62, 81920
    s_mul_i32 s58, s46, 44032
    s_add_u32 s36, s19, 0
    s_cmp_ge_u32 s36, 2
    s_cselect_b32 s48, 2, 0
    s_sub_u32 s36, s36, s48
    s_add_u32 s37, s19, 1
    s_cmp_ge_u32 s37, 2
    s_cselect_b32 s48, 2, 0
    s_sub_u32 s37, s37, s48
    s_lshl_b32 s30, s17, 18
    s_add_u32 s31, s30, 16384
    s_mul_i32 s33, s16, 10240
    v_lshrrev_b32 v21, 2, v1
    v_lshlrev_b32 v21, 10, v21
    s_lshl_b32 s48, s16, 15
    v_add_u32 v14, s48, v21
    v_lshrrev_b32 v21, 4, v1
    v_xor_b32 v21, v21, v1
    v_and_b32 v21, 3, v21
    v_lshl_add_u32 v14, v21, 4, v14
    v_lshrrev_b32 v21, 2, v1
    s_movk_i32 s48, 2752
    v_mul_lo_u32 v21, v21, s48
    v_and_b32 v22, 3, v1
    v_lshl_add_u32 v21, v22, 4, v21
    v_add_u32 v15, s52, v21
    v_lshrrev_b32 v21, 5, v1
    v_bfe_u32 v22, v1, 2, 2
    v_lshlrev_b32 v23, 6, v20
    v_add_u32 v23, s33, v23
    v_add_u32 v24, 0, v21
    v_xor_b32 v24, v24, v22
    v_lshl_add_u32 v2, v24, 4, v23
    v_add_u32 v24, 2, v21
    v_xor_b32 v24, v24, v22
    v_lshl_add_u32 v3, v24, 4, v23
    v_lshrrev_b32 v21, 5, v1
    v_bfe_u32 v22, v1, 2, 2
    v_lshl_add_u32 v21, v21, 3, v22
    v_lshlrev_b32 v21, 6, v21
    v_bfe_u32 v22, v1, 4, 1
    v_lshl_add_u32 v21, v22, 5, v21
    v_and_b32 v22, 3, v1
    v_lshl_add_u32 v21, v22, 3, v21
    s_mul_i32 s48, s36, 10240
    s_add_u32 s48, s48, 81920
    v_add_u32 v4, s48, v21
    s_mul_i32 s48, s37, 10240
    s_add_u32 s48, s48, 81920
    v_add_u32 v5, s48, v21
    v_mov_b32 v88, 0
    v_mov_b32 v89, 0
    v_mov_b32 v90, 0
    v_mov_b32 v91, 0
    s_mov_b32 s54, 0x3f803f80
    s_add_u32 m0, s33, 0
    s_nop 0
    buffer_load_dwordx4 v14, s[4:7], s30 offen lds
    s_add_u32 m0, s33, 1024
    s_nop 0
    buffer_load_dwordx4 v14, s[4:7], s31 offen lds
    s_add_u32 m0, s62, 0
    s_nop 0
    buffer_load_dwordx4 v15, s[8:11], s58 offen lds
    s_add_u32 s30, s30, 64
    s_add_u32 s31, s31, 64
    s_add_u32 s58, s58, 88064
    s_add_u32 m0, s33, 2048
    s_nop 0
    buffer_load_dwordx4 v14, s[4:7], s30 offen lds
    s_add_u32 m0, s33, 3072
    s_nop 0
    buffer_load_dwordx4 v14, s[4:7], s31 offen lds
    s_add_u32 m0, s62, 2048
    s_nop 0
    buffer_load_dwordx4 v15, s[8:11], s58 offen lds
    s_add_u32 s30, s30, 64
    s_add_u32 s31, s31, 64
    s_add_u32 s58, s58, 88064
    s_add_u32 m0, s33, 4096
    s_nop 0
    buffer_load_dwordx4 v14, s[4:7], s30 offen lds
    s_add_u32 m0, s33, 5120
    s_nop 0
    buffer_load_dwordx4 v14, s[4:7], s31 offen lds
    s_add_u32 m0, s62, 4096
    s_nop 0
    buffer_load_dwordx4 v15, s[8:11], s58 offen lds
    s_add_u32 s30, s30, 64
    s_add_u32 s31, s31, 64
    s_add_u32 s58, s58, 88064
    s_waitcnt vmcnt(6)
    s_barrier
    ds_read_b128 v[64:67], v2 offset:0
    ds_read_b64_tr_b16 v[72:73], v4 offset:0
    ds_read_b64_tr_b16 v[74:75], v4 offset:256
    ds_read_b64_tr_b16 v[76:77], v4 offset:20480
    ds_read_b64_tr_b16 v[78:79], v4 offset:20736
    ds_read_b64_tr_b16 v[80:81], v5 offset:0
    ds_read_b64_tr_b16 v[82:83], v5 offset:256
    ds_read_b64_tr_b16 v[84:85], v5 offset:20480
    ds_read_b64_tr_b16 v[86:87], v5 offset:20736
    s_waitcnt lgkmcnt(6)
    v_mfma_f32_32x32x16_bf16 v[96:111], v[72:75], v[64:67], 0
    v_dot2_f32_bf16 v88, v64, s54, v88
    v_dot2_f32_bf16 v89, v64, v64, v89
    v_dot2_f32_bf16 v88, v65, s54, v88
    v_dot2_f32_bf16 v89, v65, v65, v89
    v_dot2_f32_bf16 v88, v66, s54, v88
    v_dot2_f32_bf16 v89, v66, v66, v89
    v_dot2_f32_bf16 v88, v67, s54, v88
    v_dot2_f32_bf16 v89, v67, v67, v89
    v_dot2_f32_bf16 v90, v72, s54, v90
    v_dot2_f32_bf16 v90, v73, s54, v90
    v_dot2_f32_bf16 v90, v74, s54, v90
    v_dot2_f32_bf16 v90, v75, s54, v90
    s_add_u32 m0, s33, 6144
    s_nop 0
    buffer_load_dwordx4 v14, s[4:7], s30 offen lds
    ds_read_b128 v[68:71], v3 offset:0
    ds_read_b64_tr_b16 v[72:73], v4 offset:1024
    ds_read_b64_tr_b16 v[74:75], v4 offset:1280
    s_waitcnt lgkmcnt(7)
    v_mfma_f32_32x32x16_bf16 v[112:127], v[76:79], v[64:67], 0
    v_dot2_f32_bf16 v91, v76, s54, v91
    v_dot2_f32_bf16 v91, v77, s54, v91
    v_dot2_f32_bf16 v91, v78, s54, v91
    v_dot2_f32_bf16 v91, v79, s54, v91
    s_add_u32 m0, s33, 7168
    s_nop 0
    buffer_load_dwordx4 v14, s[4:7], s31 offen lds
    ds_read_b64_tr_b16 v[76:77], v4 offset:21504
    ds_read_b64_tr_b16 v[78:79], v4 offset:21760
    s_waitcnt lgkmcnt(7)
    v_mfma_f32_32x32x16_bf16 v[128:143], v[80:83], v[64:67], 0
    s_add_u32 m0, s62, 6144
    s_nop 0
    buffer_load_dwordx4 v15, s[8:11], s58 offen lds
    ds_read_b64_tr_b16 v[80:81], v5 offset:1024
    ds_read_b64_tr_b16 v[82:83], v5 offset:1280
    s_waitcnt lgkmcnt(7)
    v_mfma_f32_32x32x16_bf16 v[144:159], v[84:87], v[64:67], 0
    s_add_u32 s30, s30, 64
    s_add_u32 s31, s31, 64
    s_add_u32 s58, s58, 88064
    ds_read_b64_tr_b16 v[84:85], v5 offset:21504
    ds_read_b64_tr_b16 v[86:87], v5 offset:21760
    s_waitcnt lgkmcnt(6)
    v_mfma_f32_32x32x16_bf16 v[96:111], v[72:75], v[68:71], v[96:111]
    v_dot2_f32_bf16 v88, v68, s54, v88
    v_dot2_f32_bf16 v89, v68, v68, v89
    v_dot2_f32_bf16 v88, v69, s54, v88
    v_dot2_f32_bf16 v89, v69, v69, v89
    v_dot2_f32_bf16 v88, v70, s54, v88
    v_dot2_f32_bf16 v89, v70, v70, v89
    v_dot2_f32_bf16 v88, v71, s54, v88
    v_dot2_f32_bf16 v89, v71, v71, v89
    v_dot2_f32_bf16 v90, v72, s54, v90
    v_dot2_f32_bf16 v90, v73, s54, v90
    v_dot2_f32_bf16 v90, v74, s54, v90
    v_dot2_f32_bf16 v90, v75, s54, v90
    s_waitcnt vmcnt(6)
    s_barrier
    ds_read_b128 v[64:67], v2 offset:2048
    ds_read_b64_tr_b16 v[72:73], v4 offset:2048
    ds_read_b64_tr_b16 v[74:75], v4 offset:2304
    s_waitcnt lgkmcnt(7)
    v_mfma_f32_32x32x16_bf16 v[112:127], v[76:79], v[68:71], v[112:127]
    v_dot2_f32_bf16 v91, v76, s54, v91
    v_dot2_f32_bf16 v91, v77, s54, v91
    v_dot2_f32_bf16 v91, v78, s54, v91
    v_dot2_f32_bf16 v91, v79, s54, v91
    s_add_u32 m0, s33, 8192
    s_nop 0
    buffer_load_dwordx4 v14, s[4:7], s30 offen lds
    ds_read_b64_tr_b16 v[76:77], v4 offset:22528
    ds_read_b64_tr_b16 v[78:79], v4 offset:22784
    s_waitcnt lgkmcnt(7)
    v_mfma_f32_32x32x16_bf16 v[128:143], v[80:83], v[68:71], v[128:143]
    s_add_u32 m0, s33, 9216
    s_nop 0
    buffer_load_dwordx4 v14, s[4:7], s31 offen lds
    ds_read_b64_tr_b16 v[80:81], v5 offset:2048
    ds_read_b64_tr_b16 v[82:83], v5 offset:2304
    s_waitcnt lgkmcnt(7)
    v_mfma_f32_32x32x16_bf16 v[144:159], v[84:87], v[68:71], v[144:159]
    s_add_u32 m0, s62, 8192
    s_nop 0
    buffer_load_dwordx4 v15, s[8:11], s58 offen lds
    ds_read_b64_tr_b16 v[84:85], v5 offset:22528
    ds_read_b64_tr_b16 v[86:87], v5 offset:22784
    s_waitcnt lgkmcnt(6)
    v_mfma_f32_32x32x16_bf16 v[96:111], v[72:75], v[64:67], v[96:111]
    v_dot2_f32_bf16 v88, v64, s54, v88
    v_dot2_f32_bf16 v89, v64, v64, v89
    v_dot2_f32_bf16 v88, v65, s54, v88
    v_dot2_f32_bf16 v89, v65, v65, v89
    v_dot2_f32_bf16 v88, v66, s54, v88
    v_dot2_f32_bf16 v89, v66, v66, v89
    v_dot2_f32_bf16 v88, v67, s54, v88
    v_dot2_f32_bf16 v89, v67, v67, v89
    v_dot2_f32_bf16 v90, v72, s54, v90
    v_dot2_f32_bf16 v90, v73, s54, v90
    v_dot2_f32_bf16 v90, v74, s54, v90
    v_dot2_f32_bf16 v90, v75, s54, v90
    s_add_u32 s30, s30, 64
    s_add_u32 s31, s31, 64
    s_add_u32 s58, s58, 88064
    ds_read_b128 v[68:71], v3 offset:2048
    ds_read_b64_tr_b16 v[72:73], v4 offset:3072
    ds_read_b64_tr_b16 v[74:75], v4 offset:3328
    s_waitcnt lgkmcnt(7)
    v_mfma_f32_32x32x16_bf16 v[112:127], v[76:79], v[64:67], v[112:127]
    v_dot2_f32_bf16 v91, v76, s54, v91
    v_dot2_f32_bf16 v91, v77, s54, v91
    v_dot2_f32_bf16 v91, v78, s54, v91
    v_dot2_f32_bf16 v91, v79, s54, v91
    ds_read_b64_tr_b16 v[76:77], v4 offset:23552
    ds_read_b64_tr_b16 v[78:79], v4 offset:23808
    s_waitcnt lgkmcnt(7)
    v_mfma_f32_32x32x16_bf16 v[128:143], v[80:83], v[64:67], v[128:143]
    ds_read_b64_tr_b16 v[80:81], v5 offset:3072
    ds_read_b64_tr_b16 v[82:83], v5 offset:3328
    s_waitcnt lgkmcnt(7)
    v_mfma_f32_32x32x16_bf16 v[144:159], v[84:87], v[64:67], v[144:159]
    ds_read_b64_tr_b16 v[84:85], v5 offset:23552
    ds_read_b64_tr_b16 v[86:87], v5 offset:23808
    s_waitcnt lgkmcnt(6)
    v_mfma_f32_32x32x16_bf16 v[96:111], v[72:75], v[68:71], v[96:111]
    v_dot2_f32_bf16 v88, v68, s54, v88
    v_dot2_f32_bf16 v89, v68, v68, v89
    v_dot2_f32_bf16 v88, v69, s54, v88
    v_dot2_f32_bf16 v89, v69, v69, v89
    v_dot2_f32_bf16 v88, v70, s54, v88
    v_dot2_f32_bf16 v89, v70, v70, v89
    v_dot2_f32_bf16 v88, v71, s54, v88
    v_dot2_f32_bf16 v89, v71, v71, v89
    v_dot2_f32_bf16 v90, v72, s54, v90
    v_dot2_f32_bf16 v90, v73, s54, v90
    v_dot2_f32_bf16 v90, v74, s54, v90
    v_dot2_f32_bf16 v90, v75, s54, v90
    s_waitcnt vmcnt(6)
    s_barrier
    ds_read_b128 v[64:67], v2 offset:4096
    ds_read_b64_tr_b16 v[72:73], v4 offset:4096
    ds_read_b64_tr_b16 v[74:75], v4 offset:4352
    s_waitcnt lgkmcnt(7)
    v_mfma_f32_32x32x16_bf16 v[112:127], v[76:79], v[68:71], v[112:127]
    v_dot2_f32_bf16 v91, v76, s54, v91
    v_dot2_f32_bf16 v91, v77, s54, v91
    v_dot2_f32_bf16 v91, v78, s54, v91
    v_dot2_f32_bf16 v91, v79, s54, v91
    s_add_u32 m0, s33, 0
    s_nop 0
    buffer_load_dwordx4 v14, s[4:7], s30 offen lds
    ds_read_b64_tr_b16 v[76:77], v4 offset:24576
    ds_read_b64_tr_b16 v[78:79], v4 offset:24832
    s_waitcnt lgkmcnt(7)
    v_mfma_f32_32x32x16_bf16 v[128:143], v[80:83], v[68:71], v[128:143]
    s_add_u32 m0, s33, 1024
    s_nop 0
    buffer_load_dwordx4 v14, s[4:7], s31 offen lds
    ds_read_b64_tr_b16 v[80:81], v5 offset:4096
    ds_read_b64_tr_b16 v[82:83], v5 offset:4352
    s_waitcnt lgkmcnt(7)
    v_mfma_f32_32x32x16_bf16 v[144:159], v[84:87], v[68:71], v[144:159]
    s_add_u32 m0, s62, 0
    s_nop 0
    buffer_load_dwordx4 v15, s[8:11], s58 offen lds
    ds_read_b64_tr_b16 v[84:85], v5 offset:24576
    ds_read_b64_tr_b16 v[86:87], v5 offset:24832
    s_waitcnt lgkmcnt(6)
    v_mfma_f32_32x32x16_bf16 v[96:111], v[72:75], v[64:67], v[96:111]
    v_dot2_f32_bf16 v88, v64, s54, v88
    v_dot2_f32_bf16 v89, v64, v64, v89
    v_dot2_f32_bf16 v88, v65, s54, v88
    v_dot2_f32_bf16 v89, v65, v65, v89
    v_dot2_f32_bf16 v88, v66, s54, v88
    v_dot2_f32_bf16 v89, v66, v66, v89
    v_dot2_f32_bf16 v88, v67, s54, v88
    v_dot2_f32_bf16 v89, v67, v67, v89
    v_dot2_f32_bf16 v90, v72, s54, v90
    v_dot2_f32_bf16 v90, v73, s54, v90
    v_dot2_f32_bf16 v90, v74, s54, v90
    v_dot2_f32_bf16 v90, v75, s54, v90
    s_add_u32 s30, s30, 64
    s_add_u32 s31, s31, 64
    s_add_u32 s58, s58, 88064
    ds_read_b128 v[68:71], v3 offset:4096
    ds_read_b64_tr_b16 v[72:73], v4 offset:5120
    ds_read_b64_tr_b16 v[74:75], v4 offset:5376
    s_waitcnt lgkmcnt(7)
    v_mfma_f32_32x32x16_bf16 v[112:127], v[76:79], v[64:67], v[112:127]
    v_dot2_f32_bf16 v91, v76, s54, v91
    v_dot2_f32_bf16 v91, v77, s54, v91
    v_dot2_f32_bf16 v91, v78, s54, v91
    v_dot2_f32_bf16 v91, v79, s54, v91
    ds_read_b64_tr_b16 v[76:77], v4 offset:25600
    ds_read_b64_tr_b16 v[78:79], v4 offset:25856
    s_waitcnt lgkmcnt(7)
    v_mfma_f32_32x32x16_bf16 v[128:143], v[80:83], v[64:67], v[128:143]
    ds_read_b64_tr_b16 v[80:81], v5 offset:5120
    ds_read_b64_tr_b16 v[82:83], v5 offset:5376
    s_waitcnt lgkmcnt(7)
    v_mfma_f32_32x32x16_bf16 v[144:159], v[84:87], v[64:67], v[144:159]
    ds_read_b64_tr_b16 v[84:85], v5 offset:25600
    ds_read_b64_tr_b16 v[86:87], v5 offset:25856
    s_waitcnt lgkmcnt(6)
    v_mfma_f32_32x32x16_bf16 v[96:111], v[72:75], v[68:71], v[96:111]
    v_dot2_f32_bf16 v88, v68, s54, v88
    v_dot2_f32_bf16 v89, v68, v68, v89
    v_dot2_f32_bf16 v88, v69, s54, v88
    v_dot2_f32_bf16 v89, v69, v69, v89
    v_dot2_f32_bf16 v88, v70, s54, v88
    v_dot2_f32_bf16 v89, v70, v70, v89
    v_dot2_f32_bf16 v88, v71, s54, v88
    v_dot2_f32_bf16 v89, v71, v71, v89
    v_dot2_f32_bf16 v90, v72, s54, v90
    v_dot2_f32_bf16 v90, v73, s54, v90
    v_dot2_f32_bf16 v90, v74, s54, v90
    v_dot2_f32_bf16 v90, v75, s54, v90
    s_waitcnt vmcnt(6)
    s_barrier
    ds_read_b128 v[64:67], v2 offset:6144
    ds_read_b64_tr_b16 v[72:73], v4 offset:6144
    ds_read_b64_tr_b16 v[74:75], v4 offset:6400
    s_waitcnt lgkmcnt(7)
    v_mfma_f32_32x32x16_bf16 v[112:127], v[76:79], v[68:71], v[112:127]
    v_dot2_f32_bf16 v91, v76, s54, v91
    v_dot2_f32_bf16 v91, v77, s54, v91
    v_dot2_f32_bf16 v91, v78, s54, v91
    v_dot2_f32_bf16 v91, v79, s54, v91
    s_add_u32 m0, s33, 2048
    s_nop 0
    buffer_load_dwordx4 v14, s[4:7], s30 offen lds
    ds_read_b64_tr_b16 v[76:77], v4 offset:26624
    ds_read_b64_tr_b16 v[78:79], v4 offset:26880
    s_waitcnt lgkmcnt(7)
    v_mfma_f32_32x32x16_bf16 v[128:143], v[80:83], v[68:71], v[128:143]
    s_add_u32 m0, s33, 3072
    s_nop 0
    buffer_load_dwordx4 v14, s[4:7], s31 offen lds
    ds_read_b64_tr_b16 v[80:81], v5 offset:6144
    ds_read_b64_tr_b16 v[82:83], v5 offset:6400
    s_waitcnt lgkmcnt(7)
    v_mfma_f32_32x32x16_bf16 v[144:159], v[84:87], v[68:71], v[144:159]
    s_add_u32 m0, s62, 2048
    s_nop 0
    buffer_load_dwordx4 v15, s[8:11], s58 offen lds
    ds_read_b64_tr_b16 v[84:85], v5 offset:26624
    ds_read_b64_tr_b16 v[86:87], v5 offset:26880
    s_waitcnt lgkmcnt(6)
    v_mfma_f32_32x32x16_bf16 v[96:111], v[72:75], v[64:67], v[96:111]
    v_dot2_f32_bf16 v88, v64, s54, v88
    v_dot2_f32_bf16 v89, v64, v64, v89
    v_dot2_f32_bf16 v88, v65, s54, v88
    v_dot2_f32_bf16 v89, v65, v65, v89
    v_dot2_f32_bf16 v88, v66, s54, v88
    v_dot2_f32_bf16 v89, v66, v66, v89
    v_dot2_f32_bf16 v88, v67, s54, v88
    v_dot2_f32_bf16 v89, v67, v67, v89
    v_dot2_f32_bf16 v90, v72, s54, v90
    v_dot2_f32_bf16 v90, v73, s54, v90
    v_dot2_f32_bf16 v90, v74, s54, v90
    v_dot2_f32_bf16 v90, v75, s54, v90
    s_add_u32 s30, s30, 64
    s_add_u32 s31, s31, 64
    s_add_u32 s58, s58, 88064
    ds_read_b128 v[68:71], v3 offset:6144
    ds_read_b64_tr_b16 v[72:73], v4 offset:7168
    ds_read_b64_tr_b16 v[74:75], v4 offset:7424
    s_waitcnt lgkmcnt(7)
    v_mfma_f32_32x32x16_bf16 v[112:127], v[76:79], v[64:67], v[112:127]
    v_dot2_f32_bf16 v91, v76, s54, v91
    v_dot2_f32_bf16 v91, v77, s54, v91
    v_dot2_f32_bf16 v91, v78, s54, v91
    v_dot2_f32_bf16 v91, v79, s54, v91
    ds_read_b64_tr_b16 v[76:77], v4 offset:27648
    ds_read_b64_tr_b16 v[78:79], v4 offset:27904
    s_waitcnt lgkmcnt(7)
    v_mfma_f32_32x32x16_bf16 v[128:143], v[80:83], v[64:67], v[128:143]
    ds_read_b64_tr_b16 v[80:81], v5 offset:7168
    ds_read_b64_tr_b16 v[82:83], v5 offset:7424
    s_waitcnt lgkmcnt(7)
    v_mfma_f32_32x32x16_bf16 v[144:159], v[84:87], v[64:67], v[144:159]
    ds_read_b64_tr_b16 v[84:85], v5 offset:27648
    ds_read_b64_tr_b16 v[86:87], v5 offset:27904
    s_waitcnt lgkmcnt(6)
    v_mfma_f32_32x32x16_bf16 v[96:111], v[72:75], v[68:71], v[96:111]
    v_dot2_f32_bf16 v88, v68, s54, v88
    v_dot2_f32_bf16 v89, v68, v68, v89
    v_dot2_f32_bf16 v88, v69, s54, v88
    v_dot2_f32_bf16 v89, v69, v69, v89
    v_dot2_f32_bf16 v88, v70, s54, v88
    v_dot2_f32_bf16 v89, v70, v70, v89
    v_dot2_f32_bf16 v88, v71, s54, v88
    v_dot2_f32_bf16 v89, v71, v71, v89
    v_dot2_f32_bf16 v90, v72, s54, v90
    v_dot2_f32_bf16 v90, v73, s54, v90
    v_dot2_f32_bf16 v90, v74, s54, v90
    v_dot2_f32_bf16 v90, v75, s54, v90
    s_waitcnt vmcnt(6)
    s_barrier
    ds_read_b128 v[64:67], v2 offset:8192
    ds_read_b64_tr_b16 v[72:73], v4 offset:8192
    ds_read_b64_tr_b16 v[74:75], v4 offset:8448
    s_waitcnt lgkmcnt(7)
    v_mfma_f32_32x32x16_bf16 v[112:127], v[76:79], v[68:71], v[112:127]
    v_dot2_f32_bf16 v91, v76, s54, v91
    v_dot2_f32_bf16 v91, v77, s54, v91
    v_dot2_f32_bf16 v91, v78, s54, v91
    v_dot2_f32_bf16 v91, v79, s54, v91
    s_add_u32 m0, s33, 4096
    s_nop 0
    buffer_load_dwordx4 v14, s[4:7], s30 offen lds
    ds_read_b64_tr_b16 v[76:77], v4 offset:28672
    ds_read_b64_tr_b16 v[78:79], v4 offset:28928
    s_waitcnt lgkmcnt(7)
    v_mfma_f32_32x32x16_bf16 v[128:143], v[80:83], v[68:71], v[128:143]
    s_add_u32 m0, s33, 5120
    s_nop 0
    buffer_load_dwordx4 v14, s[4:7], s31 offen lds
    ds_read_b64_tr_b16 v[80:81], v5 offset:8192
    ds_read_b64_tr_b16 v[82:83], v5 offset:8448
    s_waitcnt lgkmcnt(7)
    v_mfma_f32_32x32x16_bf16 v[144:159], v[84:87], v[68:71], v[144:159]
    s_add_u32 m0, s62, 4096
    s_nop 0
    buffer_load_dwordx4 v15, s[8:11], s58 offen lds
    ds_read_b64_tr_b16 v[84:85], v5 offset:28672
    ds_read_b64_tr_b16 v[86:87], v5 offset:28928
    s_waitcnt lgkmcnt(6)
    v_mfma_f32_32x32x16_bf16 v[96:111], v[72:75], v[64:67], v[96:111]
    v_dot2_f32_bf16 v88, v64, s54, v88
    v_dot2_f32_bf16 v89, v64, v64, v89
    v_dot2_f32_bf16 v88, v65, s54, v88
    v_dot2_f32_bf16 v89, v65, v65, v89
    v_dot2_f32_bf16 v88, v66, s54, v88
    v_dot2_f32_bf16 v89, v66, v66, v89
    v_dot2_f32_bf16 v88, v67, s54, v88
    v_dot2_f32_bf16 v89, v67, v67, v89
    v_dot2_f32_bf16 v90, v72, s54, v90
    v_dot2_f32_bf16 v90, v73, s54, v90
    v_dot2_f32_bf16 v90, v74, s54, v90
    v_dot2_f32_bf16 v90, v75, s54, v90
    s_add_u32 s30, s30, 64
    s_add_u32 s31, s31, 64
    s_add_u32 s58, s58, 88064
    ds_read_b128 v[68:71], v3 offset:8192
    ds_read_b64_tr_b16 v[72:73], v4 offset:9216
    ds_read_b64_tr_b16 v[74:75], v4 offset:9472
    s_waitcnt lgkmcnt(7)
    v_mfma_f32_32x32x16_bf16 v[112:127], v[76:79], v[64:67], v[112:127]
    v_dot2_f32_bf16 v91, v76, s54, v91
    v_dot2_f32_bf16 v91, v77, s54, v91
    v_dot2_f32_bf16 v91, v78, s54, v91
    v_dot2_f32_bf16 v91, v79, s54, v91
    ds_read_b64_tr_b16 v[76:77], v4 offset:29696
    ds_read_b64_tr_b16 v[78:79], v4 offset:29952
    s_waitcnt lgkmcnt(7)
    v_mfma_f32_32x32x16_bf16 v[128:143], v[80:83], v[64:67], v[128:143]
    ds_read_b64_tr_b16 v[80:81], v5 offset:9216
    ds_read_b64_tr_b16 v[82:83], v5 offset:9472
    s_waitcnt lgkmcnt(7)
    v_mfma_f32_32x32x16_bf16 v[144:159], v[84:87], v[64:67], v[144:159]
    ds_read_b64_tr_b16 v[84:85], v5 offset:29696
    ds_read_b64_tr_b16 v[86:87], v5 offset:29952
    s_waitcnt lgkmcnt(6)
    v_mfma_f32_32x32x16_bf16 v[96:111], v[72:75], v[68:71], v[96:111]
    v_dot2_f32_bf16 v88, v68, s54, v88
    v_dot2_f32_bf16 v89, v68, v68, v89
    v_dot2_f32_bf16 v88, v69, s54, v88
    v_dot2_f32_bf16 v89, v69, v69, v89
    v_dot2_f32_bf16 v88, v70, s54, v88
    v_dot2_f32_bf16 v89, v70, v70, v89
    v_dot2_f32_bf16 v88, v71, s54, v88
    v_dot2_f32_bf16 v89, v71, v71, v89
    v_dot2_f32_bf16 v90, v72, s54, v90
    v_dot2_f32_bf16 v90, v73, s54, v90
    v_dot2_f32_bf16 v90, v74, s54, v90
    v_dot2_f32_bf16 v90, v75, s54, v90
    s_waitcnt vmcnt(6)
    s_barrier
    ds_read_b128 v[64:67], v2 offset:0
    ds_read_b64_tr_b16 v[72:73], v4 offset:0
    ds_read_b64_tr_b16 v[74:75], v4 offset:256
    s_waitcnt lgkmcnt(7)
    v_mfma_f32_32x32x16_bf16 v[112:127], v[76:79], v[68:71], v[112:127]
    v_dot2_f32_bf16 v91, v76, s54, v91
    v_dot2_f32_bf16 v91, v77, s54, v91
    v_dot2_f32_bf16 v91, v78, s54, v91
    v_dot2_f32_bf16 v91, v79, s54, v91
    s_add_u32 m0, s33, 6144
    s_nop 0
    buffer_load_dwordx4 v14, s[4:7], s30 offen lds
    ds_read_b64_tr_b16 v[76:77], v4 offset:20480
    ds_read_b64_tr_b16 v[78:79], v4 offset:20736
    s_waitcnt lgkmcnt(7)
    v_mfma_f32_32x32x16_bf16 v[128:143], v[80:83], v[68:71], v[128:143]
    s_add_u32 m0, s33, 7168
    s_nop 0
    buffer_load_dwordx4 v14, s[4:7], s31 offen lds
    ds_read_b64_tr_b16 v[80:81], v5 offset:0
    ds_read_b64_tr_b16 v[82:83], v5 offset:256
    s_waitcnt lgkmcnt(7)
    v_mfma_f32_32x32x16_bf16 v[144:159], v[84:87], v[68:71], v[144:159]
    s_add_u32 m0, s62, 6144
    s_nop 0
    buffer_load_dwordx4 v15, s[8:11], s58 offen lds
    ds_read_b64_tr_b16 v[84:85], v5 offset:20480
    ds_read_b64_tr_b16 v[86:87], v5 offset:20736
    s_waitcnt lgkmcnt(6)
    v_mfma_f32_32x32x16_bf16 v[96:111], v[72:75], v[64:67], v[96:111]
    v_dot2_f32_bf16 v88, v64, s54, v88
    v_dot2_f32_bf16 v89, v64, v64, v89
    v_dot2_f32_bf16 v88, v65, s54, v88
    v_dot2_f32_bf16 v89, v65, v65, v89
    v_dot2_f32_bf16 v88, v66, s54, v88
    v_dot2_f32_bf16 v89, v66, v66, v89
    v_dot2_f32_bf16 v88, v67, s54, v88
    v_dot2_f32_bf16 v89, v67, v67, v89
    v_dot2_f32_bf16 v90, v72, s54, v90
    v_dot2_f32_bf16 v90, v73, s54, v90
    v_dot2_f32_bf16 v90, v74, s54, v90
    v_dot2_f32_bf16 v90, v75, s54, v90
    s_add_u32 s30, s30, 64
    s_add_u32 s31, s31, 64
    s_add_u32 s58, s58, 88064
    ds_read_b128 v[68:71], v3 offset:0
    ds_read_b64_tr_b16 v[72:73], v4 offset:1024
    ds_read_b64_tr_b16 v[74:75], v4 offset:1280
    s_waitcnt lgkmcnt(7)
    v_mfma_f32_32x32x16_bf16 v[112:127], v[76:79], v[64:67], v[112:127]
    v_dot2_f32_bf16 v91, v76, s54, v91
    v_dot2_f32_bf16 v91, v77, s54, v91
    v_dot2_f32_bf16 v91, v78, s54, v91
    v_dot2_f32_bf16 v91, v79, s54, v91
    ds_read_b64_tr_b16 v[76:77], v4 offset:21504
    ds_read_b64_tr_b16 v[78:79], v4 offset:21760
    s_waitcnt lgkmcnt(7)
    v_mfma_f32_32x32x16_bf16 v[128:143], v[80:83], v[64:67], v[128:143]
    ds_read_b64_tr_b16 v[80:81], v5 offset:1024
    ds_read_b64_tr_b16 v[82:83], v5 offset:1280
    s_waitcnt lgkmcnt(7)
    v_mfma_f32_32x32x16_bf16 v[144:159], v[84:87], v[64:67], v[144:159]
    ds_read_b64_tr_b16 v[84:85], v5 offset:21504
    ds_read_b64_tr_b16 v[86:87], v5 offset:21760
    s_waitcnt lgkmcnt(6)
    v_mfma_f32_32x32x16_bf16 v[96:111], v[72:75], v[68:71], v[96:111]
    v_dot2_f32_bf16 v88, v68, s54, v88
    v_dot2_f32_bf16 v89, v68, v68, v89
    v_dot2_f32_bf16 v88, v69, s54, v88
    v_dot2_f32_bf16 v89, v69, v69, v89
    v_dot2_f32_bf16 v88, v70, s54, v88
    v_dot2_f32_bf16 v89, v70, v70, v89
    v_dot2_f32_bf16 v88, v71, s54, v88
    v_dot2_f32_bf16 v89, v71, v71, v89
    v_dot2_f32_bf16 v90, v72, s54, v90
    v_dot2_f32_bf16 v90, v73, s54, v90
    v_dot2_f32_bf16 v90, v74, s54, v90
    v_dot2_f32_bf16 v90, v75, s54, v90
    s_waitcnt vmcnt(6)
    s_barrier
    ds_read_b128 v[64:67], v2 offset:2048
    ds_read_b64_tr_b16 v[72:73], v4 offset:2048
    ds_read_b64_tr_b16 v[74:75], v4 offset:2304
    s_waitcnt lgkmcnt(7)
    v_mfma_f32_32x32x16_bf16 v[112:127], v[76:79], v[68:71], v[112:127]
    v_dot2_f32_bf16 v91, v76, s54, v91
    v_dot2_f32_bf16 v91, v77, s54, v91
    v_dot2_f32_bf16 v91, v78, s54, v91
    v_dot2_f32_bf16 v91, v79, s54, v91
    s_add_u32 m0, s33, 8192
    s_nop 0
    buffer_load_dwordx4 v14, s[4:7], s30 offen lds
    ds_read_b64_tr_b16 v[76:77], v4 offset:22528
    ds_read_b64_tr_b16 v[78:79], v4 offset:22784
    s_waitcnt lgkmcnt(7)
    v_mfma_f32_32x32x16_bf16 v[128:143], v[80:83], v[68:71], v[128:143]
    s_add_u32 m0, s33, 9216
    s_nop 0
    buffer_load_dwordx4 v14, s[4:7], s31 offen lds
    ds_read_b64_tr_b16 v[80:81], v5 offset:2048
    ds_read_b64_tr_b16 v[82:83], v5 offset:2304
    s_waitcnt lgkmcnt(7)
    v_mfma_f32_32x32x16_bf16 v[144:159], v[84:87], v[68:71], v[144:159]
    s_add_u32 m0, s62, 8192
    s_nop 0
    buffer_load_dwordx4 v15, s[8:11], s58 offen lds
    ds_read_b64_tr_b16 v[84:85], v5 offset:22528
    ds_read_b64_tr_b16 v[86:87], v5 offset:22784
    s_waitcnt lgkmcnt(6)
    v_mfma_f32_32x32x16_bf16 v[96:111], v[72:75], v[64:67], v[96:111]
    v_dot2_f32_bf16 v88, v64, s54, v88
    v_dot2_f32_bf16 v89, v64, v64, v89
    v_dot2_f32_bf16 v88, v65, s54, v88
    v_dot2_f32_bf16 v89, v65, v65, v89
    v_dot2_f32_bf16 v88, v66, s54, v88
    v_dot2_f32_bf16 v89, v66, v66, v89
    v_dot2_f32_bf16 v88, v67, s54, v88
    v_dot2_f32_bf16 v89, v67, v67, v89
    v_dot2_f32_bf16 v90, v72, s54, v90
    v_dot2_f32_bf16 v90, v73, s54, v90
    v_dot2_f32_bf16 v90, v74, s54, v90
    v_dot2_f32_bf16 v90, v75, s54, v90
    s_add_u32 s30, s30, 64
    s_add_u32 s31, s31, 64
    s_add_u32 s58, s58, 88064
    ds_read_b128 v[68:71], v3 offset:2048
    ds_read_b64_tr_b16 v[72:73], v4 offset:3072
    ds_read_b64_tr_b16 v[74:75], v4 offset:3328
    s_waitcnt lgkmcnt(7)
    v_mfma_f32_32x32x16_bf16 v[112:127], v[76:79], v[64:67], v[112:127]
    v_dot2_f32_bf16 v91, v76, s54, v91
    v_dot2_f32_bf16 v91, v77, s54, v91
    v_dot2_f32_bf16 v91, v78, s54, v91
    v_dot2_f32_bf16 v91, v79, s54, v91
    ds_read_b64_tr_b16 v[76:77], v4 offset:23552
    ds_read_b64_tr_b16 v[78:79], v4 offset:23808
    s_waitcnt lgkmcnt(7)
    v_mfma_f32_32x32x16_bf16 v[128:143], v[80:83], v[64:67], v[128:143]
    ds_read_b64_tr_b16 v[80:81], v5 offset:3072
    ds_read_b64_tr_b16 v[82:83], v5 offset:3328
    s_waitcnt lgkmcnt(7)
    v_mfma_f32_32x32x16_bf16 v[144:159], v[84:87], v[64:67], v[144:159]
    ds_read_b64_tr_b16 v[84:85], v5 offset:23552
    ds_read_b64_tr_b16 v[86:87], v5 offset:23808
    s_waitcnt lgkmcnt(6)
    v_mfma_f32_32x32x16_bf16 v[96:111], v[72:75], v[68:71], v[96:111]
    v_dot2_f32_bf16 v88, v68, s54, v88
    v_dot2_f32_bf16 v89, v68, v68, v89
    v_dot2_f32_bf16 v88, v69, s54, v88
    v_dot2_f32_bf16 v89, v69, v69, v89
    v_dot2_f32_bf16 v88, v70, s54, v88
    v_dot2_f32_bf16 v89, v70, v70, v89
    v_dot2_f32_bf16 v88, v71, s54, v88
    v_dot2_f32_bf16 v89, v71, v71, v89
    v_dot2_f32_bf16 v90, v72, s54, v90
    v_dot2_f32_bf16 v90, v73, s54, v90
    v_dot2_f32_bf16 v90, v74, s54, v90
    v_dot2_f32_bf16 v90, v75, s54, v90
    s_waitcnt vmcnt(6)
    s_barrier
    ds_read_b128 v[64:67], v2 offset:4096
    ds_read_b64_tr_b16 v[72:73], v4 offset:4096
    ds_read_b64_tr_b16 v[74:75], v4 offset:4352
    s_waitcnt lgkmcnt(7)
    v_mfma_f32_32x32x16_bf16 v[112:127], v[76:79], v[68:71], v[112:127]
    v_dot2_f32_bf16 v91, v76, s54, v91
    v_dot2_f32_bf16 v91, v77, s54, v91
    v_dot2_f32_bf16 v91, v78, s54, v91
    v_dot2_f32_bf16 v91, v79, s54, v91
    s_add_u32 m0, s33, 0
    s_nop 0
    buffer_load_dwordx4 v14, s[4:7], s30 offen lds
    ds_read_b64_tr_b16 v[76:77], v4 offset:24576
    ds_read_b64_tr_b16 v[78:79], v4 offset:24832
    s_waitcnt lgkmcnt(7)
    v_mfma_f32_32x32x16_bf16 v[128:143], v[80:83], v[68:71], v[128:143]
    s_add_u32 m0, s33, 1024
    s_nop 0
    buffer_load_dwordx4 v14, s[4:7], s31 offen lds
    ds_read_b64_tr_b16 v[80:81], v5 offset:4096
    ds_read_b64_tr_b16 v[82:83], v5 offset:4352
    s_waitcnt lgkmcnt(7)
    v_mfma_f32_32x32x16_bf16 v[144:159], v[84:87], v[68:71], v[144:159]
    s_add_u32 m0, s62, 0
    s_nop 0
    buffer_load_dwordx4 v15, s[8:11], s58 offen lds
    ds_read_b64_tr_b16 v[84:85], v5 offset:24576
    ds_read_b64_tr_b16 v[86:87], v5 offset:24832
    s_waitcnt lgkmcnt(6)
    v_mfma_f32_32x32x16_bf16 v[96:111], v[72:75], v[64:67], v[96:111]
    v_dot2_f32_bf16 v88, v64, s54, v88
    v_dot2_f32_bf16 v89, v64, v64, v89
    v_dot2_f32_bf16 v88, v65, s54, v88
    v_dot2_f32_bf16 v89, v65, v65, v89
    v_dot2_f32_bf16 v88, v66, s54, v88
    v_dot2_f32_bf16 v89, v66, v66, v89
    v_dot2_f32_bf16 v88, v67, s54, v88
    v_dot2_f32_bf16 v89, v67, v67, v89
    v_dot2_f32_bf16 v90, v72, s54, v90
    v_dot2_f32_bf16 v90, v73, s54, v90
    v_dot2_f32_bf16 v90, v74, s54, v90
    v_dot2_f32_bf16 v90, v75, s54, v90
    s_add_u32 s30, s30, 64
    s_add_u32 s31, s31, 64
    s_add_u32 s58, s58, 88064
    ds_read_b128 v[68:71], v3 offset:4096
    ds_read_b64_tr_b16 v[72:73], v4 offset:5120
    ds_read_b64_tr_b16 v[74:75], v4 offset:5376
    s_waitcnt lgkmcnt(7)
    v_mfma_f32_32x32x16_bf16 v[112:127], v[76:79], v[64:67], v[112:127]
    v_dot2_f32_bf16 v91, v76, s54, v91
    v_dot2_f32_bf16 v91, v77, s54, v91
    v_dot2_f32_bf16 v91, v78, s54, v91
    v_dot2_f32_bf16 v91, v79, s54, v91
    ds_read_b64_tr_b16 v[76:77], v4 offset:25600
    ds_read_b64_tr_b16 v[78:79], v4 offset:25856
    s_waitcnt lgkmcnt(7)
    v_mfma_f32_32x32x16_bf16 v[128:143], v[80:83], v[64:67], v[128:143]
    ds_read_b64_tr_b16 v[80:81], v5 offset:5120
    ds_read_b64_tr_b16 v[82:83], v5 offset:5376
    s_waitcnt lgkmcnt(7)
    v_mfma_f32_32x32x16_bf16 v[144:159], v[84:87], v[64:67], v[144:159]
    ds_read_b64_tr_b16 v[84:85], v5 offset:25600
    ds_read_b64_tr_b16 v[86:87], v5 offset:25856
    s_waitcnt lgkmcnt(6)
    v_mfma_f32_32x32x16_bf16 v[96:111], v[72:75], v[68:71], v[96:111]
    v_dot2_f32_bf16 v88, v68, s54, v88
    v_dot2_f32_bf16 v89, v68, v68, v89
    v_dot2_f32_bf16 v88, v69, s54, v88
    v_dot2_f32_bf16 v89, v69, v69, v89
    v_dot2_f32_bf16 v88, v70, s54, v88
    v_dot2_f32_bf16 v89, v70, v70, v89
    v_dot2_f32_bf16 v88, v71, s54, v88
    v_dot2_f32_bf16 v89, v71, v71, v89
    v_dot2_f32_bf16 v90, v72, s54, v90
    v_dot2_f32_bf16 v90, v73, s54, v90
    v_dot2_f32_bf16 v90, v74, s54, v90
    v_dot2_f32_bf16 v90, v75, s54, v90
    s_waitcnt vmcnt(6)
    s_barrier
    ds_read_b128 v[64:67], v2 offset:6144
    ds_read_b64_tr_b16 v[72:73], v4 offset:6144
    ds_read_b64_tr_b16 v[74:75], v4 offset:6400
    s_waitcnt lgkmcnt(7)
    v_mfma_f32_32x32x16_bf16 v[112:127], v[76:79], v[68:71], v[112:127]
    v_dot2_f32_bf16 v91, v76, s54, v91
    v_dot2_f32_bf16 v91, v77, s54, v91
    v_dot2_f32_bf16 v91, v78, s54, v91
    v_dot2_f32_bf16 v91, v79, s54, v91
    s_add_u32 m0, s33, 2048
    s_nop 0
    buffer_load_dwordx4 v14, s[4:7], s30 offen lds
    ds_read_b64_tr_b16 v[76:77], v4 offset:26624
    ds_read_b64_tr_b16 v[78:79], v4 offset:26880
    s_waitcnt lgkmcnt(7)
    v_mfma_f32_32x32x16_bf16 v[128:143], v[80:83], v[68:71], v[128:143]
    s_add_u32 m0, s33, 3072
    s_nop 0
    buffer_load_dwordx4 v14, s[4:7], s31 offen lds
    ds_read_b64_tr_b16 v[80:81], v5 offset:6144
    ds_read_b64_tr_b16 v[82:83], v5 offset:6400
    s_waitcnt lgkmcnt(7)
    v_mfma_f32_32x32x16_bf16 v[144:159], v[84:87], v[68:71], v[144:159]
    s_add_u32 m0, s62, 2048
    s_nop 0
    buffer_load_dwordx4 v15, s[8:11], s58 offen lds
    ds_read_b64_tr_b16 v[84:85], v5 offset:26624
    ds_read_b64_tr_b16 v[86:87], v5 offset:26880
    s_waitcnt lgkmcnt(6)
    v_mfma_f32_32x32x16_bf16 v[96:111], v[72:75], v[64:67], v[96:111]
    v_dot2_f32_bf16 v88, v64, s54, v88
    v_dot2_f32_bf16 v89, v64, v64, v89
    v_dot2_f32_bf16 v88, v65, s54, v88
    v_dot2_f32_bf16 v89, v65, v65, v89
    v_dot2_f32_bf16 v88, v66, s54, v88
    v_dot2_f32_bf16 v89, v66, v66, v89
    v_dot2_f32_bf16 v88, v67, s54, v88
    v_dot2_f32_bf16 v89, v67, v67, v89
    v_dot2_f32_bf16 v90, v72, s54, v90
    v_dot2_f32_bf16 v90, v73, s54, v90
    v_dot2_f32_bf16 v90, v74, s54, v90
    v_dot2_f32_bf16 v90, v75, s54, v90
    s_add_u32 s30, s30, 64
    s_add_u32 s31, s31, 64
    s_add_u32 s58, s58, 88064
    ds_read_b128 v[68:71], v3 offset:6144
    ds_read_b64_tr_b16 v[72:73], v4 offset:7168
    ds_read_b64_tr_b16 v[74:75], v4 offset:7424
    s_waitcnt lgkmcnt(7)
    v_mfma_f32_32x32x16_bf16 v[112:127], v[76:79], v[64:67], v[112:127]
    v_dot2_f32_bf16 v91, v76, s54, v91
    v_dot2_f32_bf16 v91, v77, s54, v91
    v_dot2_f32_bf16 v91, v78, s54, v91
    v_dot2_f32_bf16 v91, v79, s54, v91
    ds_read_b64_tr_b16 v[76:77], v4 offset:27648
    ds_read_b64_tr_b16 v[78:79], v4 offset:27904
    s_waitcnt lgkmcnt(7)
    v_mfma_f32_32x32x16_bf16 v[128:143], v[80:83], v[64:67], v[128:143]
    ds_read_b64_tr_b16 v[80:81], v5 offset:7168
    ds_read_b64_tr_b16 v[82:83], v5 offset:7424
    s_waitcnt lgkmcnt(7)
    v_mfma_f32_32x32x16_bf16 v[144:159], v[84:87], v[64:67], v[144:159]
    ds_read_b64_tr_b16 v[84:85], v5 offset:27648
    ds_read_b64_tr_b16 v[86:87], v5 offset:27904
    s_waitcnt lgkmcnt(6)
    v_mfma_f32_32x32x16_bf16 v[96:111], v[72:75], v[68:71], v[96:111]
    v_dot2_f32_bf16 v88, v68, s54, v88
    v_dot2_f32_bf16 v89, v68, v68, v89
    v_dot2_f32_bf16 v88, v69, s54, v88
    v_dot2_f32_bf16 v89, v69, v69, v89
    v_dot2_f32_bf16 v88, v70, s54, v88
    v_dot2_f32_bf16 v89, v70, v70, v89
    v_dot2_f32_bf16 v88, v71, s54, v88
    v_dot2_f32_bf16 v89, v71, v71, v89
    v_dot2_f32_bf16 v90, v72, s54, v90
    v_dot2_f32_bf16 v90, v73, s54, v90
    v_dot2_f32_bf16 v90, v74, s54, v90
    v_dot2_f32_bf16 v90, v75, s54, v90
    s_waitcnt vmcnt(6)
    s_barrier
    ds_read_b128 v[64:67], v2 offset:8192
    ds_read_b64_tr_b16 v[72:73], v4 offset:8192
    ds_read_b64_tr_b16 v[74:75], v4 offset:8448
    s_waitcnt lgkmcnt(7)
    v_mfma_f32_32x32x16_bf16 v[112:127], v[76:79], v[68:71], v[112:127]
    v_dot2_f32_bf16 v91, v76, s54, v91
    v_dot2_f32_bf16 v91, v77, s54, v91
    v_dot2_f32_bf16 v91, v78, s54, v91
    v_dot2_f32_bf16 v91, v79, s54, v91
    s_add_u32 m0, s33, 4096
    s_nop 0
    buffer_load_dwordx4 v14, s[4:7], s30 offen lds
    ds_read_b64_tr_b16 v[76:77], v4 offset:28672
    ds_read_b64_tr_b16 v[78:79], v4 offset:28928
    s_waitcnt lgkmcnt(7)
    v_mfma_f32_32x32x16_bf16 v[128:143], v[80:83], v[68:71], v[128:143]
    s_add_u32 m0, s33, 5120
    s_nop 0
    buffer_load_dwordx4 v14, s[4:7], s31 offen lds
    ds_read_b64_tr_b16 v[80:81], v5 offset:8192
    ds_read_b64_tr_b16 v[82:83], v5 offset:8448
    s_waitcnt lgkmcnt(7)
    v_mfma_f32_32x32x16_bf16 v[144:159], v[84:87], v[68:71], v[144:159]
    s_add_u32 m0, s62, 4096
    s_nop 0
    buffer_load_dwordx4 v15, s[8:11], s58 offen lds
    ds_read_b64_tr_b16 v[84:85], v5 offset:28672
    ds_read_b64_tr_b16 v[86:87], v5 offset:28928
    s_waitcnt lgkmcnt(6)
    v_mfma_f32_32x32x16_bf16 v[96:111], v[72:75], v[64:67], v[96:111]
    v_dot2_f32_bf16 v88, v64, s54, v88
    v_dot2_f32_bf16 v89, v64, v64, v89
    v_dot2_f32_bf16 v88, v65, s54, v88
    v_dot2_f32_bf16 v89, v65, v65, v89
    v_dot2_f32_bf16 v88, v66, s54, v88
    v_dot2_f32_bf16 v89, v66, v66, v89
    v_dot2_f32_bf16 v88, v67, s54, v88
    v_dot2_f32_bf16 v89, v67, v67, v89
    v_dot2_f32_bf16 v90, v72, s54, v90
    v_dot2_f32_bf16 v90, v73, s54, v90
    v_dot2_f32_bf16 v90, v74, s54, v90
    v_dot2_f32_bf16 v90, v75, s54, v90
    s_add_u32 s30, s30, 64
    s_add_u32 s31, s31, 64
    s_add_u32 s58, s58, 88064
    ds_read_b128 v[68:71], v3 offset:8192
    ds_read_b64_tr_b16 v[72:73], v4 offset:9216
    ds_read_b64_tr_b16 v[74:75], v4 offset:9472
    s_waitcnt lgkmcnt(7)
    v_mfma_f32_32x32x16_bf16 v[112:127], v[76:79], v[64:67], v[112:127]
    v_dot2_f32_bf16 v91, v76, s54, v91
    v_dot2_f32_bf16 v91, v77, s54, v91
    v_dot2_f32_bf16 v91, v78, s54, v91
    v_dot2_f32_bf16 v91, v79, s54, v91
    ds_read_b64_tr_b16 v[76:77], v4 offset:29696
    ds_read_b64_tr_b16 v[78:79], v4 offset:29952
    s_waitcnt lgkmcnt(7)
    v_mfma_f32_32x32x16_bf16 v[128:143], v[80:83], v[64:67], v[128:143]
    ds_read_b64_tr_b16 v[80:81], v5 offset:9216
    ds_read_b64_tr_b16 v[82:83], v5 offset:9472
    s_waitcnt lgkmcnt(7)
    v_mfma_f32_32x32x16_bf16 v[144:159], v[84:87], v[64:67], v[144:159]
    ds_read_b64_tr_b16 v[84:85], v5 offset:29696
    ds_read_b64_tr_b16 v[86:87], v5 offset:29952
    s_waitcnt lgkmcnt(6)
    v_mfma_f32_32x32x16_bf16 v[96:111], v[72:75], v[68:71], v[96:111]
    v_dot2_f32_bf16 v88, v68, s54, v88
    v_dot2_f32_bf16 v89, v68, v68, v89
    v_dot2_f32_bf16 v88, v69, s54, v88
    v_dot2_f32_bf16 v89, v69, v69, v89
    v_dot2_f32_bf16 v88, v70, s54, v88
    v_dot2_f32_bf16 v89, v70, v70, v89
    v_dot2_f32_bf16 v88, v71, s54, v88
    v_dot2_f32_bf16 v89, v71, v71, v89
    v_dot2_f32_bf16 v90, v72, s54, v90
    v_dot2_f32_bf16 v90, v73, s54, v90
    v_dot2_f32_bf16 v90, v74, s54, v90
    v_dot2_f32_bf16 v90, v75, s54, v90
    s_waitcnt vmcnt(6)
    s_barrier
    ds_read_b128 v[64:67], v2 offset:0
    ds_read_b64_tr_b16 v[72:73], v4 offset:0
    ds_read_b64_tr_b16 v[74:75], v4 offset:256
    s_waitcnt lgkmcnt(7)
    v_mfma_f32_32x32x16_bf16 v[112:127], v[76:79], v[68:71], v[112:127]
    v_dot2_f32_bf16 v91, v76, s54, v91
    v_dot2_f32_bf16 v91, v77, s54, v91
    v_dot2_f32_bf16 v91, v78, s54, v91
    v_dot2_f32_bf16 v91, v79, s54, v91
    s_add_u32 m0, s33, 6144
    s_nop 0
    buffer_load_dwordx4 v14, s[4:7], s30 offen lds
    ds_read_b64_tr_b16 v[76:77], v4 offset:20480
    ds_read_b64_tr_b16 v[78:79], v4 offset:20736
    s_waitcnt lgkmcnt(7)
    v_mfma_f32_32x32x16_bf16 v[128:143], v[80:83], v[68:71], v[128:143]
    s_add_u32 m0, s33, 7168
    s_nop 0
    buffer_load_dwordx4 v14, s[4:7], s31 offen lds
    ds_read_b64_tr_b16 v[80:81], v5 offset:0
    ds_read_b64_tr_b16 v[82:83], v5 offset:256
    s_waitcnt lgkmcnt(7)
    v_mfma_f32_32x32x16_bf16 v[144:159], v[84:87], v[68:71], v[144:159]
    s_add_u32 m0, s62, 6144
    s_nop 0
    buffer_load_dwordx4 v15, s[8:11], s58 offen lds
    ds_read_b64_tr_b16 v[84:85], v5 offset:20480
    ds_read_b64_tr_b16 v[86:87], v5 offset:20736
    s_waitcnt lgkmcnt(6)
    v_mfma_f32_32x32x16_bf16 v[96:111], v[72:75], v[64:67], v[96:111]
    v_dot2_f32_bf16 v88, v64, s54, v88
    v_dot2_f32_bf16 v89, v64, v64, v89
    v_dot2_f32_bf16 v88, v65, s54, v88
    v_dot2_f32_bf16 v89, v65, v65, v89
    v_dot2_f32_bf16 v88, v66, s54, v88
    v_dot2_f32_bf16 v89, v66, v66, v89
    v_dot2_f32_bf16 v88, v67, s54, v88
    v_dot2_f32_bf16 v89, v67, v67, v89
    v_dot2_f32_bf16 v90, v72, s54, v90
    v_dot2_f32_bf16 v90, v73, s54, v90
    v_dot2_f32_bf16 v90, v74, s54, v90
    v_dot2_f32_bf16 v90, v75, s54, v90
    s_add_u32 s30, s30, 64
    s_add_u32 s31, s31, 64
    s_add_u32 s58, s58, 88064
    ds_read_b128 v[68:71], v3 offset:0
    ds_read_b64_tr_b16 v[72:73], v4 offset:1024
    ds_read_b64_tr_b16 v[74:75], v4 offset:1280
    s_waitcnt lgkmcnt(7)
    v_mfma_f32_32x32x16_bf16 v[112:127], v[76:79], v[64:67], v[112:127]
    v_dot2_f32_bf16 v91, v76, s54, v91
    v_dot2_f32_bf16 v91, v77, s54, v91
    v_dot2_f32_bf16 v91, v78, s54, v91
    v_dot2_f32_bf16 v91, v79, s54, v91
    ds_read_b64_tr_b16 v[76:77], v4 offset:21504
    ds_read_b64_tr_b16 v[78:79], v4 offset:21760
    s_waitcnt lgkmcnt(7)
    v_mfma_f32_32x32x16_bf16 v[128:143], v[80:83], v[64:67], v[128:143]
    ds_read_b64_tr_b16 v[80:81], v5 offset:1024
    ds_read_b64_tr_b16 v[82:83], v5 offset:1280
    s_waitcnt lgkmcnt(7)
    v_mfma_f32_32x32x16_bf16 v[144:159], v[84:87], v[64:67], v[144:159]
    ds_read_b64_tr_b16 v[84:85], v5 offset:21504
    ds_read_b64_tr_b16 v[86:87], v5 offset:21760
    s_waitcnt lgkmcnt(6)
    v_mfma_f32_32x32x16_bf16 v[96:111], v[72:75], v[68:71], v[96:111]
    v_dot2_f32_bf16 v88, v68, s54, v88
    v_dot2_f32_bf16 v89, v68, v68, v89
    v_dot2_f32_bf16 v88, v69, s54, v88
    v_dot2_f32_bf16 v89, v69, v69, v89
    v_dot2_f32_bf16 v88, v70, s54, v88
    v_dot2_f32_bf16 v89, v70, v70, v89
    v_dot2_f32_bf16 v88, v71, s54, v88
    v_dot2_f32_bf16 v89, v71, v71, v89
    v_dot2_f32_bf16 v90, v72, s54, v90
    v_dot2_f32_bf16 v90, v73, s54, v90
    v_dot2_f32_bf16 v90, v74, s54, v90
    v_dot2_f32_bf16 v90, v75, s54, v90
    s_waitcnt vmcnt(6)
    s_barrier
    ds_read_b128 v[64:67], v2 offset:2048
    ds_read_b64_tr_b16 v[72:73], v4 offset:2048
    ds_read_b64_tr_b16 v[74:75], v4 offset:2304
    s_waitcnt lgkmcnt(7)
    v_mfma_f32_32x32x16_bf16 v[112:127], v[76:79], v[68:71], v[112:127]
    v_dot2_f32_bf16 v91, v76, s54, v91
    v_dot2_f32_bf16 v91, v77, s54, v91
    v_dot2_f32_bf16 v91, v78, s54, v91
    v_dot2_f32_bf16 v91, v79, s54, v91
    s_add_u32 m0, s33, 8192
    s_nop 0
    buffer_load_dwordx4 v14, s[4:7], s30 offen lds
    ds_read_b64_tr_b16 v[76:77], v4 offset:22528
    ds_read_b64_tr_b16 v[78:79], v4 offset:22784
    s_waitcnt lgkmcnt(7)
    v_mfma_f32_32x32x16_bf16 v[128:143], v[80:83], v[68:71], v[128:143]
    s_add_u32 m0, s33, 9216
    s_nop 0
    buffer_load_dwordx4 v14, s[4:7], s31 offen lds
    ds_read_b64_tr_b16 v[80:81], v5 offset:2048
    ds_read_b64_tr_b16 v[82:83], v5 offset:2304
    s_waitcnt lgkmcnt(7)
    v_mfma_f32_32x32x16_bf16 v[144:159], v[84:87], v[68:71], v[144:159]
    s_add_u32 m0, s62, 8192
    s_nop 0
    buffer_load_dwordx4 v15, s[8:11], s58 offen lds
    ds_read_b64_tr_b16 v[84:85], v5 offset:22528
    ds_read_b64_tr_b16 v[86:87], v5 offset:22784
    s_waitcnt lgkmcnt(6)
    v_mfma_f32_32x32x16_bf16 v[96:111], v[72:75], v[64:67], v[96:111]
    v_dot2_f32_bf16 v88, v64, s54, v88
    v_dot2_f32_bf16 v89, v64, v64, v89
    v_dot2_f32_bf16 v88, v65, s54, v88
    v_dot2_f32_bf16 v89, v65, v65, v89
    v_dot2_f32_bf16 v88, v66, s54, v88
    v_dot2_f32_bf16 v89, v66, v66, v89
    v_dot2_f32_bf16 v88, v67, s54, v88
    v_dot2_f32_bf16 v89, v67, v67, v89
    v_dot2_f32_bf16 v90, v72, s54, v90
    v_dot2_f32_bf16 v90, v73, s54, v90
    v_dot2_f32_bf16 v90, v74, s54, v90
    v_dot2_f32_bf16 v90, v75, s54, v90
    s_add_u32 s30, s30, 64
    s_add_u32 s31, s31, 64
    s_add_u32 s58, s58, 88064
    ds_read_b128 v[68:71], v3 offset:2048
    ds_read_b64_tr_b16 v[72:73], v4 offset:3072
    ds_read_b64_tr_b16 v[74:75], v4 offset:3328
    s_waitcnt lgkmcnt(7)
    v_mfma_f32_32x32x16_bf16 v[112:127], v[76:79], v[64:67], v[112:127]
    v_dot2_f32_bf16 v91, v76, s54, v91
    v_dot2_f32_bf16 v91, v77, s54, v91
    v_dot2_f32_bf16 v91, v78, s54, v91
    v_dot2_f32_bf16 v91, v79, s54, v91
    ds_read_b64_tr_b16 v[76:77], v4 offset:23552
    ds_read_b64_tr_b16 v[78:79], v4 offset:23808
    s_waitcnt lgkmcnt(7)
    v_mfma_f32_32x32x16_bf16 v[128:143], v[80:83], v[64:67], v[128:143]
    ds_read_b64_tr_b16 v[80:81], v5 offset:3072
    ds_read_b64_tr_b16 v[82:83], v5 offset:3328
    s_waitcnt lgkmcnt(7)
    v_mfma_f32_32x32x16_bf16 v[144:159], v[84:87], v[64:67], v[144:159]
    ds_read_b64_tr_b16 v[84:85], v5 offset:23552
    ds_read_b64_tr_b16 v[86:87], v5 offset:23808
    s_waitcnt lgkmcnt(6)
    v_mfma_f32_32x32x16_bf16 v[96:111], v[72:75], v[68:71], v[96:111]
    v_dot2_f32_bf16 v88, v68, s54, v88
    v_dot2_f32_bf16 v89, v68, v68, v89
    v_dot2_f32_bf16 v88, v69, s54, v88
    v_dot2_f32_bf16 v89, v69, v69, v89
    v_dot2_f32_bf16 v88, v70, s54, v88
    v_dot2_f32_bf16 v89, v70, v70, v89
    v_dot2_f32_bf16 v88, v71, s54, v88
    v_dot2_f32_bf16 v89, v71, v71, v89
    v_dot2_f32_bf16 v90, v72, s54, v90
    v_dot2_f32_bf16 v90, v73, s54, v90
    v_dot2_f32_bf16 v90, v74, s54, v90
    v_dot2_f32_bf16 v90, v75, s54, v90
    s_waitcnt vmcnt(6)
    s_barrier
    ds_read_b128 v[64:67], v2 offset:4096
    ds_read_b64_tr_b16 v[72:73], v4 offset:4096
    ds_read_b64_tr_b16 v[74:75], v4 offset:4352
    s_waitcnt lgkmcnt(7)
    v_mfma_f32_32x32x16_bf16 v[112:127], v[76:79], v[68:71], v[112:127]
    v_dot2_f32_bf16 v91, v76, s54, v91
    v_dot2_f32_bf16 v91, v77, s54, v91
    v_dot2_f32_bf16 v91, v78, s54, v91
    v_dot2_f32_bf16 v91, v79, s54, v91
    s_add_u32 m0, s33, 0
    s_nop 0
    buffer_load_dwordx4 v14, s[4:7], s30 offen lds
    ds_read_b64_tr_b16 v[76:77], v4 offset:24576
    ds_read_b64_tr_b16 v[78:79], v4 offset:24832
    s_waitcnt lgkmcnt(7)
    v_mfma_f32_32x32x16_bf16 v[128:143], v[80:83], v[68:71], v[128:143]
    s_add_u32 m0, s33, 1024
    s_nop 0
    buffer_load_dwordx4 v14, s[4:7], s31 offen lds
    ds_read_b64_tr_b16 v[80:81], v5 offset:4096
    ds_read_b64_tr_b16 v[82:83], v5 offset:4352
    s_waitcnt lgkmcnt(7)
    v_mfma_f32_32x32x16_bf16 v[144:159], v[84:87], v[68:71], v[144:159]
    s_add_u32 m0, s62, 0
    s_nop 0
    buffer_load_dwordx4 v15, s[8:11], s58 offen lds
    ds_read_b64_tr_b16 v[84:85], v5 offset:24576
    ds_read_b64_tr_b16 v[86:87], v5 offset:24832
    s_waitcnt lgkmcnt(6)
    v_mfma_f32_32x32x16_bf16 v[96:111], v[72:75], v[64:67], v[96:111]
    v_dot2_f32_bf16 v88, v64, s54, v88
    v_dot2_f32_bf16 v89, v64, v64, v89
    v_dot2_f32_bf16 v88, v65, s54, v88
    v_dot2_f32_bf16 v89, v65, v65, v89
    v_dot2_f32_bf16 v88, v66, s54, v88
    v_dot2_f32_bf16 v89, v66, v66, v89
    v_dot2_f32_bf16 v88, v67, s54, v88
    v_dot2_f32_bf16 v89, v67, v67, v89
    v_dot2_f32_bf16 v90, v72, s54, v90
    v_dot2_f32_bf16 v90, v73, s54, v90
    v_dot2_f32_bf16 v90, v74, s54, v90
    v_dot2_f32_bf16 v90, v75, s54, v90
    s_add_u32 s30, s30, 64
    s_add_u32 s31, s31, 64
    s_add_u32 s58, s58, 88064
    ds_read_b128 v[68:71], v3 offset:4096
    ds_read_b64_tr_b16 v[72:73], v4 offset:5120
    ds_read_b64_tr_b16 v[74:75], v4 offset:5376
    s_waitcnt lgkmcnt(7)
    v_mfma_f32_32x32x16_bf16 v[112:127], v[76:79], v[64:67], v[112:127]
    v_dot2_f32_bf16 v91, v76, s54, v91
    v_dot2_f32_bf16 v91, v77, s54, v91
    v_dot2_f32_bf16 v91, v78, s54, v91
    v_dot2_f32_bf16 v91, v79, s54, v91
    ds_read_b64_tr_b16 v[76:77], v4 offset:25600
    ds_read_b64_tr_b16 v[78:79], v4 offset:25856
    s_waitcnt lgkmcnt(7)
    v_mfma_f32_32x32x16_bf16 v[128:143], v[80:83], v[64:67], v[128:143]
    ds_read_b64_tr_b16 v[80:81], v5 offset:5120
    ds_read_b64_tr_b16 v[82:83], v5 offset:5376
    s_waitcnt lgkmcnt(7)
    v_mfma_f32_32x32x16_bf16 v[144:159], v[84:87], v[64:67], v[144:159]
    ds_read_b64_tr_b16 v[84:85], v5 offset:25600
    ds_read_b64_tr_b16 v[86:87], v5 offset:25856
    s_waitcnt lgkmcnt(6)
    v_mfma_f32_32x32x16_bf16 v[96:111], v[72:75], v[68:71], v[96:111]
    v_dot2_f32_bf16 v88, v68, s54, v88
    v_dot2_f32_bf16 v89, v68, v68, v89
    v_dot2_f32_bf16 v88, v69, s54, v88
    v_dot2_f32_bf16 v89, v69, v69, v89
    v_dot2_f32_bf16 v88, v70, s54, v88
    v_dot2_f32_bf16 v89, v70, v70, v89
    v_dot2_f32_bf16 v88, v71, s54, v88
    v_dot2_f32_bf16 v89, v71, v71, v89
    v_dot2_f32_bf16 v90, v72, s54, v90
    v_dot2_f32_bf16 v90, v73, s54, v90
    v_dot2_f32_bf16 v90, v74, s54, v90
    v_dot2_f32_bf16 v90, v75, s54, v90
    s_waitcnt vmcnt(6)
    s_barrier
    ds_read_b128 v[64:67], v2 offset:6144
    ds_read_b64_tr_b16 v[72:73], v4 offset:6144
    ds_read_b64_tr_b16 v[74:75], v4 offset:6400
    s_waitcnt lgkmcnt(7)
    v_mfma_f32_32x32x16_bf16 v[112:127], v[76:79], v[68:71], v[112:127]
    v_dot2_f32_bf16 v91, v76, s54, v91
    v_dot2_f32_bf16 v91, v77, s54, v91
    v_dot2_f32_bf16 v91, v78, s54, v91
    v_dot2_f32_bf16 v91, v79, s54, v91
    ds_read_b64_tr_b16 v[76:77], v4 offset:26624
    ds_read_b64_tr_b16 v[78:79], v4 offset:26880
    s_waitcnt lgkmcnt(7)
    v_mfma_f32_32x32x16_bf16 v[128:143], v[80:83], v[68:71], v[128:143]
    ds_read_b64_tr_b16 v[80:81], v5 offset:6144
    ds_read_b64_tr_b16 v[82:83], v5 offset:6400
    s_waitcnt lgkmcnt(7)
    v_mfma_f32_32x32x16_bf16 v[144:159], v[84:87], v[68:71], v[144:159]
    ds_read_b64_tr_b16 v[84:85], v5 offset:26624
    ds_read_b64_tr_b16 v[86:87], v5 offset:26880
    s_waitcnt lgkmcnt(6)
    v_mfma_f32_32x32x16_bf16 v[96:111], v[72:75], v[64:67], v[96:111]
    v_dot2_f32_bf16 v88, v64, s54, v88
    v_dot2_f32_bf16 v89, v64, v64, v89
    v_dot2_f32_bf16 v88, v65, s54, v88
    v_dot2_f32_bf16 v89, v65, v65, v89
    v_dot2_f32_bf16 v88, v66, s54, v88
    v_dot2_f32_bf16 v89, v66, v66, v89
    v_dot2_f32_bf16 v88, v67, s54, v88
    v_dot2_f32_bf16 v89, v67, v67, v89
    v_dot2_f32_bf16 v90, v72, s54, v90
    v_dot2_f32_bf16 v90, v73, s54, v90
    v_dot2_f32_bf16 v90, v74, s54, v90
    v_dot2_f32_bf16 v90, v75, s54, v90
    ds_read_b128 v[68:71], v3 offset:6144
    ds_read_b64_tr_b16 v[72:73], v4 offset:7168
    ds_read_b64_tr_b16 v[74:75], v4 offset:7424
    s_waitcnt lgkmcnt(7)
    v_mfma_f32_32x32x16_bf16 v[112:127], v[76:79], v[64:67], v[112:127]
    v_dot2_f32_bf16 v91, v76, s54, v91
    v_dot2_f32_bf16 v91, v77, s54, v91
    v_dot2_f32_bf16 v91, v78, s54, v91
    v_dot2_f32_bf16 v91, v79, s54, v91
    ds_read_b64_tr_b16 v[76:77], v4 offset:27648
    ds_read_b64_tr_b16 v[78:79], v4 offset:27904
    s_waitcnt lgkmcnt(7)
    v_mfma_f32_32x32x16_bf16 v[128:143], v[80:83], v[64:67], v[128:143]
    ds_read_b64_tr_b16 v[80:81], v5 offset:7168
    ds_read_b64_tr_b16 v[82:83], v5 offset:7424
    s_waitcnt lgkmcnt(7)
    v_mfma_f32_32x32x16_bf16 v[144:159], v[84:87], v[64:67], v[144:159]
    ds_read_b64_tr_b16 v[84:85], v5 offset:27648
    ds_read_b64_tr_b16 v[86:87], v5 offset:27904
    s_waitcnt lgkmcnt(6)
    v_mfma_f32_32x32x16_bf16 v[96:111], v[72:75], v[68:71], v[96:111]
    v_dot2_f32_bf16 v88, v68, s54, v88
    v_dot2_f32_bf16 v89, v68, v68, v89
    v_dot2_f32_bf16 v88, v69, s54, v88
    v_dot2_f32_bf16 v89, v69, v69, v89
    v_dot2_f32_bf16 v88, v70, s54, v88
    v_dot2_f32_bf16 v89, v70, v70, v89
    v_dot2_f32_bf16 v88, v71, s54, v88
    v_dot2_f32_bf16 v89, v71, v71, v89
    v_dot2_f32_bf16 v90, v72, s54, v90
    v_dot2_f32_bf16 v90, v73, s54, v90
    v_dot2_f32_bf16 v90, v74, s54, v90
    v_dot2_f32_bf16 v90, v75, s54, v90
    s_waitcnt vmcnt(3)
    s_barrier
    ds_read_b128 v[64:67], v2 offset:8192
    ds_read_b64_tr_b16 v[72:73], v4 offset:8192
    ds_read_b64_tr_b16 v[74:75], v4 offset:8448
    s_waitcnt lgkmcnt(7)
    v_mfma_f32_32x32x16_bf16 v[112:127], v[76:79], v[68:71], v[112:127]
    v_dot2_f32_bf16 v91, v76, s54, v91
    v_dot2_f32_bf16 v91, v77, s54, v91
    v_dot2_f32_bf16 v91, v78, s54, v91
    v_dot2_f32_bf16 v91, v79, s54, v91
    ds_read_b64_tr_b16 v[76:77], v4 offset:28672
    ds_read_b64_tr_b16 v[78:79], v4 offset:28928
    s_waitcnt lgkmcnt(7)
    v_mfma_f32_32x32x16_bf16 v[128:143], v[80:83], v[68:71], v[128:143]
    ds_read_b64_tr_b16 v[80:81], v5 offset:8192
    ds_read_b64_tr_b16 v[82:83], v5 offset:8448
    s_waitcnt lgkmcnt(7)
    v_mfma_f32_32x32x16_bf16 v[144:159], v[84:87], v[68:71], v[144:159]
    ds_read_b64_tr_b16 v[84:85], v5 offset:28672
    ds_read_b64_tr_b16 v[86:87], v5 offset:28928
    s_waitcnt lgkmcnt(6)
    v_mfma_f32_32x32x16_bf16 v[96:111], v[72:75], v[64:67], v[96:111]
    v_dot2_f32_bf16 v88, v64, s54, v88
    v_dot2_f32_bf16 v89, v64, v64, v89
    v_dot2_f32_bf16 v88, v65, s54, v88
    v_dot2_f32_bf16 v89, v65, v65, v89
    v_dot2_f32_bf16 v88, v66, s54, v88
    v_dot2_f32_bf16 v89, v66, v66, v89
    v_dot2_f32_bf16 v88, v67, s54, v88
    v_dot2_f32_bf16 v89, v67, v67, v89
    v_dot2_f32_bf16 v90, v72, s54, v90
    v_dot2_f32_bf16 v90, v73, s54, v90
    v_dot2_f32_bf16 v90, v74, s54, v90
    v_dot2_f32_bf16 v90, v75, s54, v90
    ds_read_b128 v[68:71], v3 offset:8192
    ds_read_b64_tr_b16 v[72:73], v4 offset:9216
    ds_read_b64_tr_b16 v[74:75], v4 offset:9472
    s_waitcnt lgkmcnt(7)
    v_mfma_f32_32x32x16_bf16 v[112:127], v[76:79], v[64:67], v[112:127]
    v_dot2_f32_bf16 v91, v76, s54, v91
    v_dot2_f32_bf16 v91, v77, s54, v91
    v_dot2_f32_bf16 v91, v78, s54, v91
    v_dot2_f32_bf16 v91, v79, s54, v91
    ds_read_b64_tr_b16 v[76:77], v4 offset:29696
    ds_read_b64_tr_b16 v[78:79], v4 offset:29952
    s_waitcnt lgkmcnt(7)
    v_mfma_f32_32x32x16_bf16 v[128:143], v[80:83], v[64:67], v[128:143]
    ds_read_b64_tr_b16 v[80:81], v5 offset:9216
    ds_read_b64_tr_b16 v[82:83], v5 offset:9472
    s_waitcnt lgkmcnt(7)
    v_mfma_f32_32x32x16_bf16 v[144:159], v[84:87], v[64:67], v[144:159]
    ds_read_b64_tr_b16 v[84:85], v5 offset:29696
    ds_read_b64_tr_b16 v[86:87], v5 offset:29952
    s_waitcnt lgkmcnt(6)
    v_mfma_f32_32x32x16_bf16 v[96:111], v[72:75], v[68:71], v[96:111]
    v_dot2_f32_bf16 v88, v68, s54, v88
    v_dot2_f32_bf16 v89, v68, v68, v89
    v_dot2_f32_bf16 v88, v69, s54, v88
    v_dot2_f32_bf16 v89, v69, v69, v89
    v_dot2_f32_bf16 v88, v70, s54, v88
    v_dot2_f32_bf16 v89, v70, v70, v89
    v_dot2_f32_bf16 v88, v71, s54, v88
    v_dot2_f32_bf16 v89, v71, v71, v89
    v_dot2_f32_bf16 v90, v72, s54, v90
    v_dot2_f32_bf16 v90, v73, s54, v90
    v_dot2_f32_bf16 v90, v74, s54, v90
    v_dot2_f32_bf16 v90, v75, s54, v90
    s_waitcnt vmcnt(0)
    s_barrier
    ds_read_b128 v[64:67], v2 offset:0
    ds_read_b64_tr_b16 v[72:73], v4 offset:0
    ds_read_b64_tr_b16 v[74:75], v4 offset:256
    s_waitcnt lgkmcnt(7)
    v_mfma_f32_32x32x16_bf16 v[112:127], v[76:79], v[68:71], v[112:127]
    v_dot2_f32_bf16 v91, v76, s54, v91
    v_dot2_f32_bf16 v91, v77, s54, v91
    v_dot2_f32_bf16 v91, v78, s54, v91
    v_dot2_f32_bf16 v91, v79, s54, v91
    ds_read_b64_tr_b16 v[76:77], v4 offset:20480
    ds_read_b64_tr_b16 v[78:79], v4 offset:20736
    s_waitcnt lgkmcnt(7)
    v_mfma_f32_32x32x16_bf16 v[128:143], v[80:83], v[68:71], v[128:143]
    ds_read_b64_tr_b16 v[80:81], v5 offset:0
    ds_read_b64_tr_b16 v[82:83], v5 offset:256
    s_waitcnt lgkmcnt(7)
    v_mfma_f32_32x32x16_bf16 v[144:159], v[84:87], v[68:71], v[144:159]
    ds_read_b64_tr_b16 v[84:85], v5 offset:20480
    ds_read_b64_tr_b16 v[86:87], v5 offset:20736
    s_waitcnt lgkmcnt(6)
    v_mfma_f32_32x32x16_bf16 v[96:111], v[72:75], v[64:67], v[96:111]
    v_dot2_f32_bf16 v88, v64, s54, v88
    v_dot2_f32_bf16 v89, v64, v64, v89
    v_dot2_f32_bf16 v88, v65, s54, v88
    v_dot2_f32_bf16 v89, v65, v65, v89
    v_dot2_f32_bf16 v88, v66, s54, v88
    v_dot2_f32_bf16 v89, v66, v66, v89
    v_dot2_f32_bf16 v88, v67, s54, v88
    v_dot2_f32_bf16 v89, v67, v67, v89
    v_dot2_f32_bf16 v90, v72, s54, v90
    v_dot2_f32_bf16 v90, v73, s54, v90
    v_dot2_f32_bf16 v90, v74, s54, v90
    v_dot2_f32_bf16 v90, v75, s54, v90
    ds_read_b128 v[68:71], v3 offset:0
    ds_read_b64_tr_b16 v[72:73], v4 offset:1024
    ds_read_b64_tr_b16 v[74:75], v4 offset:1280
    s_waitcnt lgkmcnt(7)
    v_mfma_f32_32x32x16_bf16 v[112:127], v[76:79], v[64:67], v[112:127]
    v_dot2_f32_bf16 v91, v76, s54, v91
    v_dot2_f32_bf16 v91, v77, s54, v91
    v_dot2_f32_bf16 v91, v78, s54, v91
    v_dot2_f32_bf16 v91, v79, s54, v91
    ds_read_b64_tr_b16 v[76:77], v4 offset:21504
    ds_read_b64_tr_b16 v[78:79], v4 offset:21760
    s_waitcnt lgkmcnt(7)
    v_mfma_f32_32x32x16_bf16 v[128:143], v[80:83], v[64:67], v[128:143]
    ds_read_b64_tr_b16 v[80:81], v5 offset:1024
    ds_read_b64_tr_b16 v[82:83], v5 offset:1280
    s_waitcnt lgkmcnt(7)
    v_mfma_f32_32x32x16_bf16 v[144:159], v[84:87], v[64:67], v[144:159]
    ds_read_b64_tr_b16 v[84:85], v5 offset:21504
    ds_read_b64_tr_b16 v[86:87], v5 offset:21760
    s_waitcnt lgkmcnt(6)
    v_mfma_f32_32x32x16_bf16 v[96:111], v[72:75], v[68:71], v[96:111]
    v_dot2_f32_bf16 v88, v68, s54, v88
    v_dot2_f32_bf16 v89, v68, v68, v89
    v_dot2_f32_bf16 v88, v69, s54, v88
    v_dot2_f32_bf16 v89, v69, v69, v89
    v_dot2_f32_bf16 v88, v70, s54, v88
    v_dot2_f32_bf16 v89, v70, v70, v89
    v_dot2_f32_bf16 v88, v71, s54, v88
    v_dot2_f32_bf16 v89, v71, v71, v89
    v_dot2_f32_bf16 v90, v72, s54, v90
    v_dot2_f32_bf16 v90, v73, s54, v90
    v_dot2_f32_bf16 v90, v74, s54, v90
    v_dot2_f32_bf16 v90, v75, s54, v90
    s_waitcnt lgkmcnt(4)
    v_mfma_f32_32x32x16_bf16 v[112:127], v[76:79], v[68:71], v[112:127]
    v_dot2_f32_bf16 v91, v76, s54, v91
    v_dot2_f32_bf16 v91, v77, s54, v91
    v_dot2_f32_bf16 v91, v78, s54, v91
    v_dot2_f32_bf16 v91, v79, s54, v91
    s_waitcnt lgkmcnt(2)
    v_mfma_f32_32x32x16_bf16 v[128:143], v[80:83], v[68:71], v[128:143]
    s_waitcnt lgkmcnt(0)
    v_mfma_f32_32x32x16_bf16 v[144:159], v[84:87], v[68:71], v[144:159]
    v_mov_b32 v21, v88
    v_mov_b32 v22, v88
    s_nop 1
    v_permlane32_swap_b32 v21, v22
    v_add_f32 v88, v21, v22
    v_mov_b32 v21, v89
    v_mov_b32 v22, v89
    s_nop 1
    v_permlane32_swap_b32 v21, v22
    v_add_f32 v89, v21, v22
    v_mov_b32 v21, v90
    v_mov_b32 v22, v90
    s_nop 1
    v_permlane32_swap_b32 v21, v22
    v_add_f32 v90, v21, v22
    v_mov_b32 v21, v91
    v_mov_b32 v22, v91
    s_nop 1
    v_permlane32_swap_b32 v21, v22
    v_add_f32 v91, v21, v22
    v_mul_f32 v23, 0x3b000000, v88
    v_mul_f32 v24, 0x3b000000, v89
    v_fma_f32 v24, -v23, v23, v24
    v_add_f32 v24, 0x3727c5ac, v24
    v_rsq_f32 v25, v24
    s_waitcnt lgkmcnt(0)
    s_barrier
    v_lshlrev_b32 v21, 2, v20
    s_lshl_b32 s48, s36, 7
    v_add_u32 v22, s48, v21
    ds_write_b32 v22, v90
    s_lshl_b32 s48, s36, 7
    s_add_u32 s48, s48, 256
    v_add_u32 v22, s48, v21
    ds_write_b32 v22, v91
    s_waitcnt lgkmcnt(0)
    s_barrier
    s_lshl_b32 s48, s36, 7
    v_add_u32 v22, s48, v21
    ds_read_b32 v32, v22
    s_lshl_b32 s48, s36, 7
    s_add_u32 s48, s48, 256
    v_add_u32 v22, s48, v21
    ds_read_b32 v33, v22
    s_lshl_b32 s48, s37, 7
    v_add_u32 v22, s48, v21
    ds_read_b32 v34, v22
    s_lshl_b32 s48, s37, 7
    s_add_u32 s48, s48, 256
    v_add_u32 v22, s48, v21
    ds_read_b32 v35, v22
    v_mov_b32 v46, 0
    v_mov_b32 v47, 0
    v_mov_b32 v50, 0
    v_mov_b32 v51, 0
    v_sub_f32 v21, 0, v23
    v_cndmask_b32 v21, v21, 0, s[50:51]
    v_cvt_pk_bf16_f32 v44, v21, v21
    v_lshlrev_b32 v22, 16, v44
    v_sub_f32 v22, v21, v22
    v_cvt_pk_bf16_f32 v44, v21, v22
    v_mov_b32 v45, v44
    s_waitcnt lgkmcnt(3)
    v_cndmask_b32 v21, v32, 0, s[50:51]
    v_cvt_pk_bf16_f32 v48, v21, v21
    v_lshlrev_b32 v22, 16, v48
    v_sub_f32 v22, v21, v22
    v_cvt_pk_bf16_f32 v49, v22, v22
    s_nop 1
    v_mfma_f32_32x32x16_bf16 v[96:111], v[48:51], v[44:47], v[96:111]
    s_waitcnt lgkmcnt(2)
    v_cndmask_b32 v21, v33, 0, s[50:51]
    v_cvt_pk_bf16_f32 v48, v21, v21
    v_lshlrev_b32 v22, 16, v48
    v_sub_f32 v22, v21, v22
    v_cvt_pk_bf16_f32 v49, v22, v22
    s_nop 1
    v_mfma_f32_32x32x16_bf16 v[112:127], v[48:51], v[44:47], v[112:127]
    s_waitcnt lgkmcnt(1)
    v_cndmask_b32 v21, v34, 0, s[50:51]
    v_cvt_pk_bf16_f32 v48, v21, v21
    v_lshlrev_b32 v22, 16, v48
    v_sub_f32 v22, v21, v22
    v_cvt_pk_bf16_f32 v49, v22, v22
    s_nop 1
    v_mfma_f32_32x32x16_bf16 v[128:143], v[48:51], v[44:47], v[128:143]
    s_waitcnt lgkmcnt(0)
    v_cndmask_b32 v21, v35, 0, s[50:51]
    v_cvt_pk_bf16_f32 v48, v21, v21
    v_lshlrev_b32 v22, 16, v48
    v_sub_f32 v22, v21, v22
    v_cvt_pk_bf16_f32 v49, v22, v22
    s_nop 1
    v_mfma_f32_32x32x16_bf16 v[144:159], v[48:51], v[44:47], v[144:159]
    v_mul_f32 v52, 0xbfb8aa3b, v25
    v_mov_b32 v53, v52
    v_mov_b32 v54, v24
    v_mov_b32 v55, v24
    s_movk_i32 s48, 2752
    v_mul_lo_u32 v26, v20, s48
    v_lshrrev_b32 v21, 5, v1
    v_lshl_add_u32 v26, v21, 4, v26
    s_mul_i32 s48, s16, 88064
    v_add_u32 v26, s48, v26
    s_mul_i32 s46, s17, 704512
    s_add_u32 s46, s46, 0x800000
    v_pk_mul_f32 v[32:33], v[96:97], v[52:53]
    v_pk_mul_f32 v[34:35], v[98:99], v[52:53]
    v_pk_mul_f32 v[36:37], v[100:101], v[52:53]
    v_pk_mul_f32 v[38:39], v[102:103], v[52:53]
    v_pk_mul_f32 v[40:41], v[104:105], v[52:53]
    v_pk_mul_f32 v[42:43], v[106:107], v[52:53]
    v_pk_mul_f32 v[44:45], v[108:109], v[52:53]
    v_pk_mul_f32 v[46:47], v[110:111], v[52:53]
    v_exp_f32 v32, v32
    v_exp_f32 v33, v33
    v_pk_mul_f32 v[96:97], v[96:97], v[112:113]
    v_exp_f32 v34, v34
    v_exp_f32 v35, v35
    v_pk_mul_f32 v[98:99], v[98:99], v[114:115]
    v_exp_f32 v36, v36
    v_exp_f32 v37, v37
    v_pk_mul_f32 v[100:101], v[100:101], v[116:117]
    v_exp_f32 v38, v38
    v_exp_f32 v39, v39
    v_pk_mul_f32 v[102:103], v[102:103], v[118:119]
    v_exp_f32 v40, v40
    v_exp_f32 v41, v41
    v_pk_mul_f32 v[104:105], v[104:105], v[120:121]
    v_exp_f32 v42, v42
    v_exp_f32 v43, v43
    v_pk_mul_f32 v[106:107], v[106:107], v[122:123]
    v_exp_f32 v44, v44
    v_exp_f32 v45, v45
    v_pk_mul_f32 v[108:109], v[108:109], v[124:125]
    v_exp_f32 v46, v46
    v_exp_f32 v47, v47
    v_pk_mul_f32 v[110:111], v[110:111], v[126:127]
    v_pk_fma_f32 v[32:33], v[32:33], v[54:55], v[54:55]
    v_pk_fma_f32 v[34:35], v[34:35], v[54:55], v[54:55]
    v_pk_fma_f32 v[36:37], v[36:37], v[54:55], v[54:55]
    v_pk_fma_f32 v[38:39], v[38:39], v[54:55], v[54:55]
    v_pk_fma_f32 v[40:41], v[40:41], v[54:55], v[54:55]
    v_pk_fma_f32 v[42:43], v[42:43], v[54:55], v[54:55]
    v_pk_fma_f32 v[44:45], v[44:45], v[54:55], v[54:55]
    v_pk_fma_f32 v[46:47], v[46:47], v[54:55], v[54:55]
    v_rcp_f32 v32, v32
    v_rcp_f32 v33, v33
    v_rcp_f32 v34, v34
    v_rcp_f32 v35, v35
    v_rcp_f32 v36, v36
    v_rcp_f32 v37, v37
    v_rcp_f32 v38, v38
    v_rcp_f32 v39, v39
    v_rcp_f32 v40, v40
    v_rcp_f32 v41, v41
    v_rcp_f32 v42, v42
    v_rcp_f32 v43, v43
    v_rcp_f32 v44, v44
    v_rcp_f32 v45, v45
    v_rcp_f32 v46, v46
    v_rcp_f32 v47, v47
    v_pk_mul_f32 v[96:97], v[96:97], v[32:33]
    v_pk_mul_f32 v[98:99], v[98:99], v[34:35]
    v_pk_mul_f32 v[100:101], v[100:101], v[36:37]
    v_pk_mul_f32 v[102:103], v[102:103], v[38:39]
    v_pk_mul_f32 v[104:105], v[104:105], v[40:41]
    v_pk_mul_f32 v[106:107], v[106:107], v[42:43]
    v_pk_mul_f32 v[108:109], v[108:109], v[44:45]
    v_pk_mul_f32 v[110:111], v[110:111], v[46:47]
    v_cvt_pk_bf16_f32 v56, v96, v97
    v_cvt_pk_bf16_f32 v57, v98, v99
    v_cvt_pk_bf16_f32 v58, v100, v101
    v_cvt_pk_bf16_f32 v59, v102, v103
    v_cvt_pk_bf16_f32 v60, v104, v105
    v_cvt_pk_bf16_f32 v61, v106, v107
    v_cvt_pk_bf16_f32 v62, v108, v109
    v_cvt_pk_bf16_f32 v63, v110, v111
    v_permlane32_swap_b32 v56, v58
    v_permlane32_swap_b32 v57, v59
    v_permlane32_swap_b32 v60, v62
    v_permlane32_swap_b32 v61, v63
    s_add_u32 s47, s35, s36
    s_lshl_b32 s48, s47, 6
    s_add_u32 s48, s48, s46
    s_cmp_gt_u32 s47, 42
    s_cselect_b32 s48, 0x6000000, s48
    buffer_store_dwordx4 v[56:59], v26, s[12:15], s48 offen
    buffer_store_dwordx4 v[60:63], v26, s[12:15], s48 offen offset:32
    v_pk_mul_f32 v[32:33], v[128:129], v[52:53]
    v_pk_mul_f32 v[34:35], v[130:131], v[52:53]
    v_pk_mul_f32 v[36:37], v[132:133], v[52:53]
    v_pk_mul_f32 v[38:39], v[134:135], v[52:53]
    v_pk_mul_f32 v[40:41], v[136:137], v[52:53]
    v_pk_mul_f32 v[42:43], v[138:139], v[52:53]
    v_pk_mul_f32 v[44:45], v[140:141], v[52:53]
    v_pk_mul_f32 v[46:47], v[142:143], v[52:53]
    v_exp_f32 v32, v32
    v_exp_f32 v33, v33
    v_pk_mul_f32 v[128:129], v[128:129], v[144:145]
    v_exp_f32 v34, v34
    v_exp_f32 v35, v35
    v_pk_mul_f32 v[130:131], v[130:131], v[146:147]
    v_exp_f32 v36, v36
    v_exp_f32 v37, v37
    v_pk_mul_f32 v[132:133], v[132:133], v[148:149]
    v_exp_f32 v38, v38
    v_exp_f32 v39, v39
    v_pk_mul_f32 v[134:135], v[134:135], v[150:151]
    v_exp_f32 v40, v40
    v_exp_f32 v41, v41
    v_pk_mul_f32 v[136:137], v[136:137], v[152:153]
    v_exp_f32 v42, v42
    v_exp_f32 v43, v43
    v_pk_mul_f32 v[138:139], v[138:139], v[154:155]
    v_exp_f32 v44, v44
    v_exp_f32 v45, v45
    v_pk_mul_f32 v[140:141], v[140:141], v[156:157]
    v_exp_f32 v46, v46
    v_exp_f32 v47, v47
    v_pk_mul_f32 v[142:143], v[142:143], v[158:159]
    v_pk_fma_f32 v[32:33], v[32:33], v[54:55], v[54:55]
    v_pk_fma_f32 v[34:35], v[34:35], v[54:55], v[54:55]
    v_pk_fma_f32 v[36:37], v[36:37], v[54:55], v[54:55]
    v_pk_fma_f32 v[38:39], v[38:39], v[54:55], v[54:55]
    v_pk_fma_f32 v[40:41], v[40:41], v[54:55], v[54:55]
    v_pk_fma_f32 v[42:43], v[42:43], v[54:55], v[54:55]
    v_pk_fma_f32 v[44:45], v[44:45], v[54:55], v[54:55]
    v_pk_fma_f32 v[46:47], v[46:47], v[54:55], v[54:55]
    v_rcp_f32 v32, v32
    v_rcp_f32 v33, v33
    v_rcp_f32 v34, v34
    v_rcp_f32 v35, v35
    v_rcp_f32 v36, v36
    v_rcp_f32 v37, v37
    v_rcp_f32 v38, v38
    v_rcp_f32 v39, v39
    v_rcp_f32 v40, v40
    v_rcp_f32 v41, v41
    v_rcp_f32 v42, v42
    v_rcp_f32 v43, v43
    v_rcp_f32 v44, v44
    v_rcp_f32 v45, v45
    v_rcp_f32 v46, v46
    v_rcp_f32 v47, v47
    v_pk_mul_f32 v[128:129], v[128:129], v[32:33]
    v_pk_mul_f32 v[130:131], v[130:131], v[34:35]
    v_pk_mul_f32 v[132:133], v[132:133], v[36:37]
    v_pk_mul_f32 v[134:135], v[134:135], v[38:39]
    v_pk_mul_f32 v[136:137], v[136:137], v[40:41]
    v_pk_mul_f32 v[138:139], v[138:139], v[42:43]
    v_pk_mul_f32 v[140:141], v[140:141], v[44:45]
    v_pk_mul_f32 v[142:143], v[142:143], v[46:47]
    v_cvt_pk_bf16_f32 v56, v128, v129
    v_cvt_pk_bf16_f32 v57, v130, v131
    v_cvt_pk_bf16_f32 v58, v132, v133
    v_cvt_pk_bf16_f32 v59, v134, v135
    v_cvt_pk_bf16_f32 v60, v136, v137
    v_cvt_pk_bf16_f32 v61, v138, v139
    v_cvt_pk_bf16_f32 v62, v140, v141
    v_cvt_pk_bf16_f32 v63, v142, v143
    v_permlane32_swap_b32 v56, v58
    v_permlane32_swap_b32 v57, v59
    v_permlane32_swap_b32 v60, v62
    v_permlane32_swap_b32 v61, v63
    s_add_u32 s47, s35, s37
    s_lshl_b32 s48, s47, 6
    s_add_u32 s48, s48, s46
    s_cmp_gt_u32 s47, 42
    s_cselect_b32 s48, 0x6000000, s48
    buffer_store_dwordx4 v[56:59], v26, s[12:15], s48 offen
    buffer_store_dwordx4 v[60:63], v26, s[12:15], s48 offen offset:32
    s_endpgm
L_k1_exit:
    s_endpgm
.section .rodata,"a"
.p2align 6
.amdhsa_kernel k1_gemm_kernel
  .amdhsa_next_free_vgpr 192
  .amdhsa_next_free_sgpr 72
  .amdhsa_accum_offset 192
  .amdhsa_group_segment_fixed_size 0
  .amdhsa_kernarg_size 80
  .amdhsa_user_sgpr_count 2
  .amdhsa_user_sgpr_kernarg_segment_ptr 1
  .amdhsa_system_sgpr_workgroup_id_x 1
.end_amdhsa_kernel
.text
.p2align 8
.globl k2_attn_kernel
.type k2_attn_kernel,@function
k2_attn_kernel:
    s_cmp_ge_u32 s2, 512
    s_nop 0
    s_cbranch_scc1 L_k2_exit
    s_load_dwordx2 s[28:29], s[0:1], 72
    v_and_b32 v1, 63, v0
    v_and_b32 v2, 31, v0
    v_bfe_u32 v3, v0, 5, 1
    v_lshrrev_b32 v4, 6, v0
    s_nop 0
    v_readfirstlane_b32 s8, v4
    s_and_b32 s11, s2, 7
    s_lshl_b32 s11, s11, 2
    s_add_u32 s9, s11, s8
    s_lshr_b32 s10, s2, 3
    s_mov_b32 s15, 0x3eb8aa3b
    s_mov_b32 s16, 0x0000ffff
    s_mov_b32 s17, 0x0000ffff
    v_mov_b32 v7, 0xff800000
    s_waitcnt lgkmcnt(0)
    s_mov_b32 s4, s28
    s_mov_b32 s5, s29
    s_mov_b32 s6, 0x10000000
    s_mov_b32 s7, 0x00020000
    v_lshlrev_b32 v99, 5, v2
    v_lshl_add_u32 v99, v3, 4, v99
    s_lshl_b32 s11, s9, 16
    s_lshl_b32 s12, s10, 10
    s_add_u32 s12, s12, s11
    buffer_load_dwordx4 v[8:11], v99, s[4:7], s12 offen
    s_add_u32 s11, s11, 0x200000
    s_add_i32 s13, s10, -8
    s_max_i32 s13, s13, 0
    s_lshl_b32 s13, s13, 10
    s_add_u32 s13, s13, s11
    buffer_load_dwordx4 v[12:15], v99, s[4:7], s13 offen
    s_add_i32 s13, s10, -7
    s_max_i32 s13, s13, 0
    s_lshl_b32 s13, s13, 10
    s_add_u32 s13, s13, s11
    buffer_load_dwordx4 v[16:19], v99, s[4:7], s13 offen
    s_add_i32 s13, s10, -6
    s_max_i32 s13, s13, 0
    s_lshl_b32 s13, s13, 10
    s_add_u32 s13, s13, s11
    buffer_load_dwordx4 v[20:23], v99, s[4:7], s13 offen
    s_add_i32 s13, s10, -5
    s_max_i32 s13, s13, 0
    s_lshl_b32 s13, s13, 10
    s_add_u32 s13, s13, s11
    buffer_load_dwordx4 v[24:27], v99, s[4:7], s13 offen
    s_add_i32 s13, s10, -4
    s_max_i32 s13, s13, 0
    s_lshl_b32 s13, s13, 10
    s_add_u32 s13, s13, s11
    buffer_load_dwordx4 v[28:31], v99, s[4:7], s13 offen
    s_add_i32 s13, s10, -3
    s_max_i32 s13, s13, 0
    s_lshl_b32 s13, s13, 10
    s_add_u32 s13, s13, s11
    buffer_load_dwordx4 v[32:35], v99, s[4:7], s13 offen
    s_add_i32 s13, s10, -2
    s_max_i32 s13, s13, 0
    s_lshl_b32 s13, s13, 10
    s_add_u32 s13, s13, s11
    buffer_load_dwordx4 v[36:39], v99, s[4:7], s13 offen
    s_add_i32 s13, s10, -1
    s_max_i32 s13, s13, 0
    s_lshl_b32 s13, s13, 10
    s_add_u32 s13, s13, s11
    buffer_load_dwordx4 v[40:43], v99, s[4:7], s13 offen
    s_add_i32 s13, s10, 0
    s_max_i32 s13, s13, 0
    s_lshl_b32 s13, s13, 10
    s_add_u32 s13, s13, s11
    buffer_load_dwordx4 v[44:47], v99, s[4:7], s13 offen
    v_cmp_eq_u32 vcc, 16, v2
    v_cmp_eq_u32 s[18:19], 20, v2
    s_or_b64 vcc, vcc, s[18:19]
    v_mov_b32 v5, 0x3f803f80
    v_cndmask_b32 v4, 0, v5, vcc
    v_mov_b32 v48, v4
    v_mov_b32 v49, v4
    v_mov_b32 v50, v4
    v_mov_b32 v51, v4
    v_mov_b32 v52, v4
    v_mov_b32 v53, v4
    v_mov_b32 v54, v4
    v_mov_b32 v55, v4
    v_mov_b32 v56, v4
    v_mov_b32 v57, v4
    v_mov_b32 v58, v4
    v_mov_b32 v59, v4
    v_mov_b32 v60, v4
    v_mov_b32 v61, v4
    v_mov_b32 v62, v4
    v_mov_b32 v63, v4
    v_mov_b32 v64, v4
    v_mov_b32 v65, v4
    v_mov_b32 v66, v4
    v_mov_b32 v67, v4
    v_mov_b32 v68, v4
    v_mov_b32 v69, v4
    v_mov_b32 v70, v4
    v_mov_b32 v71, v4
    v_and_b32 v4, 15, v1
    v_lshlrev_b32 v100, 5, v4
    v_lshl_add_u32 v100, v3, 4, v100
    s_add_i32 s13, s10, -7
    s_max_i32 s13, s13, 0
    s_lshl_b32 s13, s13, 10
    s_lshl_b32 s14, s9, 16
    s_add_u32 s13, s13, s14
    s_add_u32 s13, s13, 0x400000
    s_mov_b64 exec, s[16:17]
    buffer_load_dwordx4 v[48:51], v100, s[4:7], s13 offen
    s_mov_b64 exec, -1
    s_add_i32 s13, s10, -7
    s_max_i32 s13, s13, 0
    s_lshl_b32 s13, s13, 10
    s_lshl_b32 s14, s9, 16
    s_add_u32 s13, s13, s14
    s_add_u32 s13, s13, 0x400200
    s_mov_b64 exec, s[16:17]
    buffer_load_dwordx4 v[52:55], v100, s[4:7], s13 offen
    s_mov_b64 exec, -1
    s_add_i32 s13, s10, -6
    s_max_i32 s13, s13, 0
    s_lshl_b32 s13, s13, 10
    s_lshl_b32 s14, s9, 16
    s_add_u32 s13, s13, s14
    s_add_u32 s13, s13, 0x400000
    s_mov_b64 exec, s[16:17]
    buffer_load_dwordx4 v[56:59], v100, s[4:7], s13 offen
    s_mov_b64 exec, -1
    s_add_i32 s13, s10, -6
    s_max_i32 s13, s13, 0
    s_lshl_b32 s13, s13, 10
    s_lshl_b32 s14, s9, 16
    s_add_u32 s13, s13, s14
    s_add_u32 s13, s13, 0x400200
    s_mov_b64 exec, s[16:17]
    buffer_load_dwordx4 v[60:63], v100, s[4:7], s13 offen
    s_mov_b64 exec, -1
    s_add_i32 s13, s10, -5
    s_max_i32 s13, s13, 0
    s_lshl_b32 s13, s13, 10
    s_lshl_b32 s14, s9, 16
    s_add_u32 s13, s13, s14
    s_add_u32 s13, s13, 0x400000
    s_mov_b64 exec, s[16:17]
    buffer_load_dwordx4 v[64:67], v100, s[4:7], s13 offen
    s_mov_b64 exec, -1
    s_add_i32 s13, s10, -5
    s_max_i32 s13, s13, 0
    s_lshl_b32 s13, s13, 10
    s_lshl_b32 s14, s9, 16
    s_add_u32 s13, s13, s14
    s_add_u32 s13, s13, 0x400200
    s_mov_b64 exec, s[16:17]
    buffer_load_dwordx4 v[68:71], v100, s[4:7], s13 offen
    s_mov_b64 exec, -1
    v_lshl_add_u32 v4, v3, 2, 0
    v_cmp_le_u32 s[34:35], v4, v2
    v_lshl_add_u32 v4, v3, 2, 1
    v_cmp_le_u32 s[36:37], v4, v2
    v_lshl_add_u32 v4, v3, 2, 2
    v_cmp_le_u32 s[38:39], v4, v2
    v_lshl_add_u32 v4, v3, 2, 3
    v_cmp_le_u32 s[40:41], v4, v2
    v_lshl_add_u32 v4, v3, 2, 8
    v_cmp_le_u32 s[42:43], v4, v2
    v_lshl_add_u32 v4, v3, 2, 9
    v_cmp_le_u32 s[44:45], v4, v2
    v_lshl_add_u32 v4, v3, 2, 10
    v_cmp_le_u32 s[46:47], v4, v2
    v_lshl_add_u32 v4, v3, 2, 11
    v_cmp_le_u32 s[48:49], v4, v2
    v_lshl_add_u32 v4, v3, 2, 16
    v_cmp_le_u32 s[50:51], v4, v2
    v_lshl_add_u32 v4, v3, 2, 17
    v_cmp_le_u32 s[52:53], v4, v2
    v_lshl_add_u32 v4, v3, 2, 18
    v_cmp_le_u32 s[54:55], v4, v2
    v_lshl_add_u32 v4, v3, 2, 19
    v_cmp_le_u32 s[56:57], v4, v2
    v_lshl_add_u32 v4, v3, 2, 24
    v_cmp_le_u32 s[58:59], v4, v2
    v_lshl_add_u32 v4, v3, 2, 25
    v_cmp_le_u32 s[60:61], v4, v2
    v_lshl_add_u32 v4, v3, 2, 26
    v_cmp_le_u32 s[62:63], v4, v2
    v_lshl_add_u32 v4, v3, 2, 27
    v_cmp_le_u32 s[64:65], v4, v2
    s_cmp_lt_u32 s10, 8
    s_cselect_b64 s[18:19], -1, 0
    s_andn2_b64 s[66:67], s[18:19], s[34:35]
    s_andn2_b64 s[68:69], s[18:19], s[36:37]
    s_andn2_b64 s[70:71], s[18:19], s[38:39]
    s_andn2_b64 s[72:73], s[18:19], s[40:41]
    s_andn2_b64 s[74:75], s[18:19], s[42:43]
    s_andn2_b64 s[76:77], s[18:19], s[44:45]
    s_andn2_b64 s[78:79], s[18:19], s[46:47]
    s_andn2_b64 s[80:81], s[18:19], s[48:49]
    s_andn2_b64 s[82:83], s[18:19], s[50:51]
    s_andn2_b64 s[84:85], s[18:19], s[52:53]
    s_andn2_b64 s[86:87], s[18:19], s[54:55]
    s_andn2_b64 s[88:89], s[18:19], s[56:57]
    s_andn2_b64 s[90:91], s[18:19], s[58:59]
    s_andn2_b64 s[92:93], s[18:19], s[60:61]
    s_andn2_b64 s[94:95], s[18:19], s[62:63]
    s_andn2_b64 s[96:97], s[18:19], s[64:65]
    s_cmp_ge_u32 s10, 7
    s_cselect_b64 s[20:21], -1, 0
    s_cmp_ge_u32 s10, 6
    s_cselect_b64 s[22:23], -1, 0
    s_cmp_ge_u32 s10, 5
    s_cselect_b64 s[24:25], -1, 0
    s_cmp_ge_u32 s10, 4
    s_cselect_b64 s[26:27], -1, 0
    s_cmp_ge_u32 s10, 3
    s_cselect_b64 s[28:29], -1, 0
    s_cmp_ge_u32 s10, 2
    s_cselect_b64 s[30:31], -1, 0
    s_cmp_ge_u32 s10, 1
    s_cselect_b64 s[32:33], -1, 0
    v_mov_b32 v5, 0xffff
    v_mov_b32 v6, 0xffff0000
    v_cndmask_b32 v4, 0, v5, s[34:35]
    v_cndmask_b32 v88, 0, v6, s[36:37]
    v_or_b32 v88, v88, v4
    v_cndmask_b32 v4, 0, v5, s[38:39]
    v_cndmask_b32 v89, 0, v6, s[40:41]
    v_or_b32 v89, v89, v4
    v_cndmask_b32 v4, 0, v5, s[42:43]
    v_cndmask_b32 v90, 0, v6, s[44:45]
    v_or_b32 v90, v90, v4
    v_cndmask_b32 v4, 0, v5, s[46:47]
    v_cndmask_b32 v91, 0, v6, s[48:49]
    v_or_b32 v91, v91, v4
    v_cndmask_b32 v4, 0, v5, s[50:51]
    v_cndmask_b32 v92, 0, v6, s[52:53]
    v_or_b32 v92, v92, v4
    v_cndmask_b32 v4, 0, v5, s[54:55]
    v_cndmask_b32 v93, 0, v6, s[56:57]
    v_or_b32 v93, v93, v4
    v_cndmask_b32 v4, 0, v5, s[58:59]
    v_cndmask_b32 v94, 0, v6, s[60:61]
    v_or_b32 v94, v94, v4
    v_cndmask_b32 v4, 0, v5, s[62:63]
    v_cndmask_b32 v95, 0, v6, s[64:65]
    v_or_b32 v95, v95, v4
    s_waitcnt vmcnt(14)
    v_mfma_f32_32x32x16_bf16 v[112:127], v[12:15], v[8:11], 0
    s_waitcnt vmcnt(13)
    v_mfma_f32_32x32x16_bf16 v[128:143], v[16:19], v[8:11], 0
    s_waitcnt vmcnt(12)
    v_mfma_f32_32x32x16_bf16 v[144:159], v[20:23], v[8:11], 0
    s_waitcnt vmcnt(11)
    v_mfma_f32_32x32x16_bf16 v[160:175], v[24:27], v[8:11], 0
    s_waitcnt vmcnt(10)
    v_mfma_f32_32x32x16_bf16 v[176:191], v[28:31], v[8:11], 0
    s_waitcnt vmcnt(9)
    v_mfma_f32_32x32x16_bf16 v[192:207], v[32:35], v[8:11], 0
    s_waitcnt vmcnt(8)
    v_mfma_f32_32x32x16_bf16 v[208:223], v[36:39], v[8:11], 0
    s_waitcnt vmcnt(7)
    v_mfma_f32_32x32x16_bf16 v[224:239], v[40:43], v[8:11], 0
    s_waitcnt vmcnt(6)
    v_mfma_f32_32x32x16_bf16 v[240:255], v[44:47], v[8:11], 0
    s_nop 11
    v_cndmask_b32 v240, v112, v240, s[34:35]
    v_cndmask_b32 v241, v113, v241, s[36:37]
    v_cndmask_b32 v242, v114, v242, s[38:39]
    v_cndmask_b32 v243, v115, v243, s[40:41]
    v_cndmask_b32 v244, v116, v244, s[42:43]
    v_cndmask_b32 v245, v117, v245, s[44:45]
    v_cndmask_b32 v246, v118, v246, s[46:47]
    v_cndmask_b32 v247, v119, v247, s[48:49]
    v_cndmask_b32 v248, v120, v248, s[50:51]
    v_cndmask_b32 v249, v121, v249, s[52:53]
    v_cndmask_b32 v250, v122, v250, s[54:55]
    v_cndmask_b32 v251, v123, v251, s[56:57]
    v_cndmask_b32 v252, v124, v252, s[58:59]
    v_cndmask_b32 v253, v125, v253, s[60:61]
    v_cndmask_b32 v254, v126, v254, s[62:63]
    v_cndmask_b32 v255, v127, v255, s[64:65]
    v_cndmask_b32 v240, v240, v7, s[66:67]
    v_cndmask_b32 v241, v241, v7, s[68:69]
    v_cndmask_b32 v242, v242, v7, s[70:71]
    v_cndmask_b32 v243, v243, v7, s[72:73]
    v_cndmask_b32 v244, v244, v7, s[74:75]
    v_cndmask_b32 v245, v245, v7, s[76:77]
    v_cndmask_b32 v246, v246, v7, s[78:79]
    v_cndmask_b32 v247, v247, v7, s[80:81]
    v_cndmask_b32 v248, v248, v7, s[82:83]
    v_cndmask_b32 v249, v249, v7, s[84:85]
    v_cndmask_b32 v250, v250, v7, s[86:87]
    v_cndmask_b32 v251, v251, v7, s[88:89]
    v_cndmask_b32 v252, v252, v7, s[90:91]
    v_cndmask_b32 v253, v253, v7, s[92:93]
    v_cndmask_b32 v254, v254, v7, s[94:95]
    v_cndmask_b32 v255, v255, v7, s[96:97]
    v_max3_f32 v96, v240, v241, v242
    v_max3_f32 v96, v96, v243, v244
    v_max3_f32 v96, v96, v245, v246
    v_max3_f32 v96, v96, v247, v248
    v_max3_f32 v96, v96, v249, v250
    v_max3_f32 v96, v96, v251, v252
    v_max3_f32 v96, v96, v253, v254
    v_max_f32 v96, v96, v255
    v_max3_f32 v101, v128, v129, v130
    v_max3_f32 v101, v101, v131, v132
    v_max3_f32 v101, v101, v133, v134
    v_max3_f32 v101, v101, v135, v136
    v_max3_f32 v101, v101, v137, v138
    v_max3_f32 v101, v101, v139, v140
    v_max3_f32 v101, v101, v141, v142
    v_max_f32 v101, v101, v143
    v_cndmask_b32 v101, v7, v101, s[20:21]
    v_max_f32 v96, v96, v101
    v_max3_f32 v101, v144, v145, v146
    v_max3_f32 v101, v101, v147, v148
    v_max3_f32 v101, v101, v149, v150
    v_max3_f32 v101, v101, v151, v152
    v_max3_f32 v101, v101, v153, v154
    v_max3_f32 v101, v101, v155, v156
    v_max3_f32 v101, v101, v157, v158
    v_max_f32 v101, v101, v159
    v_cndmask_b32 v101, v7, v101, s[22:23]
    v_max_f32 v96, v96, v101
    v_max3_f32 v101, v160, v161, v162
    v_max3_f32 v101, v101, v163, v164
    v_max3_f32 v101, v101, v165, v166
    v_max3_f32 v101, v101, v167, v168
    v_max3_f32 v101, v101, v169, v170
    v_max3_f32 v101, v101, v171, v172
    v_max3_f32 v101, v101, v173, v174
    v_max_f32 v101, v101, v175
    v_cndmask_b32 v101, v7, v101, s[24:25]
    v_max_f32 v96, v96, v101
    v_max3_f32 v101, v176, v177, v178
    v_max3_f32 v101, v101, v179, v180
    v_max3_f32 v101, v101, v181, v182
    v_max3_f32 v101, v101, v183, v184
    v_max3_f32 v101, v101, v185, v186
    v_max3_f32 v101, v101, v187, v188
    v_max3_f32 v101, v101, v189, v190
    v_max_f32 v101, v101, v191
    v_cndmask_b32 v101, v7, v101, s[26:27]
    v_max_f32 v96, v96, v101
    v_max3_f32 v101, v192, v193, v194
    v_max3_f32 v101, v101, v195, v196
    v_max3_f32 v101, v101, v197, v198
    v_max3_f32 v101, v101, v199, v200
    v_max3_f32 v101, v101, v201, v202
    v_max3_f32 v101, v101, v203, v204
    v_max3_f32 v101, v101, v205, v206
    v_max_f32 v101, v101, v207
    v_cndmask_b32 v101, v7, v101, s[28:29]
    v_max_f32 v96, v96, v101
    v_max3_f32 v101, v208, v209, v210
    v_max3_f32 v101, v101, v211, v212
    v_max3_f32 v101, v101, v213, v214
    v_max3_f32 v101, v101, v215, v216
    v_max3_f32 v101, v101, v217, v218
    v_max3_f32 v101, v101, v219, v220
    v_max3_f32 v101, v101, v221, v222
    v_max_f32 v101, v101, v223
    v_cndmask_b32 v101, v7, v101, s[30:31]
    v_max_f32 v96, v96, v101
    v_max3_f32 v101, v224, v225, v226
    v_max3_f32 v101, v101, v227, v228
    v_max3_f32 v101, v101, v229, v230
    v_max3_f32 v101, v101, v231, v232
    v_max3_f32 v101, v101, v233, v234
    v_max3_f32 v101, v101, v235, v236
    v_max3_f32 v101, v101, v237, v238
    v_max_f32 v101, v101, v239
    v_cndmask_b32 v101, v7, v101, s[32:33]
    v_max_f32 v96, v96, v101
    v_mov_b32 v4, v96
    v_mov_b32 v5, v96
    s_nop 1
    v_permlane32_swap_b32 v4, v5
    v_max_f32 v96, v4, v5
    v_mul_f32 v97, s15, v96
    v_sub_f32 v97, 0, v97
    v_cndmask_b32 v98, v7, v97, s[20:21]
    v_fma_f32 v128, v128, s15, v98
    v_fma_f32 v129, v129, s15, v98
    v_fma_f32 v130, v130, s15, v98
    v_fma_f32 v131, v131, s15, v98
    v_fma_f32 v132, v132, s15, v98
    v_fma_f32 v133, v133, s15, v98
    v_fma_f32 v134, v134, s15, v98
    v_fma_f32 v135, v135, s15, v98
    v_fma_f32 v136, v136, s15, v98
    v_fma_f32 v137, v137, s15, v98
    v_fma_f32 v138, v138, s15, v98
    v_fma_f32 v139, v139, s15, v98
    v_fma_f32 v140, v140, s15, v98
    v_fma_f32 v141, v141, s15, v98
    v_fma_f32 v142, v142, s15, v98
    v_fma_f32 v143, v143, s15, v98
    v_exp_f32 v128, v128
    v_exp_f32 v129, v129
    v_exp_f32 v130, v130
    v_exp_f32 v131, v131
    v_exp_f32 v132, v132
    v_exp_f32 v133, v133
    v_exp_f32 v134, v134
    v_exp_f32 v135, v135
    v_exp_f32 v136, v136
    v_exp_f32 v137, v137
    v_exp_f32 v138, v138
    v_exp_f32 v139, v139
    v_exp_f32 v140, v140
    v_exp_f32 v141, v141
    v_exp_f32 v142, v142
    v_exp_f32 v143, v143
    v_cvt_pk_bf16_f32 v128, v128, v129
    v_cvt_pk_bf16_f32 v129, v130, v131
    v_cvt_pk_bf16_f32 v130, v132, v133
    v_cvt_pk_bf16_f32 v131, v134, v135
    v_cvt_pk_bf16_f32 v132, v136, v137
    v_cvt_pk_bf16_f32 v133, v138, v139
    v_cvt_pk_bf16_f32 v134, v140, v141
    v_cvt_pk_bf16_f32 v135, v142, v143
    s_waitcnt vmcnt(5)
    v_mfma_f32_32x32x16_bf16 v[72:87], v[48:51], v[128:131], 0
    s_add_i32 s13, s10, -4
    s_max_i32 s13, s13, 0
    s_lshl_b32 s13, s13, 10
    s_lshl_b32 s14, s9, 16
    s_add_u32 s13, s13, s14
    s_add_u32 s13, s13, 0x400000
    s_mov_b64 exec, s[16:17]
    buffer_load_dwordx4 v[48:51], v100, s[4:7], s13 offen
    s_mov_b64 exec, -1
    s_waitcnt vmcnt(5)
    v_mfma_f32_32x32x16_bf16 v[72:87], v[52:55], v[132:135], v[72:87]
    s_add_i32 s13, s10, -4
    s_max_i32 s13, s13, 0
    s_lshl_b32 s13, s13, 10
    s_lshl_b32 s14, s9, 16
    s_add_u32 s13, s13, s14
    s_add_u32 s13, s13, 0x400200
    s_mov_b64 exec, s[16:17]
    buffer_load_dwordx4 v[52:55], v100, s[4:7], s13 offen
    s_mov_b64 exec, -1
    v_cndmask_b32 v98, v7, v97, s[22:23]
    v_fma_f32 v144, v144, s15, v98
    v_fma_f32 v145, v145, s15, v98
    v_fma_f32 v146, v146, s15, v98
    v_fma_f32 v147, v147, s15, v98
    v_fma_f32 v148, v148, s15, v98
    v_fma_f32 v149, v149, s15, v98
    v_fma_f32 v150, v150, s15, v98
    v_fma_f32 v151, v151, s15, v98
    v_fma_f32 v152, v152, s15, v98
    v_fma_f32 v153, v153, s15, v98
    v_fma_f32 v154, v154, s15, v98
    v_fma_f32 v155, v155, s15, v98
    v_fma_f32 v156, v156, s15, v98
    v_fma_f32 v157, v157, s15, v98
    v_fma_f32 v158, v158, s15, v98
    v_fma_f32 v159, v159, s15, v98
    v_exp_f32 v144, v144
    v_exp_f32 v145, v145
    v_exp_f32 v146, v146
    v_exp_f32 v147, v147
    v_exp_f32 v148, v148
    v_exp_f32 v149, v149
    v_exp_f32 v150, v150
    v_exp_f32 v151, v151
    v_exp_f32 v152, v152
    v_exp_f32 v153, v153
    v_exp_f32 v154, v154
    v_exp_f32 v155, v155
    v_exp_f32 v156, v156
    v_exp_f32 v157, v157
    v_exp_f32 v158, v158
    v_exp_f32 v159, v159
    v_cvt_pk_bf16_f32 v144, v144, v145
    v_cvt_pk_bf16_f32 v145, v146, v147
    v_cvt_pk_bf16_f32 v146, v148, v149
    v_cvt_pk_bf16_f32 v147, v150, v151
    v_cvt_pk_bf16_f32 v148, v152, v153
    v_cvt_pk_bf16_f32 v149, v154, v155
    v_cvt_pk_bf16_f32 v150, v156, v157
    v_cvt_pk_bf16_f32 v151, v158, v159
    s_waitcnt vmcnt(5)
    v_mfma_f32_32x32x16_bf16 v[72:87], v[56:59], v[144:147], v[72:87]
    s_add_i32 s13, s10, -3
    s_max_i32 s13, s13, 0
    s_lshl_b32 s13, s13, 10
    s_lshl_b32 s14, s9, 16
    s_add_u32 s13, s13, s14
    s_add_u32 s13, s13, 0x400000
    s_mov_b64 exec, s[16:17]
    buffer_load_dwordx4 v[56:59], v100, s[4:7], s13 offen
    s_mov_b64 exec, -1
    s_waitcnt vmcnt(5)
    v_mfma_f32_32x32x16_bf16 v[72:87], v[60:63], v[148:151], v[72:87]
    s_add_i32 s13, s10, -3
    s_max_i32 s13, s13, 0
    s_lshl_b32 s13, s13, 10
    s_lshl_b32 s14, s9, 16
    s_add_u32 s13, s13, s14
    s_add_u32 s13, s13, 0x400200
    s_mov_b64 exec, s[16:17]
    buffer_load_dwordx4 v[60:63], v100, s[4:7], s13 offen
    s_mov_b64 exec, -1
    v_cndmask_b32 v98, v7, v97, s[24:25]
    v_fma_f32 v160, v160, s15, v98
    v_fma_f32 v161, v161, s15, v98
    v_fma_f32 v162, v162, s15, v98
    v_fma_f32 v163, v163, s15, v98
    v_fma_f32 v164, v164, s15, v98
    v_fma_f32 v165, v165, s15, v98
    v_fma_f32 v166, v166, s15, v98
    v_fma_f32 v167, v167, s15, v98
    v_fma_f32 v168, v168, s15, v98
    v_fma_f32 v169, v169, s15, v98
    v_fma_f32 v170, v170, s15, v98
    v_fma_f32 v171, v171, s15, v98
    v_fma_f32 v172, v172, s15, v98
    v_fma_f32 v173, v173, s15, v98
    v_fma_f32 v174, v174, s15, v98
    v_fma_f32 v175, v175, s15, v98
    v_exp_f32 v160, v160
    v_exp_f32 v161, v161
    v_exp_f32 v162, v162
    v_exp_f32 v163, v163
    v_exp_f32 v164, v164
    v_exp_f32 v165, v165
    v_exp_f32 v166, v166
    v_exp_f32 v167, v167
    v_exp_f32 v168, v168
    v_exp_f32 v169, v169
    v_exp_f32 v170, v170
    v_exp_f32 v171, v171
    v_exp_f32 v172, v172
    v_exp_f32 v173, v173
    v_exp_f32 v174, v174
    v_exp_f32 v175, v175
    v_cvt_pk_bf16_f32 v160, v160, v161
    v_cvt_pk_bf16_f32 v161, v162, v163
    v_cvt_pk_bf16_f32 v162, v164, v165
    v_cvt_pk_bf16_f32 v163, v166, v167
    v_cvt_pk_bf16_f32 v164, v168, v169
    v_cvt_pk_bf16_f32 v165, v170, v171
    v_cvt_pk_bf16_f32 v166, v172, v173
    v_cvt_pk_bf16_f32 v167, v174, v175
    s_waitcnt vmcnt(5)
    v_mfma_f32_32x32x16_bf16 v[72:87], v[64:67], v[160:163], v[72:87]
    s_add_i32 s13, s10, -2
    s_max_i32 s13, s13, 0
    s_lshl_b32 s13, s13, 10
    s_lshl_b32 s14, s9, 16
    s_add_u32 s13, s13, s14
    s_add_u32 s13, s13, 0x400000
    s_mov_b64 exec, s[16:17]
    buffer_load_dwordx4 v[64:67], v100, s[4:7], s13 offen
    s_mov_b64 exec, -1
    s_waitcnt vmcnt(5)
    v_mfma_f32_32x32x16_bf16 v[72:87], v[68:71], v[164:167], v[72:87]
    s_add_i32 s13, s10, -2
    s_max_i32 s13, s13, 0
    s_lshl_b32 s13, s13, 10
    s_lshl_b32 s14, s9, 16
    s_add_u32 s13, s13, s14
    s_add_u32 s13, s13, 0x400200
    s_mov_b64 exec, s[16:17]
    buffer_load_dwordx4 v[68:71], v100, s[4:7], s13 offen
    s_mov_b64 exec, -1
    v_cndmask_b32 v98, v7, v97, s[26:27]
    v_fma_f32 v176, v176, s15, v98
    v_fma_f32 v177, v177, s15, v98
    v_fma_f32 v178, v178, s15, v98
    v_fma_f32 v179, v179, s15, v98
    v_fma_f32 v180, v180, s15, v98
    v_fma_f32 v181, v181, s15, v98
    v_fma_f32 v182, v182, s15, v98
    v_fma_f32 v183, v183, s15, v98
    v_fma_f32 v184, v184, s15, v98
    v_fma_f32 v185, v185, s15, v98
    v_fma_f32 v186, v186, s15, v98
    v_fma_f32 v187, v187, s15, v98
    v_fma_f32 v188, v188, s15, v98
    v_fma_f32 v189, v189, s15, v98
    v_fma_f32 v190, v190, s15, v98
    v_fma_f32 v191, v191, s15, v98
    v_exp_f32 v176, v176
    v_exp_f32 v177, v177
    v_exp_f32 v178, v178
    v_exp_f32 v179, v179
    v_exp_f32 v180, v180
    v_exp_f32 v181, v181
    v_exp_f32 v182, v182
    v_exp_f32 v183, v183
    v_exp_f32 v184, v184
    v_exp_f32 v185, v185
    v_exp_f32 v186, v186
    v_exp_f32 v187, v187
    v_exp_f32 v188, v188
    v_exp_f32 v189, v189
    v_exp_f32 v190, v190
    v_exp_f32 v191, v191
    v_cvt_pk_bf16_f32 v176, v176, v177
    v_cvt_pk_bf16_f32 v177, v178, v179
    v_cvt_pk_bf16_f32 v178, v180, v181
    v_cvt_pk_bf16_f32 v179, v182, v183
    v_cvt_pk_bf16_f32 v180, v184, v185
    v_cvt_pk_bf16_f32 v181, v186, v187
    v_cvt_pk_bf16_f32 v182, v188, v189
    v_cvt_pk_bf16_f32 v183, v190, v191
    s_waitcnt vmcnt(5)
    v_mfma_f32_32x32x16_bf16 v[72:87], v[48:51], v[176:179], v[72:87]
    s_add_i32 s13, s10, -1
    s_max_i32 s13, s13, 0
    s_lshl_b32 s13, s13, 10
    s_lshl_b32 s14, s9, 16
    s_add_u32 s13, s13, s14
    s_add_u32 s13, s13, 0x400000
    s_mov_b64 exec, s[16:17]
    buffer_load_dwordx4 v[48:51], v100, s[4:7], s13 offen
    s_mov_b64 exec, -1
    s_waitcnt vmcnt(5)
    v_mfma_f32_32x32x16_bf16 v[72:87], v[52:55], v[180:183], v[72:87]
    s_add_i32 s13, s10, -1
    s_max_i32 s13, s13, 0
    s_lshl_b32 s13, s13, 10
    s_lshl_b32 s14, s9, 16
    s_add_u32 s13, s13, s14
    s_add_u32 s13, s13, 0x400200
    s_mov_b64 exec, s[16:17]
    buffer_load_dwordx4 v[52:55], v100, s[4:7], s13 offen
    s_mov_b64 exec, -1
    v_cndmask_b32 v98, v7, v97, s[28:29]
    v_fma_f32 v192, v192, s15, v98
    v_fma_f32 v193, v193, s15, v98
    v_fma_f32 v194, v194, s15, v98
    v_fma_f32 v195, v195, s15, v98
    v_fma_f32 v196, v196, s15, v98
    v_fma_f32 v197, v197, s15, v98
    v_fma_f32 v198, v198, s15, v98
    v_fma_f32 v199, v199, s15, v98
    v_fma_f32 v200, v200, s15, v98
    v_fma_f32 v201, v201, s15, v98
    v_fma_f32 v202, v202, s15, v98
    v_fma_f32 v203, v203, s15, v98
    v_fma_f32 v204, v204, s15, v98
    v_fma_f32 v205, v205, s15, v98
    v_fma_f32 v206, v206, s15, v98
    v_fma_f32 v207, v207, s15, v98
    v_exp_f32 v192, v192
    v_exp_f32 v193, v193
    v_exp_f32 v194, v194
    v_exp_f32 v195, v195
    v_exp_f32 v196, v196
    v_exp_f32 v197, v197
    v_exp_f32 v198, v198
    v_exp_f32 v199, v199
    v_exp_f32 v200, v200
    v_exp_f32 v201, v201
    v_exp_f32 v202, v202
    v_exp_f32 v203, v203
    v_exp_f32 v204, v204
    v_exp_f32 v205, v205
    v_exp_f32 v206, v206
    v_exp_f32 v207, v207
    v_cvt_pk_bf16_f32 v192, v192, v193
    v_cvt_pk_bf16_f32 v193, v194, v195
    v_cvt_pk_bf16_f32 v194, v196, v197
    v_cvt_pk_bf16_f32 v195, v198, v199
    v_cvt_pk_bf16_f32 v196, v200, v201
    v_cvt_pk_bf16_f32 v197, v202, v203
    v_cvt_pk_bf16_f32 v198, v204, v205
    v_cvt_pk_bf16_f32 v199, v206, v207
    s_waitcnt vmcnt(5)
    v_mfma_f32_32x32x16_bf16 v[72:87], v[56:59], v[192:195], v[72:87]
    s_add_i32 s13, s10, 0
    s_max_i32 s13, s13, 0
    s_lshl_b32 s13, s13, 10
    s_lshl_b32 s14, s9, 16
    s_add_u32 s13, s13, s14
    s_add_u32 s13, s13, 0x400000
    s_mov_b64 exec, s[16:17]
    buffer_load_dwordx4 v[56:59], v100, s[4:7], s13 offen
    s_mov_b64 exec, -1
    s_waitcnt vmcnt(5)
    v_mfma_f32_32x32x16_bf16 v[72:87], v[60:63], v[196:199], v[72:87]
    s_add_i32 s13, s10, 0
    s_max_i32 s13, s13, 0
    s_lshl_b32 s13, s13, 10
    s_lshl_b32 s14, s9, 16
    s_add_u32 s13, s13, s14
    s_add_u32 s13, s13, 0x400200
    s_mov_b64 exec, s[16:17]
    buffer_load_dwordx4 v[60:63], v100, s[4:7], s13 offen
    s_mov_b64 exec, -1
    v_cndmask_b32 v98, v7, v97, s[30:31]
    v_fma_f32 v208, v208, s15, v98
    v_fma_f32 v209, v209, s15, v98
    v_fma_f32 v210, v210, s15, v98
    v_fma_f32 v211, v211, s15, v98
    v_fma_f32 v212, v212, s15, v98
    v_fma_f32 v213, v213, s15, v98
    v_fma_f32 v214, v214, s15, v98
    v_fma_f32 v215, v215, s15, v98
    v_fma_f32 v216, v216, s15, v98
    v_fma_f32 v217, v217, s15, v98
    v_fma_f32 v218, v218, s15, v98
    v_fma_f32 v219, v219, s15, v98
    v_fma_f32 v220, v220, s15, v98
    v_fma_f32 v221, v221, s15, v98
    v_fma_f32 v222, v222, s15, v98
    v_fma_f32 v223, v223, s15, v98
    v_exp_f32 v208, v208
    v_exp_f32 v209, v209
    v_exp_f32 v210, v210
    v_exp_f32 v211, v211
    v_exp_f32 v212, v212
    v_exp_f32 v213, v213
    v_exp_f32 v214, v214
    v_exp_f32 v215, v215
    v_exp_f32 v216, v216
    v_exp_f32 v217, v217
    v_exp_f32 v218, v218
    v_exp_f32 v219, v219
    v_exp_f32 v220, v220
    v_exp_f32 v221, v221
    v_exp_f32 v222, v222
    v_exp_f32 v223, v223
    v_cvt_pk_bf16_f32 v208, v208, v209
    v_cvt_pk_bf16_f32 v209, v210, v211
    v_cvt_pk_bf16_f32 v210, v212, v213
    v_cvt_pk_bf16_f32 v211, v214, v215
    v_cvt_pk_bf16_f32 v212, v216, v217
    v_cvt_pk_bf16_f32 v213, v218, v219
    v_cvt_pk_bf16_f32 v214, v220, v221
    v_cvt_pk_bf16_f32 v215, v222, v223
    s_waitcnt vmcnt(5)
    v_mfma_f32_32x32x16_bf16 v[72:87], v[64:67], v[208:211], v[72:87]
    s_add_i32 s13, s10, -8
    s_max_i32 s13, s13, 0
    s_lshl_b32 s13, s13, 10
    s_lshl_b32 s14, s9, 16
    s_add_u32 s13, s13, s14
    s_add_u32 s13, s13, 0x400000
    s_mov_b64 exec, s[16:17]
    buffer_load_dwordx4 v[64:67], v100, s[4:7], s13 offen
    s_mov_b64 exec, -1
    s_waitcnt vmcnt(5)
    v_mfma_f32_32x32x16_bf16 v[72:87], v[68:71], v[212:215], v[72:87]
    s_add_i32 s13, s10, -8
    s_max_i32 s13, s13, 0
    s_lshl_b32 s13, s13, 10
    s_lshl_b32 s14, s9, 16
    s_add_u32 s13, s13, s14
    s_add_u32 s13, s13, 0x400200
    s_mov_b64 exec, s[16:17]
    buffer_load_dwordx4 v[68:71], v100, s[4:7], s13 offen
    s_mov_b64 exec, -1
    v_cndmask_b32 v98, v7, v97, s[32:33]
    v_fma_f32 v224, v224, s15, v98
    v_fma_f32 v225, v225, s15, v98
    v_fma_f32 v226, v226, s15, v98
    v_fma_f32 v227, v227, s15, v98
    v_fma_f32 v228, v228, s15, v98
    v_fma_f32 v229, v229, s15, v98
    v_fma_f32 v230, v230, s15, v98
    v_fma_f32 v231, v231, s15, v98
    v_fma_f32 v232, v232, s15, v98
    v_fma_f32 v233, v233, s15, v98
    v_fma_f32 v234, v234, s15, v98
    v_fma_f32 v235, v235, s15, v98
    v_fma_f32 v236, v236, s15, v98
    v_fma_f32 v237, v237, s15, v98
    v_fma_f32 v238, v238, s15, v98
    v_fma_f32 v239, v239, s15, v98
    v_exp_f32 v224, v224
    v_exp_f32 v225, v225
    v_exp_f32 v226, v226
    v_exp_f32 v227, v227
    v_exp_f32 v228, v228
    v_exp_f32 v229, v229
    v_exp_f32 v230, v230
    v_exp_f32 v231, v231
    v_exp_f32 v232, v232
    v_exp_f32 v233, v233
    v_exp_f32 v234, v234
    v_exp_f32 v235, v235
    v_exp_f32 v236, v236
    v_exp_f32 v237, v237
    v_exp_f32 v238, v238
    v_exp_f32 v239, v239
    v_cvt_pk_bf16_f32 v224, v224, v225
    v_cvt_pk_bf16_f32 v225, v226, v227
    v_cvt_pk_bf16_f32 v226, v228, v229
    v_cvt_pk_bf16_f32 v227, v230, v231
    v_cvt_pk_bf16_f32 v228, v232, v233
    v_cvt_pk_bf16_f32 v229, v234, v235
    v_cvt_pk_bf16_f32 v230, v236, v237
    v_cvt_pk_bf16_f32 v231, v238, v239
    s_waitcnt vmcnt(5)
    v_mfma_f32_32x32x16_bf16 v[72:87], v[48:51], v[224:227], v[72:87]
    s_waitcnt vmcnt(4)
    v_mfma_f32_32x32x16_bf16 v[72:87], v[52:55], v[228:231], v[72:87]
    v_fma_f32 v240, v240, s15, v97
    v_fma_f32 v241, v241, s15, v97
    v_fma_f32 v242, v242, s15, v97
    v_fma_f32 v243, v243, s15, v97
    v_fma_f32 v244, v244, s15, v97
    v_fma_f32 v245, v245, s15, v97
    v_fma_f32 v246, v246, s15, v97
    v_fma_f32 v247, v247, s15, v97
    v_fma_f32 v248, v248, s15, v97
    v_fma_f32 v249, v249, s15, v97
    v_fma_f32 v250, v250, s15, v97
    v_fma_f32 v251, v251, s15, v97
    v_fma_f32 v252, v252, s15, v97
    v_fma_f32 v253, v253, s15, v97
    v_fma_f32 v254, v254, s15, v97
    v_fma_f32 v255, v255, s15, v97
    v_exp_f32 v240, v240
    v_exp_f32 v241, v241
    v_exp_f32 v242, v242
    v_exp_f32 v243, v243
    v_exp_f32 v244, v244
    v_exp_f32 v245, v245
    v_exp_f32 v246, v246
    v_exp_f32 v247, v247
    v_exp_f32 v248, v248
    v_exp_f32 v249, v249
    v_exp_f32 v250, v250
    v_exp_f32 v251, v251
    v_exp_f32 v252, v252
    v_exp_f32 v253, v253
    v_exp_f32 v254, v254
    v_exp_f32 v255, v255
    v_cvt_pk_bf16_f32 v240, v240, v241
    v_cvt_pk_bf16_f32 v241, v242, v243
    v_cvt_pk_bf16_f32 v242, v244, v245
    v_cvt_pk_bf16_f32 v243, v246, v247
    v_cvt_pk_bf16_f32 v244, v248, v249
    v_cvt_pk_bf16_f32 v245, v250, v251
    v_cvt_pk_bf16_f32 v246, v252, v253
    v_cvt_pk_bf16_f32 v247, v254, v255
    v_and_b32 v112, v240, v88
    v_xor_b32 v120, v240, v112
    v_and_b32 v113, v241, v89
    v_xor_b32 v121, v241, v113
    v_and_b32 v114, v242, v90
    v_xor_b32 v122, v242, v114
    v_and_b32 v115, v243, v91
    v_xor_b32 v123, v243, v115
    v_and_b32 v116, v244, v92
    v_xor_b32 v124, v244, v116
    v_and_b32 v117, v245, v93
    v_xor_b32 v125, v245, v117
    v_and_b32 v118, v246, v94
    v_xor_b32 v126, v246, v118
    v_and_b32 v119, v247, v95
    v_xor_b32 v127, v247, v119
    s_waitcnt vmcnt(3)
    v_mfma_f32_32x32x16_bf16 v[72:87], v[56:59], v[112:115], v[72:87]
    s_waitcnt vmcnt(2)
    v_mfma_f32_32x32x16_bf16 v[72:87], v[60:63], v[116:119], v[72:87]
    s_waitcnt vmcnt(1)
    v_mfma_f32_32x32x16_bf16 v[72:87], v[64:67], v[120:123], v[72:87]
    s_waitcnt vmcnt(0)
    v_mfma_f32_32x32x16_bf16 v[72:87], v[68:71], v[124:127], v[72:87]
    s_nop 11
    v_rcp_f32 v4, v80
    s_nop 0
    v_mul_f32 v72, v72, v4
    v_mul_f32 v73, v73, v4
    v_mul_f32 v74, v74, v4
    v_mul_f32 v75, v75, v4
    v_mul_f32 v76, v76, v4
    v_mul_f32 v77, v77, v4
    v_mul_f32 v78, v78, v4
    v_mul_f32 v79, v79, v4
    v_cvt_pk_bf16_f32 v12, v72, v73
    v_cvt_pk_bf16_f32 v13, v74, v75
    v_cvt_pk_bf16_f32 v14, v76, v77
    v_cvt_pk_bf16_f32 v15, v78, v79
    s_nop 0
    v_permlane32_swap_b32 v12, v14
    v_permlane32_swap_b32 v13, v15
    v_lshlrev_b32 v5, 10, v2
    v_lshl_add_u32 v5, v3, 4, v5
    s_lshl_b32 s11, s10, 15
    s_lshl_b32 s12, s9, 5
    s_add_u32 s11, s11, s12
    s_add_u32 s11, s11, 0x1000000
    buffer_store_dwordx4 v[12:15], v5, s[4:7], s11 offen
    s_waitcnt vmcnt(0)
    s_nop 0
L_k2_exit:
    s_endpgm
.section .rodata,"a"
.p2align 6
.amdhsa_kernel k2_attn_kernel
  .amdhsa_next_free_vgpr 256
  .amdhsa_next_free_sgpr 102
  .amdhsa_accum_offset 256
  .amdhsa_group_segment_fixed_size 0
  .amdhsa_kernarg_size 80
  .amdhsa_user_sgpr_count 2
  .amdhsa_user_sgpr_kernarg_segment_ptr 1
  .amdhsa_system_sgpr_workgroup_id_x 1
.end_amdhsa_kernel
.text
.p2align 8
.globl k3_out_kernel
.type k3_out_kernel,@function
k3_out_kernel:
    s_cmp_ge_u32 s2, 256
    s_nop 0
    s_cbranch_scc1 L_k3_exit
    s_load_dwordx2 s[40:41], s[0:1], 0
    s_load_dwordx2 s[42:43], s[0:1], 16
    s_load_dwordx2 s[44:45], s[0:1], 48
    s_load_dwordx2 s[46:47], s[0:1], 56
    s_load_dwordx2 s[48:49], s[0:1], 72
    v_and_b32 v1, 63, v0
    v_and_b32 v2, 31, v0
    v_bfe_u32 v3, v0, 5, 1
    v_lshrrev_b32 v4, 6, v0
    s_nop 0
    v_readfirstlane_b32 s24, v4
    s_and_b32 s33, s2, 7
    s_lshl_b32 s33, s33, 2
    s_bfe_u32 s34, s2, 0x20003
    s_add_u32 s25, s33, s34
    s_lshr_b32 s26, s2, 5
    s_waitcnt lgkmcnt(0)
    s_mov_b32 s4, s48
    s_mov_b32 s5, s49
    s_mov_b32 s6, 0x10000000
    s_mov_b32 s7, 0x00020000
    s_mov_b32 s8, s42
    s_mov_b32 s9, s43
    s_mov_b32 s10, 0x80000
    s_mov_b32 s11, 0x00020000
    s_mov_b32 s12, s44
    s_mov_b32 s13, s45
    s_mov_b32 s14, 0x158000
    s_mov_b32 s15, 0x00020000
    s_mov_b32 s16, s40
    s_mov_b32 s17, s41
    s_mov_b32 s18, 0x200000
    s_mov_b32 s19, 0x00020000
    s_mov_b32 s20, s46
    s_mov_b32 s21, s47
    s_mov_b32 s22, 0x200000
    s_mov_b32 s23, 0x00020000
    s_lshr_b32 s33, s24, 1
    s_and_b32 s34, s24, 1
    v_lshlrev_b32 v13, 10, v2
    v_lshl_add_u32 v13, v3, 3, v13
    s_lshl_b32 s35, s25, 16
    s_lshl_b32 s27, s33, 15
    s_add_u32 s35, s35, s27
    s_lshl_b32 s27, s26, 7
    s_add_u32 s35, s35, s27
    s_lshl_b32 s27, s34, 6
    s_add_u32 s35, s35, s27
    v_add_u32 v13, s35, v13
    buffer_load_dwordx2 v[16:17], v13, s[16:19], 0 offen offset:0
    buffer_load_dwordx2 v[18:19], v13, s[16:19], 0 offen offset:16
    buffer_load_dwordx2 v[20:21], v13, s[16:19], 0 offen offset:32
    buffer_load_dwordx2 v[22:23], v13, s[16:19], 0 offen offset:48
    v_lshrrev_b32 v4, 2, v1
    s_lshl_b32 s35, s24, 4
    v_add_u32 v4, s35, v4
    v_lshrrev_b32 v5, 4, v1
    v_xor_b32 v5, v5, v1
    v_and_b32 v5, 3, v5
    v_lshlrev_b32 v5, 4, v5
    v_lshl_add_u32 v7, v4, 10, v5
    s_movk_i32 s35, 2752
    v_mul_lo_u32 v8, v4, s35
    v_add_u32 v8, v8, v5
    v_lshrrev_b32 v4, 2, v1
    v_and_b32 v5, 3, v1
    v_lshlrev_b32 v5, 4, v5
    v_lshl_add_u32 v9, v4, 10, v5
    s_lshl_b32 s35, s26, 7
    s_lshl_b32 s27, s34, 6
    s_add_u32 s35, s35, s27
    v_add_u32 v9, s35, v9
    s_lshl_b32 s31, s24, 10
    s_lshl_b32 s32, s33, 11
    s_lshl_b32 s35, s34, 10
    s_add_u32 s32, s32, s35
    s_add_u32 s32, s32, 65536
    v_bfe_u32 v5, v1, 2, 2
    v_lshlrev_b32 v6, 6, v2
    s_lshl_b32 s35, s33, 11
    v_add_u32 v6, s35, v6
    v_add_u32 v4, 0, v3
    v_xor_b32 v4, v4, v5
    v_lshl_add_u32 v10, v4, 4, v6
    v_add_u32 v4, 2, v3
    v_xor_b32 v4, v4, v5
    v_lshl_add_u32 v11, v4, 4, v6
    v_lshrrev_b32 v4, 5, v1
    v_bfe_u32 v5, v1, 2, 2
    v_lshl_add_u32 v4, v4, 3, v5
    v_lshlrev_b32 v4, 6, v4
    v_bfe_u32 v5, v1, 4, 1
    v_lshl_add_u32 v4, v5, 5, v4
    v_and_b32 v5, 3, v1
    v_lshl_add_u32 v4, v5, 3, v4
    s_lshl_b32 s35, s34, 10
    s_add_u32 s35, s35, 65536
    v_add_u32 v12, s35, v4
    s_lshl_b32 s27, s25, 16
    s_add_u32 s27, s27, 0x1000000
    s_lshl_b32 s30, s33, 14
    s_add_u32 m0, s31, 0
    s_nop 0
    buffer_load_dwordx4 v7, s[4:7], s27 offen lds
    s_add_u32 m0, s32, 0
    s_nop 0
    buffer_load_dwordx4 v9, s[8:11], s30 offen lds
    s_add_u32 s27, s27, 64
    s_add_u32 s30, s30, 32768
    s_add_u32 m0, s31, 4096
    s_nop 0
    buffer_load_dwordx4 v7, s[4:7], s27 offen lds
    s_add_u32 m0, s32, 4096
    s_nop 0
    buffer_load_dwordx4 v9, s[8:11], s30 offen lds
    s_add_u32 s27, s27, 64
    s_add_u32 s30, s30, 32768
    s_add_u32 m0, s31, 8192
    s_nop 0
    buffer_load_dwordx4 v7, s[4:7], s27 offen lds
    s_add_u32 m0, s32, 8192
    s_nop 0
    buffer_load_dwordx4 v9, s[8:11], s30 offen lds
    s_add_u32 s27, s27, 64
    s_add_u32 s30, s30, 32768
    s_add_u32 m0, s31, 12288
    s_nop 0
    buffer_load_dwordx4 v7, s[4:7], s27 offen lds
    s_add_u32 m0, s32, 12288
    s_nop 0
    buffer_load_dwordx4 v9, s[8:11], s30 offen lds
    s_add_u32 s27, s27, 64
    s_add_u32 s30, s30, 32768
    s_add_u32 m0, s31, 16384
    s_nop 0
    buffer_load_dwordx4 v7, s[4:7], s27 offen lds
    s_add_u32 m0, s32, 16384
    s_nop 0
    buffer_load_dwordx4 v9, s[8:11], s30 offen lds
    s_add_u32 s27, s27, 64
    s_add_u32 s30, s30, 32768
    s_add_u32 m0, s31, 20480
    s_nop 0
    buffer_load_dwordx4 v7, s[4:7], s27 offen lds
    s_add_u32 m0, s32, 20480
    s_nop 0
    buffer_load_dwordx4 v9, s[8:11], s30 offen lds
    s_add_u32 s27, s27, 64
    s_add_u32 s30, s30, 32768
    s_add_u32 m0, s31, 24576
    s_nop 0
    buffer_load_dwordx4 v7, s[4:7], s27 offen lds
    s_add_u32 m0, s32, 24576
    s_nop 0
    buffer_load_dwordx4 v9, s[8:11], s30 offen lds
    s_add_u32 s27, s27, 64
    s_add_u32 s30, s30, 32768
    s_add_u32 m0, s31, 28672
    s_nop 0
    buffer_load_dwordx4 v7, s[4:7], s27 offen lds
    s_add_u32 m0, s32, 28672
    s_nop 0
    buffer_load_dwordx4 v9, s[8:11], s30 offen lds
    s_add_u32 s27, s27, 64
    s_add_u32 s30, s30, 32768
    s_add_u32 m0, s31, 32768
    s_nop 0
    buffer_load_dwordx4 v7, s[4:7], s27 offen lds
    s_add_u32 m0, s32, 32768
    s_nop 0
    buffer_load_dwordx4 v9, s[8:11], s30 offen lds
    s_add_u32 s27, s27, 64
    s_add_u32 s30, s30, 32768
    s_add_u32 m0, s31, 36864
    s_nop 0
    buffer_load_dwordx4 v7, s[4:7], s27 offen lds
    s_add_u32 m0, s32, 36864
    s_nop 0
    buffer_load_dwordx4 v9, s[8:11], s30 offen lds
    s_add_u32 s27, s27, 64
    s_add_u32 s30, s30, 32768
    s_add_u32 m0, s31, 40960
    s_nop 0
    buffer_load_dwordx4 v7, s[4:7], s27 offen lds
    s_add_u32 m0, s32, 40960
    s_nop 0
    buffer_load_dwordx4 v9, s[8:11], s30 offen lds
    s_add_u32 s27, s27, 64
    s_add_u32 s30, s30, 32768
    s_add_u32 m0, s31, 45056
    s_nop 0
    buffer_load_dwordx4 v7, s[4:7], s27 offen lds
    s_add_u32 m0, s32, 45056
    s_nop 0
    buffer_load_dwordx4 v9, s[8:11], s30 offen lds
    s_add_u32 s27, s27, 64
    s_add_u32 s30, s30, 32768
    s_add_u32 m0, s31, 49152
    s_nop 0
    buffer_load_dwordx4 v7, s[4:7], s27 offen lds
    s_add_u32 m0, s32, 49152
    s_nop 0
    buffer_load_dwordx4 v9, s[8:11], s30 offen lds
    s_add_u32 s27, s27, 64
    s_add_u32 s30, s30, 32768
    s_add_u32 m0, s31, 53248
    s_nop 0
    buffer_load_dwordx4 v7, s[4:7], s27 offen lds
    s_add_u32 m0, s32, 53248
    s_nop 0
    buffer_load_dwordx4 v9, s[8:11], s30 offen lds
    s_add_u32 s27, s27, 64
    s_add_u32 s30, s30, 32768
    s_waitcnt vmcnt(26)
    s_barrier
    ds_read_b128 v[64:67], v10 offset:0
    ds_read_b64_tr_b16 v[76:77], v12 offset:0
    ds_read_b64_tr_b16 v[78:79], v12 offset:256
    ds_read_b128 v[68:71], v11 offset:0
    ds_read_b64_tr_b16 v[80:81], v12 offset:2048
    ds_read_b64_tr_b16 v[82:83], v12 offset:2304
    s_waitcnt vmcnt(24)
    s_barrier
    ds_read_b128 v[72:75], v10 offset:4096
    ds_read_b64_tr_b16 v[84:85], v12 offset:4096
    ds_read_b64_tr_b16 v[86:87], v12 offset:4352
    s_waitcnt lgkmcnt(6)
    v_mfma_f32_32x32x16_bf16 v[32:47], v[76:79], v[64:67], 0
    s_add_u32 m0, s31, 57344
    s_nop 0
    buffer_load_dwordx4 v7, s[4:7], s27 offen lds
    s_add_u32 m0, s32, 57344
    s_nop 0
    buffer_load_dwordx4 v9, s[8:11], s30 offen lds
    s_add_u32 s27, s27, 64
    s_add_u32 s30, s30, 32768
    s_add_u32 m0, s31, 61440
    s_nop 0
    buffer_load_dwordx4 v7, s[4:7], s27 offen lds
    s_add_u32 m0, s32, 61440
    s_nop 0
    buffer_load_dwordx4 v9, s[8:11], s30 offen lds
    s_add_u32 s27, s27, 64
    s_add_u32 s30, s30, 32768
    ds_read_b128 v[64:67], v11 offset:4096
    ds_read_b64_tr_b16 v[76:77], v12 offset:6144
    ds_read_b64_tr_b16 v[78:79], v12 offset:6400
    s_waitcnt lgkmcnt(6)
    v_mfma_f32_32x32x16_bf16 v[32:47], v[80:83], v[68:71], v[32:47]
    s_waitcnt vmcnt(26)
    s_barrier
    ds_read_b128 v[68:71], v10 offset:8192
    ds_read_b64_tr_b16 v[80:81], v12 offset:8192
    ds_read_b64_tr_b16 v[82:83], v12 offset:8448
    s_waitcnt lgkmcnt(6)
    v_mfma_f32_32x32x16_bf16 v[32:47], v[84:87], v[72:75], v[32:47]
    s_mul_i32 s27, s25, 176128
    s_add_u32 s27, s27, 0x800000
    s_lshr_b32 s30, s24, 1
    s_lshl_b32 s30, s30, 14
    s_add_u32 m0, s31, 0
    s_nop 0
    buffer_load_dwordx4 v8, s[4:7], s27 offen lds
    s_add_u32 m0, s32, 0
    s_nop 0
    buffer_load_dwordx4 v9, s[12:15], s30 offen lds
    s_add_u32 s27, s27, 64
    s_add_u32 s30, s30, 32768
    ds_read_b128 v[72:75], v11 offset:8192
    ds_read_b64_tr_b16 v[84:85], v12 offset:10240
    ds_read_b64_tr_b16 v[86:87], v12 offset:10496
    s_waitcnt lgkmcnt(6)
    v_mfma_f32_32x32x16_bf16 v[32:47], v[76:79], v[64:67], v[32:47]
    s_waitcnt vmcnt(26)
    s_barrier
    ds_read_b128 v[64:67], v10 offset:12288
    ds_read_b64_tr_b16 v[76:77], v12 offset:12288
    ds_read_b64_tr_b16 v[78:79], v12 offset:12544
    s_waitcnt lgkmcnt(6)
    v_mfma_f32_32x32x16_bf16 v[32:47], v[80:83], v[68:71], v[32:47]
    s_add_u32 m0, s31, 4096
    s_nop 0
    buffer_load_dwordx4 v8, s[4:7], s27 offen lds
    s_add_u32 m0, s32, 4096
    s_nop 0
    buffer_load_dwordx4 v9, s[12:15], s30 offen lds
    s_add_u32 s27, s27, 64
    s_add_u32 s30, s30, 32768
    ds_read_b128 v[68:71], v11 offset:12288
    ds_read_b64_tr_b16 v[80:81], v12 offset:14336
    ds_read_b64_tr_b16 v[82:83], v12 offset:14592
    s_waitcnt lgkmcnt(6)
    v_mfma_f32_32x32x16_bf16 v[32:47], v[84:87], v[72:75], v[32:47]
    s_waitcnt vmcnt(26)
    s_barrier
    ds_read_b128 v[72:75], v10 offset:16384
    ds_read_b64_tr_b16 v[84:85], v12 offset:16384
    ds_read_b64_tr_b16 v[86:87], v12 offset:16640
    s_waitcnt lgkmcnt(6)
    v_mfma_f32_32x32x16_bf16 v[32:47], v[76:79], v[64:67], v[32:47]
    s_add_u32 m0, s31, 8192
    s_nop 0
    buffer_load_dwordx4 v8, s[4:7], s27 offen lds
    s_add_u32 m0, s32, 8192
    s_nop 0
    buffer_load_dwordx4 v9, s[12:15], s30 offen lds
    s_add_u32 s27, s27, 64
    s_add_u32 s30, s30, 32768
    ds_read_b128 v[64:67], v11 offset:16384
    ds_read_b64_tr_b16 v[76:77], v12 offset:18432
    ds_read_b64_tr_b16 v[78:79], v12 offset:18688
    s_waitcnt lgkmcnt(6)
    v_mfma_f32_32x32x16_bf16 v[32:47], v[80:83], v[68:71], v[32:47]
    s_waitcnt vmcnt(26)
    s_barrier
    ds_read_b128 v[68:71], v10 offset:20480
    ds_read_b64_tr_b16 v[80:81], v12 offset:20480
    ds_read_b64_tr_b16 v[82:83], v12 offset:20736
    s_waitcnt lgkmcnt(6)
    v_mfma_f32_32x32x16_bf16 v[32:47], v[84:87], v[72:75], v[32:47]
    s_add_u32 m0, s31, 12288
    s_nop 0
    buffer_load_dwordx4 v8, s[4:7], s27 offen lds
    s_add_u32 m0, s32, 12288
    s_nop 0
    buffer_load_dwordx4 v9, s[12:15], s30 offen lds
    s_add_u32 s27, s27, 64
    s_add_u32 s30, s30, 32768
    ds_read_b128 v[72:75], v11 offset:20480
    ds_read_b64_tr_b16 v[84:85], v12 offset:22528
    ds_read_b64_tr_b16 v[86:87], v12 offset:22784
    s_waitcnt lgkmcnt(6)
    v_mfma_f32_32x32x16_bf16 v[32:47], v[76:79], v[64:67], v[32:47]
    s_waitcnt vmcnt(26)
    s_barrier
    ds_read_b128 v[64:67], v10 offset:24576
    ds_read_b64_tr_b16 v[76:77], v12 offset:24576
    ds_read_b64_tr_b16 v[78:79], v12 offset:24832
    s_waitcnt lgkmcnt(6)
    v_mfma_f32_32x32x16_bf16 v[32:47], v[80:83], v[68:71], v[32:47]
    s_add_u32 m0, s31, 16384
    s_nop 0
    buffer_load_dwordx4 v8, s[4:7], s27 offen lds
    s_add_u32 m0, s32, 16384
    s_nop 0
    buffer_load_dwordx4 v9, s[12:15], s30 offen lds
    s_add_u32 s27, s27, 64
    s_add_u32 s30, s30, 32768
    ds_read_b128 v[68:71], v11 offset:24576
    ds_read_b64_tr_b16 v[80:81], v12 offset:26624
    ds_read_b64_tr_b16 v[82:83], v12 offset:26880
    s_waitcnt lgkmcnt(6)
    v_mfma_f32_32x32x16_bf16 v[32:47], v[84:87], v[72:75], v[32:47]
    s_waitcnt vmcnt(26)
    s_barrier
    ds_read_b128 v[72:75], v10 offset:28672
    ds_read_b64_tr_b16 v[84:85], v12 offset:28672
    ds_read_b64_tr_b16 v[86:87], v12 offset:28928
    s_waitcnt lgkmcnt(6)
    v_mfma_f32_32x32x16_bf16 v[32:47], v[76:79], v[64:67], v[32:47]
    s_add_u32 m0, s31, 20480
    s_nop 0
    buffer_load_dwordx4 v8, s[4:7], s27 offen lds
    s_add_u32 m0, s32, 20480
    s_nop 0
    buffer_load_dwordx4 v9, s[12:15], s30 offen lds
    s_add_u32 s27, s27, 64
    s_add_u32 s30, s30, 32768
    ds_read_b128 v[64:67], v11 offset:28672
    ds_read_b64_tr_b16 v[76:77], v12 offset:30720
    ds_read_b64_tr_b16 v[78:79], v12 offset:30976
    s_waitcnt lgkmcnt(6)
    v_mfma_f32_32x32x16_bf16 v[32:47], v[80:83], v[68:71], v[32:47]
    s_waitcnt vmcnt(26)
    s_barrier
    ds_read_b128 v[68:71], v10 offset:32768
    ds_read_b64_tr_b16 v[80:81], v12 offset:32768
    ds_read_b64_tr_b16 v[82:83], v12 offset:33024
    s_waitcnt lgkmcnt(6)
    v_mfma_f32_32x32x16_bf16 v[32:47], v[84:87], v[72:75], v[32:47]
    s_add_u32 m0, s31, 24576
    s_nop 0
    buffer_load_dwordx4 v8, s[4:7], s27 offen lds
    s_add_u32 m0, s32, 24576
    s_nop 0
    buffer_load_dwordx4 v9, s[12:15], s30 offen lds
    s_add_u32 s27, s27, 64
    s_add_u32 s30, s30, 32768
    ds_read_b128 v[72:75], v11 offset:32768
    ds_read_b64_tr_b16 v[84:85], v12 offset:34816
    ds_read_b64_tr_b16 v[86:87], v12 offset:35072
    s_waitcnt lgkmcnt(6)
    v_mfma_f32_32x32x16_bf16 v[32:47], v[76:79], v[64:67], v[32:47]
    s_waitcnt vmcnt(26)
    s_barrier
    ds_read_b128 v[64:67], v10 offset:36864
    ds_read_b64_tr_b16 v[76:77], v12 offset:36864
    ds_read_b64_tr_b16 v[78:79], v12 offset:37120
    s_waitcnt lgkmcnt(6)
    v_mfma_f32_32x32x16_bf16 v[32:47], v[80:83], v[68:71], v[32:47]
    s_add_u32 m0, s31, 28672
    s_nop 0
    buffer_load_dwordx4 v8, s[4:7], s27 offen lds
    s_add_u32 m0, s32, 28672
    s_nop 0
    buffer_load_dwordx4 v9, s[12:15], s30 offen lds
    s_add_u32 s27, s27, 64
    s_add_u32 s30, s30, 32768
    ds_read_b128 v[68:71], v11 offset:36864
    ds_read_b64_tr_b16 v[80:81], v12 offset:38912
    ds_read_b64_tr_b16 v[82:83], v12 offset:39168
    s_waitcnt lgkmcnt(6)
    v_mfma_f32_32x32x16_bf16 v[32:47], v[84:87], v[72:75], v[32:47]
    s_waitcnt vmcnt(26)
    s_barrier
    ds_read_b128 v[72:75], v10 offset:40960
    ds_read_b64_tr_b16 v[84:85], v12 offset:40960
    ds_read_b64_tr_b16 v[86:87], v12 offset:41216
    s_waitcnt lgkmcnt(6)
    v_mfma_f32_32x32x16_bf16 v[32:47], v[76:79], v[64:67], v[32:47]
    s_add_u32 m0, s31, 32768
    s_nop 0
    buffer_load_dwordx4 v8, s[4:7], s27 offen lds
    s_add_u32 m0, s32, 32768
    s_nop 0
    buffer_load_dwordx4 v9, s[12:15], s30 offen lds
    s_add_u32 s27, s27, 64
    s_add_u32 s30, s30, 32768
    ds_read_b128 v[64:67], v11 offset:40960
    ds_read_b64_tr_b16 v[76:77], v12 offset:43008
    ds_read_b64_tr_b16 v[78:79], v12 offset:43264
    s_waitcnt lgkmcnt(6)
    v_mfma_f32_32x32x16_bf16 v[32:47], v[80:83], v[68:71], v[32:47]
    s_waitcnt vmcnt(26)
    s_barrier
    ds_read_b128 v[68:71], v10 offset:45056
    ds_read_b64_tr_b16 v[80:81], v12 offset:45056
    ds_read_b64_tr_b16 v[82:83], v12 offset:45312
    s_waitcnt lgkmcnt(6)
    v_mfma_f32_32x32x16_bf16 v[32:47], v[84:87], v[72:75], v[32:47]
    s_add_u32 m0, s31, 36864
    s_nop 0
    buffer_load_dwordx4 v8, s[4:7], s27 offen lds
    s_add_u32 m0, s32, 36864
    s_nop 0
    buffer_load_dwordx4 v9, s[12:15], s30 offen lds
    s_add_u32 s27, s27, 64
    s_add_u32 s30, s30, 32768
    ds_read_b128 v[72:75], v11 offset:45056
    ds_read_b64_tr_b16 v[84:85], v12 offset:47104
    ds_read_b64_tr_b16 v[86:87], v12 offset:47360
    s_waitcnt lgkmcnt(6)
    v_mfma_f32_32x32x16_bf16 v[32:47], v[76:79], v[64:67], v[32:47]
    s_waitcnt vmcnt(26)
    s_barrier
    ds_read_b128 v[64:67], v10 offset:49152
    ds_read_b64_tr_b16 v[76:77], v12 offset:49152
    ds_read_b64_tr_b16 v[78:79], v12 offset:49408
    s_waitcnt lgkmcnt(6)
    v_mfma_f32_32x32x16_bf16 v[32:47], v[80:83], v[68:71], v[32:47]
    s_add_u32 m0, s31, 40960
    s_nop 0
    buffer_load_dwordx4 v8, s[4:7], s27 offen lds
    s_add_u32 m0, s32, 40960
    s_nop 0
    buffer_load_dwordx4 v9, s[12:15], s30 offen lds
    s_add_u32 s27, s27, 64
    s_add_u32 s30, s30, 32768
    ds_read_b128 v[68:71], v11 offset:49152
    ds_read_b64_tr_b16 v[80:81], v12 offset:51200
    ds_read_b64_tr_b16 v[82:83], v12 offset:51456
    s_waitcnt lgkmcnt(6)
    v_mfma_f32_32x32x16_bf16 v[32:47], v[84:87], v[72:75], v[32:47]
    s_waitcnt vmcnt(26)
    s_barrier
    ds_read_b128 v[72:75], v10 offset:53248
    ds_read_b64_tr_b16 v[84:85], v12 offset:53248
    ds_read_b64_tr_b16 v[86:87], v12 offset:53504
    s_waitcnt lgkmcnt(6)
    v_mfma_f32_32x32x16_bf16 v[32:47], v[76:79], v[64:67], v[32:47]
    s_add_u32 m0, s31, 45056
    s_nop 0
    buffer_load_dwordx4 v8, s[4:7], s27 offen lds
    s_add_u32 m0, s32, 45056
    s_nop 0
    buffer_load_dwordx4 v9, s[12:15], s30 offen lds
    s_add_u32 s27, s27, 64
    s_add_u32 s30, s30, 32768
    ds_read_b128 v[64:67], v11 offset:53248
    ds_read_b64_tr_b16 v[76:77], v12 offset:55296
    ds_read_b64_tr_b16 v[78:79], v12 offset:55552
    s_waitcnt lgkmcnt(6)
    v_mfma_f32_32x32x16_bf16 v[32:47], v[80:83], v[68:71], v[32:47]
    s_barrier
    ds_read_b128 v[68:71], v10 offset:57344
    ds_read_b64_tr_b16 v[80:81], v12 offset:57344
    ds_read_b64_tr_b16 v[82:83], v12 offset:57600
    s_waitcnt lgkmcnt(6)
    v_mfma_f32_32x32x16_bf16 v[32:47], v[84:87], v[72:75], v[32:47]
    s_add_u32 m0, s31, 49152
    s_nop 0
    buffer_load_dwordx4 v8, s[4:7], s27 offen lds
    s_add_u32 m0, s32, 49152
    s_nop 0
    buffer_load_dwordx4 v9, s[12:15], s30 offen lds
    s_add_u32 s27, s27, 64
    s_add_u32 s30, s30, 32768
    ds_read_b128 v[72:75], v11 offset:57344
    ds_read_b64_tr_b16 v[84:85], v12 offset:59392
    ds_read_b64_tr_b16 v[86:87], v12 offset:59648
    s_waitcnt lgkmcnt(6)
    v_mfma_f32_32x32x16_bf16 v[32:47], v[76:79], v[64:67], v[32:47]
    s_waitcnt vmcnt(26)
    s_barrier
    ds_read_b128 v[64:67], v10 offset:61440
    ds_read_b64_tr_b16 v[76:77], v12 offset:61440
    ds_read_b64_tr_b16 v[78:79], v12 offset:61696
    s_waitcnt lgkmcnt(6)
    v_mfma_f32_32x32x16_bf16 v[32:47], v[80:83], v[68:71], v[32:47]
    s_add_u32 m0, s31, 53248
    s_nop 0
    buffer_load_dwordx4 v8, s[4:7], s27 offen lds
    s_add_u32 m0, s32, 53248
    s_nop 0
    buffer_load_dwordx4 v9, s[12:15], s30 offen lds
    s_add_u32 s27, s27, 64
    s_add_u32 s30, s30, 32768
    ds_read_b128 v[68:71], v11 offset:61440
    ds_read_b64_tr_b16 v[80:81], v12 offset:63488
    ds_read_b64_tr_b16 v[82:83], v12 offset:63744
    s_waitcnt lgkmcnt(6)
    v_mfma_f32_32x32x16_bf16 v[32:47], v[84:87], v[72:75], v[32:47]
    s_waitcnt vmcnt(26)
    s_barrier
    ds_read_b128 v[72:75], v10 offset:0
    ds_read_b64_tr_b16 v[84:85], v12 offset:0
    ds_read_b64_tr_b16 v[86:87], v12 offset:256
    s_waitcnt lgkmcnt(6)
    v_mfma_f32_32x32x16_bf16 v[32:47], v[76:79], v[64:67], v[32:47]
    s_add_u32 m0, s31, 57344
    s_nop 0
    buffer_load_dwordx4 v8, s[4:7], s27 offen lds
    s_add_u32 m0, s32, 57344
    s_nop 0
    buffer_load_dwordx4 v9, s[12:15], s30 offen lds
    s_add_u32 s27, s27, 64
    s_add_u32 s30, s30, 32768
    ds_read_b128 v[64:67], v11 offset:0
    ds_read_b64_tr_b16 v[76:77], v12 offset:2048
    ds_read_b64_tr_b16 v[78:79], v12 offset:2304
    s_waitcnt lgkmcnt(6)
    v_mfma_f32_32x32x16_bf16 v[32:47], v[80:83], v[68:71], v[32:47]
    s_waitcnt vmcnt(26)
    s_barrier
    ds_read_b128 v[68:71], v10 offset:4096
    ds_read_b64_tr_b16 v[80:81], v12 offset:4096
    ds_read_b64_tr_b16 v[82:83], v12 offset:4352
    s_waitcnt lgkmcnt(6)
    v_mfma_f32_32x32x16_bf16 v[48:63], v[84:87], v[72:75], 0
    s_add_u32 m0, s31, 61440
    s_nop 0
    buffer_load_dwordx4 v8, s[4:7], s27 offen lds
    s_add_u32 m0, s32, 61440
    s_nop 0
    buffer_load_dwordx4 v9, s[12:15], s30 offen lds
    s_add_u32 s27, s27, 64
    s_add_u32 s30, s30, 32768
    ds_read_b128 v[72:75], v11 offset:4096
    ds_read_b64_tr_b16 v[84:85], v12 offset:6144
    ds_read_b64_tr_b16 v[86:87], v12 offset:6400
    s_waitcnt lgkmcnt(6)
    v_mfma_f32_32x32x16_bf16 v[48:63], v[76:79], v[64:67], v[48:63]
    s_waitcnt vmcnt(26)
    s_barrier
    ds_read_b128 v[64:67], v10 offset:8192
    ds_read_b64_tr_b16 v[76:77], v12 offset:8192
    ds_read_b64_tr_b16 v[78:79], v12 offset:8448
    s_waitcnt lgkmcnt(6)
    v_mfma_f32_32x32x16_bf16 v[48:63], v[80:83], v[68:71], v[48:63]
    s_add_u32 m0, s31, 0
    s_nop 0
    buffer_load_dwordx4 v8, s[4:7], s27 offen lds
    s_add_u32 m0, s32, 0
    s_nop 0
    buffer_load_dwordx4 v9, s[12:15], s30 offen lds
    s_add_u32 s27, s27, 64
    s_add_u32 s30, s30, 32768
    ds_read_b128 v[68:71], v11 offset:8192
    ds_read_b64_tr_b16 v[80:81], v12 offset:10240
    ds_read_b64_tr_b16 v[82:83], v12 offset:10496
    s_waitcnt lgkmcnt(6)
    v_mfma_f32_32x32x16_bf16 v[48:63], v[84:87], v[72:75], v[48:63]
    s_waitcnt vmcnt(26)
    s_barrier
    ds_read_b128 v[72:75], v10 offset:12288
    ds_read_b64_tr_b16 v[84:85], v12 offset:12288
    ds_read_b64_tr_b16 v[86:87], v12 offset:12544
    s_waitcnt lgkmcnt(6)
    v_mfma_f32_32x32x16_bf16 v[48:63], v[76:79], v[64:67], v[48:63]
    s_add_u32 m0, s31, 4096
    s_nop 0
    buffer_load_dwordx4 v8, s[4:7], s27 offen lds
    s_add_u32 m0, s32, 4096
    s_nop 0
    buffer_load_dwordx4 v9, s[12:15], s30 offen lds
    s_add_u32 s27, s27, 64
    s_add_u32 s30, s30, 32768
    ds_read_b128 v[64:67], v11 offset:12288
    ds_read_b64_tr_b16 v[76:77], v12 offset:14336
    ds_read_b64_tr_b16 v[78:79], v12 offset:14592
    s_waitcnt lgkmcnt(6)
    v_mfma_f32_32x32x16_bf16 v[48:63], v[80:83], v[68:71], v[48:63]
    s_waitcnt vmcnt(26)
    s_barrier
    ds_read_b128 v[68:71], v10 offset:16384
    ds_read_b64_tr_b16 v[80:81], v12 offset:16384
    ds_read_b64_tr_b16 v[82:83], v12 offset:16640
    s_waitcnt lgkmcnt(6)
    v_mfma_f32_32x32x16_bf16 v[48:63], v[84:87], v[72:75], v[48:63]
    s_add_u32 m0, s31, 8192
    s_nop 0
    buffer_load_dwordx4 v8, s[4:7], s27 offen lds
    s_add_u32 m0, s32, 8192
    s_nop 0
    buffer_load_dwordx4 v9, s[12:15], s30 offen lds
    s_add_u32 s27, s27, 64
    s_add_u32 s30, s30, 32768
    ds_read_b128 v[72:75], v11 offset:16384
    ds_read_b64_tr_b16 v[84:85], v12 offset:18432
    ds_read_b64_tr_b16 v[86:87], v12 offset:18688
    s_waitcnt lgkmcnt(6)
    v_mfma_f32_32x32x16_bf16 v[48:63], v[76:79], v[64:67], v[48:63]
    s_waitcnt vmcnt(26)
    s_barrier
    ds_read_b128 v[64:67], v10 offset:20480
    ds_read_b64_tr_b16 v[76:77], v12 offset:20480
    ds_read_b64_tr_b16 v[78:79], v12 offset:20736
    s_waitcnt lgkmcnt(6)
    v_mfma_f32_32x32x16_bf16 v[48:63], v[80:83], v[68:71], v[48:63]
    s_add_u32 m0, s31, 12288
    s_nop 0
    buffer_load_dwordx4 v8, s[4:7], s27 offen lds
    s_add_u32 m0, s32, 12288
    s_nop 0
    buffer_load_dwordx4 v9, s[12:15], s30 offen lds
    s_add_u32 s27, s27, 64
    s_add_u32 s30, s30, 32768
    ds_read_b128 v[68:71], v11 offset:20480
    ds_read_b64_tr_b16 v[80:81], v12 offset:22528
    ds_read_b64_tr_b16 v[82:83], v12 offset:22784
    s_waitcnt lgkmcnt(6)
    v_mfma_f32_32x32x16_bf16 v[48:63], v[84:87], v[72:75], v[48:63]
    s_waitcnt vmcnt(26)
    s_barrier
    ds_read_b128 v[72:75], v10 offset:24576
    ds_read_b64_tr_b16 v[84:85], v12 offset:24576
    ds_read_b64_tr_b16 v[86:87], v12 offset:24832
    s_waitcnt lgkmcnt(6)
    v_mfma_f32_32x32x16_bf16 v[48:63], v[76:79], v[64:67], v[48:63]
    s_add_u32 m0, s31, 16384
    s_nop 0
    buffer_load_dwordx4 v8, s[4:7], s27 offen lds
    s_add_u32 m0, s32, 16384
    s_nop 0
    buffer_load_dwordx4 v9, s[12:15], s30 offen lds
    s_add_u32 s27, s27, 64
    s_add_u32 s30, s30, 32768
    ds_read_b128 v[64:67], v11 offset:24576
    ds_read_b64_tr_b16 v[76:77], v12 offset:26624
    ds_read_b64_tr_b16 v[78:79], v12 offset:26880
    s_waitcnt lgkmcnt(6)
    v_mfma_f32_32x32x16_bf16 v[48:63], v[80:83], v[68:71], v[48:63]
    s_waitcnt vmcnt(26)
    s_barrier
    ds_read_b128 v[68:71], v10 offset:28672
    ds_read_b64_tr_b16 v[80:81], v12 offset:28672
    ds_read_b64_tr_b16 v[82:83], v12 offset:28928
    s_waitcnt lgkmcnt(6)
    v_mfma_f32_32x32x16_bf16 v[48:63], v[84:87], v[72:75], v[48:63]
    s_add_u32 m0, s31, 20480
    s_nop 0
    buffer_load_dwordx4 v8, s[4:7], s27 offen lds
    s_add_u32 m0, s32, 20480
    s_nop 0
    buffer_load_dwordx4 v9, s[12:15], s30 offen lds
    s_add_u32 s27, s27, 64
    s_add_u32 s30, s30, 32768
    ds_read_b128 v[72:75], v11 offset:28672
    ds_read_b64_tr_b16 v[84:85], v12 offset:30720
    ds_read_b64_tr_b16 v[86:87], v12 offset:30976
    s_waitcnt lgkmcnt(6)
    v_mfma_f32_32x32x16_bf16 v[48:63], v[76:79], v[64:67], v[48:63]
    s_waitcnt vmcnt(26)
    s_barrier
    ds_read_b128 v[64:67], v10 offset:32768
    ds_read_b64_tr_b16 v[76:77], v12 offset:32768
    ds_read_b64_tr_b16 v[78:79], v12 offset:33024
    s_waitcnt lgkmcnt(6)
    v_mfma_f32_32x32x16_bf16 v[48:63], v[80:83], v[68:71], v[48:63]
    s_add_u32 m0, s31, 24576
    s_nop 0
    buffer_load_dwordx4 v8, s[4:7], s27 offen lds
    s_add_u32 m0, s32, 24576
    s_nop 0
    buffer_load_dwordx4 v9, s[12:15], s30 offen lds
    s_add_u32 s27, s27, 64
    s_add_u32 s30, s30, 32768
    ds_read_b128 v[68:71], v11 offset:32768
    ds_read_b64_tr_b16 v[80:81], v12 offset:34816
    ds_read_b64_tr_b16 v[82:83], v12 offset:35072
    s_waitcnt lgkmcnt(6)
    v_mfma_f32_32x32x16_bf16 v[48:63], v[84:87], v[72:75], v[48:63]
    s_waitcnt vmcnt(26)
    s_barrier
    ds_read_b128 v[72:75], v10 offset:36864
    ds_read_b64_tr_b16 v[84:85], v12 offset:36864
    ds_read_b64_tr_b16 v[86:87], v12 offset:37120
    s_waitcnt lgkmcnt(6)
    v_mfma_f32_32x32x16_bf16 v[48:63], v[76:79], v[64:67], v[48:63]
    s_add_u32 m0, s31, 28672
    s_nop 0
    buffer_load_dwordx4 v8, s[4:7], s27 offen lds
    s_add_u32 m0, s32, 28672
    s_nop 0
    buffer_load_dwordx4 v9, s[12:15], s30 offen lds
    s_add_u32 s27, s27, 64
    s_add_u32 s30, s30, 32768
    ds_read_b128 v[64:67], v11 offset:36864
    ds_read_b64_tr_b16 v[76:77], v12 offset:38912
    ds_read_b64_tr_b16 v[78:79], v12 offset:39168
    s_waitcnt lgkmcnt(6)
    v_mfma_f32_32x32x16_bf16 v[48:63], v[80:83], v[68:71], v[48:63]
    s_waitcnt vmcnt(26)
    s_barrier
    ds_read_b128 v[68:71], v10 offset:40960
    ds_read_b64_tr_b16 v[80:81], v12 offset:40960
    ds_read_b64_tr_b16 v[82:83], v12 offset:41216
    s_waitcnt lgkmcnt(6)
    v_mfma_f32_32x32x16_bf16 v[48:63], v[84:87], v[72:75], v[48:63]
    s_add_u32 m0, s31, 32768
    s_nop 0
    buffer_load_dwordx4 v8, s[4:7], s27 offen lds
    s_add_u32 m0, s32, 32768
    s_nop 0
    buffer_load_dwordx4 v9, s[12:15], s30 offen lds
    s_add_u32 s27, s27, 64
    s_add_u32 s30, s30, 32768
    ds_read_b128 v[72:75], v11 offset:40960
    ds_read_b64_tr_b16 v[84:85], v12 offset:43008
    ds_read_b64_tr_b16 v[86:87], v12 offset:43264
    s_waitcnt lgkmcnt(6)
    v_mfma_f32_32x32x16_bf16 v[48:63], v[76:79], v[64:67], v[48:63]
    s_waitcnt vmcnt(26)
    s_barrier
    ds_read_b128 v[64:67], v10 offset:45056
    ds_read_b64_tr_b16 v[76:77], v12 offset:45056
    ds_read_b64_tr_b16 v[78:79], v12 offset:45312
    s_waitcnt lgkmcnt(6)
    v_mfma_f32_32x32x16_bf16 v[48:63], v[80:83], v[68:71], v[48:63]
    s_add_u32 m0, s31, 36864
    s_nop 0
    buffer_load_dwordx4 v8, s[4:7], s27 offen lds
    s_add_u32 m0, s32, 36864
    s_nop 0
    buffer_load_dwordx4 v9, s[12:15], s30 offen lds
    s_add_u32 s27, s27, 64
    s_add_u32 s30, s30, 32768
    ds_read_b128 v[68:71], v11 offset:45056
    ds_read_b64_tr_b16 v[80:81], v12 offset:47104
    ds_read_b64_tr_b16 v[82:83], v12 offset:47360
    s_waitcnt lgkmcnt(6)
    v_mfma_f32_32x32x16_bf16 v[48:63], v[84:87], v[72:75], v[48:63]
    s_waitcnt vmcnt(26)
    s_barrier
    ds_read_b128 v[72:75], v10 offset:49152
    ds_read_b64_tr_b16 v[84:85], v12 offset:49152
    ds_read_b64_tr_b16 v[86:87], v12 offset:49408
    s_waitcnt lgkmcnt(6)
    v_mfma_f32_32x32x16_bf16 v[48:63], v[76:79], v[64:67], v[48:63]
    s_add_u32 m0, s31, 40960
    s_nop 0
    buffer_load_dwordx4 v8, s[4:7], s27 offen lds
    s_add_u32 m0, s32, 40960
    s_nop 0
    buffer_load_dwordx4 v9, s[12:15], s30 offen lds
    s_add_u32 s27, s27, 64
    s_add_u32 s30, s30, 32768
    ds_read_b128 v[64:67], v11 offset:49152
    ds_read_b64_tr_b16 v[76:77], v12 offset:51200
    ds_read_b64_tr_b16 v[78:79], v12 offset:51456
    s_waitcnt lgkmcnt(6)
    v_mfma_f32_32x32x16_bf16 v[48:63], v[80:83], v[68:71], v[48:63]
    s_waitcnt vmcnt(26)
    s_barrier
    ds_read_b128 v[68:71], v10 offset:53248
    ds_read_b64_tr_b16 v[80:81], v12 offset:53248
    ds_read_b64_tr_b16 v[82:83], v12 offset:53504
    s_waitcnt lgkmcnt(6)
    v_mfma_f32_32x32x16_bf16 v[48:63], v[84:87], v[72:75], v[48:63]
    s_add_u32 m0, s31, 45056
    s_nop 0
    buffer_load_dwordx4 v8, s[4:7], s27 offen lds
    s_add_u32 m0, s32, 45056
    s_nop 0
    buffer_load_dwordx4 v9, s[12:15], s30 offen lds
    s_add_u32 s27, s27, 64
    s_add_u32 s30, s30, 32768
    ds_read_b128 v[72:75], v11 offset:53248
    ds_read_b64_tr_b16 v[84:85], v12 offset:55296
    ds_read_b64_tr_b16 v[86:87], v12 offset:55552
    s_waitcnt lgkmcnt(6)
    v_mfma_f32_32x32x16_bf16 v[48:63], v[76:79], v[64:67], v[48:63]
    s_waitcnt vmcnt(26)
    s_barrier
    ds_read_b128 v[64:67], v10 offset:57344
    ds_read_b64_tr_b16 v[76:77], v12 offset:57344
    ds_read_b64_tr_b16 v[78:79], v12 offset:57600
    s_waitcnt lgkmcnt(6)
    v_mfma_f32_32x32x16_bf16 v[48:63], v[80:83], v[68:71], v[48:63]
    s_add_u32 m0, s31, 49152
    s_nop 0
    buffer_load_dwordx4 v8, s[4:7], s27 offen lds
    s_add_u32 m0, s32, 49152
    s_nop 0
    buffer_load_dwordx4 v9, s[12:15], s30 offen lds
    s_add_u32 s27, s27, 64
    s_add_u32 s30, s30, 32768
    ds_read_b128 v[68:71], v11 offset:57344
    ds_read_b64_tr_b16 v[80:81], v12 offset:59392
    ds_read_b64_tr_b16 v[82:83], v12 offset:59648
    s_waitcnt lgkmcnt(6)
    v_mfma_f32_32x32x16_bf16 v[48:63], v[84:87], v[72:75], v[48:63]
    s_waitcnt vmcnt(26)
    s_barrier
    ds_read_b128 v[72:75], v10 offset:61440
    ds_read_b64_tr_b16 v[84:85], v12 offset:61440
    ds_read_b64_tr_b16 v[86:87], v12 offset:61696
    s_waitcnt lgkmcnt(6)
    v_mfma_f32_32x32x16_bf16 v[48:63], v[76:79], v[64:67], v[48:63]
    s_add_u32 m0, s31, 53248
    s_nop 0
    buffer_load_dwordx4 v8, s[4:7], s27 offen lds
    s_add_u32 m0, s32, 53248
    s_nop 0
    buffer_load_dwordx4 v9, s[12:15], s30 offen lds
    s_add_u32 s27, s27, 64
    s_add_u32 s30, s30, 32768
    ds_read_b128 v[64:67], v11 offset:61440
    ds_read_b64_tr_b16 v[76:77], v12 offset:63488
    ds_read_b64_tr_b16 v[78:79], v12 offset:63744
    s_waitcnt lgkmcnt(6)
    v_mfma_f32_32x32x16_bf16 v[48:63], v[80:83], v[68:71], v[48:63]
    s_waitcnt vmcnt(26)
    s_barrier
    ds_read_b128 v[68:71], v10 offset:0
    ds_read_b64_tr_b16 v[80:81], v12 offset:0
    ds_read_b64_tr_b16 v[82:83], v12 offset:256
    s_waitcnt lgkmcnt(6)
    v_mfma_f32_32x32x16_bf16 v[48:63], v[84:87], v[72:75], v[48:63]
    s_add_u32 m0, s31, 57344
    s_nop 0
    buffer_load_dwordx4 v8, s[4:7], s27 offen lds
    s_add_u32 m0, s32, 57344
    s_nop 0
    buffer_load_dwordx4 v9, s[12:15], s30 offen lds
    s_add_u32 s27, s27, 64
    s_add_u32 s30, s30, 32768
    ds_read_b128 v[72:75], v11 offset:0
    ds_read_b64_tr_b16 v[84:85], v12 offset:2048
    ds_read_b64_tr_b16 v[86:87], v12 offset:2304
    s_waitcnt lgkmcnt(6)
    v_mfma_f32_32x32x16_bf16 v[48:63], v[76:79], v[64:67], v[48:63]
    s_waitcnt vmcnt(26)
    s_barrier
    ds_read_b128 v[64:67], v10 offset:4096
    ds_read_b64_tr_b16 v[76:77], v12 offset:4096
    ds_read_b64_tr_b16 v[78:79], v12 offset:4352
    s_waitcnt lgkmcnt(6)
    v_mfma_f32_32x32x16_bf16 v[48:63], v[80:83], v[68:71], v[48:63]
    s_add_u32 m0, s31, 61440
    s_nop 0
    buffer_load_dwordx4 v8, s[4:7], s27 offen lds
    s_add_u32 m0, s32, 61440
    s_nop 0
    buffer_load_dwordx4 v9, s[12:15], s30 offen lds
    s_add_u32 s27, s27, 64
    s_add_u32 s30, s30, 32768
    ds_read_b128 v[68:71], v11 offset:4096
    ds_read_b64_tr_b16 v[80:81], v12 offset:6144
    ds_read_b64_tr_b16 v[82:83], v12 offset:6400
    s_waitcnt lgkmcnt(6)
    v_mfma_f32_32x32x16_bf16 v[48:63], v[84:87], v[72:75], v[48:63]
    s_waitcnt vmcnt(26)
    s_barrier
    ds_read_b128 v[72:75], v10 offset:8192
    ds_read_b64_tr_b16 v[84:85], v12 offset:8192
    ds_read_b64_tr_b16 v[86:87], v12 offset:8448
    s_waitcnt lgkmcnt(6)
    v_mfma_f32_32x32x16_bf16 v[48:63], v[76:79], v[64:67], v[48:63]
    s_add_u32 m0, s31, 0
    s_nop 0
    buffer_load_dwordx4 v8, s[4:7], s27 offen lds
    s_add_u32 m0, s32, 0
    s_nop 0
    buffer_load_dwordx4 v9, s[12:15], s30 offen lds
    s_add_u32 s27, s27, 64
    s_add_u32 s30, s30, 32768
    ds_read_b128 v[64:67], v11 offset:8192
    ds_read_b64_tr_b16 v[76:77], v12 offset:10240
    ds_read_b64_tr_b16 v[78:79], v12 offset:10496
    s_waitcnt lgkmcnt(6)
    v_mfma_f32_32x32x16_bf16 v[48:63], v[80:83], v[68:71], v[48:63]
    s_waitcnt vmcnt(26)
    s_barrier
    ds_read_b128 v[68:71], v10 offset:12288
    ds_read_b64_tr_b16 v[80:81], v12 offset:12288
    ds_read_b64_tr_b16 v[82:83], v12 offset:12544
    s_waitcnt lgkmcnt(6)
    v_mfma_f32_32x32x16_bf16 v[48:63], v[84:87], v[72:75], v[48:63]
    s_add_u32 m0, s31, 4096
    s_nop 0
    buffer_load_dwordx4 v8, s[4:7], s27 offen lds
    s_add_u32 m0, s32, 4096
    s_nop 0
    buffer_load_dwordx4 v9, s[12:15], s30 offen lds
    s_add_u32 s27, s27, 64
    s_add_u32 s30, s30, 32768
    ds_read_b128 v[72:75], v11 offset:12288
    ds_read_b64_tr_b16 v[84:85], v12 offset:14336
    ds_read_b64_tr_b16 v[86:87], v12 offset:14592
    s_waitcnt lgkmcnt(6)
    v_mfma_f32_32x32x16_bf16 v[48:63], v[76:79], v[64:67], v[48:63]
    s_waitcnt vmcnt(26)
    s_barrier
    ds_read_b128 v[64:67], v10 offset:16384
    ds_read_b64_tr_b16 v[76:77], v12 offset:16384
    ds_read_b64_tr_b16 v[78:79], v12 offset:16640
    s_waitcnt lgkmcnt(6)
    v_mfma_f32_32x32x16_bf16 v[48:63], v[80:83], v[68:71], v[48:63]
    s_add_u32 m0, s31, 8192
    s_nop 0
    buffer_load_dwordx4 v8, s[4:7], s27 offen lds
    s_add_u32 m0, s32, 8192
    s_nop 0
    buffer_load_dwordx4 v9, s[12:15], s30 offen lds
    s_add_u32 s27, s27, 64
    s_add_u32 s30, s30, 32768
    ds_read_b128 v[68:71], v11 offset:16384
    ds_read_b64_tr_b16 v[80:81], v12 offset:18432
    ds_read_b64_tr_b16 v[82:83], v12 offset:18688
    s_waitcnt lgkmcnt(6)
    v_mfma_f32_32x32x16_bf16 v[48:63], v[84:87], v[72:75], v[48:63]
    s_waitcnt vmcnt(26)
    s_barrier
    ds_read_b128 v[72:75], v10 offset:20480
    ds_read_b64_tr_b16 v[84:85], v12 offset:20480
    ds_read_b64_tr_b16 v[86:87], v12 offset:20736
    s_waitcnt lgkmcnt(6)
    v_mfma_f32_32x32x16_bf16 v[48:63], v[76:79], v[64:67], v[48:63]
    s_add_u32 m0, s31, 12288
    s_nop 0
    buffer_load_dwordx4 v8, s[4:7], s27 offen lds
    s_add_u32 m0, s32, 12288
    s_nop 0
    buffer_load_dwordx4 v9, s[12:15], s30 offen lds
    s_add_u32 s27, s27, 64
    s_add_u32 s30, s30, 32768
    ds_read_b128 v[64:67], v11 offset:20480
    ds_read_b64_tr_b16 v[76:77], v12 offset:22528
    ds_read_b64_tr_b16 v[78:79], v12 offset:22784
    s_waitcnt lgkmcnt(6)
    v_mfma_f32_32x32x16_bf16 v[48:63], v[80:83], v[68:71], v[48:63]
    s_waitcnt vmcnt(26)
    s_barrier
    ds_read_b128 v[68:71], v10 offset:24576
    ds_read_b64_tr_b16 v[80:81], v12 offset:24576
    ds_read_b64_tr_b16 v[82:83], v12 offset:24832
    s_waitcnt lgkmcnt(6)
    v_mfma_f32_32x32x16_bf16 v[48:63], v[84:87], v[72:75], v[48:63]
    s_add_u32 m0, s31, 16384
    s_nop 0
    buffer_load_dwordx4 v8, s[4:7], s27 offen lds
    s_add_u32 m0, s32, 16384
    s_nop 0
    buffer_load_dwordx4 v9, s[12:15], s30 offen lds
    s_add_u32 s27, s27, 64
    s_add_u32 s30, s30, 32768
    ds_read_b128 v[72:75], v11 offset:24576
    ds_read_b64_tr_b16 v[84:85], v12 offset:26624
    ds_read_b64_tr_b16 v[86:87], v12 offset:26880
    s_waitcnt lgkmcnt(6)
    v_mfma_f32_32x32x16_bf16 v[48:63], v[76:79], v[64:67], v[48:63]
    s_waitcnt vmcnt(26)
    s_barrier
    ds_read_b128 v[64:67], v10 offset:28672
    ds_read_b64_tr_b16 v[76:77], v12 offset:28672
    ds_read_b64_tr_b16 v[78:79], v12 offset:28928
    s_waitcnt lgkmcnt(6)
    v_mfma_f32_32x32x16_bf16 v[48:63], v[80:83], v[68:71], v[48:63]
    s_add_u32 m0, s31, 20480
    s_nop 0
    buffer_load_dwordx4 v8, s[4:7], s27 offen lds
    s_add_u32 m0, s32, 20480
    s_nop 0
    buffer_load_dwordx4 v9, s[12:15], s30 offen lds
    s_add_u32 s27, s27, 64
    s_add_u32 s30, s30, 32768
    ds_read_b128 v[68:71], v11 offset:28672
    ds_read_b64_tr_b16 v[80:81], v12 offset:30720
    ds_read_b64_tr_b16 v[82:83], v12 offset:30976
    s_waitcnt lgkmcnt(6)
    v_mfma_f32_32x32x16_bf16 v[48:63], v[84:87], v[72:75], v[48:63]
    s_waitcnt vmcnt(26)
    s_barrier
    ds_read_b128 v[72:75], v10 offset:32768
    ds_read_b64_tr_b16 v[84:85], v12 offset:32768
    ds_read_b64_tr_b16 v[86:87], v12 offset:33024
    s_waitcnt lgkmcnt(6)
    v_mfma_f32_32x32x16_bf16 v[48:63], v[76:79], v[64:67], v[48:63]
    s_add_u32 m0, s31, 24576
    s_nop 0
    buffer_load_dwordx4 v8, s[4:7], s27 offen lds
    s_add_u32 m0, s32, 24576
    s_nop 0
    buffer_load_dwordx4 v9, s[12:15], s30 offen lds
    s_add_u32 s27, s27, 64
    s_add_u32 s30, s30, 32768
    ds_read_b128 v[64:67], v11 offset:32768
    ds_read_b64_tr_b16 v[76:77], v12 offset:34816
    ds_read_b64_tr_b16 v[78:79], v12 offset:35072
    s_waitcnt lgkmcnt(6)
    v_mfma_f32_32x32x16_bf16 v[48:63], v[80:83], v[68:71], v[48:63]
    s_waitcnt vmcnt(26)
    s_barrier
    ds_read_b128 v[68:71], v10 offset:36864
    ds_read_b64_tr_b16 v[80:81], v12 offset:36864
    ds_read_b64_tr_b16 v[82:83], v12 offset:37120
    s_waitcnt lgkmcnt(6)
    v_mfma_f32_32x32x16_bf16 v[48:63], v[84:87], v[72:75], v[48:63]
    s_add_u32 m0, s31, 28672
    s_nop 0
    buffer_load_dwordx4 v8, s[4:7], s27 offen lds
    s_add_u32 m0, s32, 28672
    s_nop 0
    buffer_load_dwordx4 v9, s[12:15], s30 offen lds
    s_add_u32 s27, s27, 64
    s_add_u32 s30, s30, 32768
    ds_read_b128 v[72:75], v11 offset:36864
    ds_read_b64_tr_b16 v[84:85], v12 offset:38912
    ds_read_b64_tr_b16 v[86:87], v12 offset:39168
    s_waitcnt lgkmcnt(6)
    v_mfma_f32_32x32x16_bf16 v[48:63], v[76:79], v[64:67], v[48:63]
    s_waitcnt vmcnt(26)
    s_barrier
    ds_read_b128 v[64:67], v10 offset:40960
    ds_read_b64_tr_b16 v[76:77], v12 offset:40960
    ds_read_b64_tr_b16 v[78:79], v12 offset:41216
    s_waitcnt lgkmcnt(6)
    v_mfma_f32_32x32x16_bf16 v[48:63], v[80:83], v[68:71], v[48:63]
    s_add_u32 m0, s31, 32768
    s_nop 0
    buffer_load_dwordx4 v8, s[4:7], s27 offen lds
    s_add_u32 m0, s32, 32768
    s_nop 0
    buffer_load_dwordx4 v9, s[12:15], s30 offen lds
    s_add_u32 s27, s27, 64
    s_add_u32 s30, s30, 32768
    ds_read_b128 v[68:71], v11 offset:40960
    ds_read_b64_tr_b16 v[80:81], v12 offset:43008
    ds_read_b64_tr_b16 v[82:83], v12 offset:43264
    s_waitcnt lgkmcnt(6)
    v_mfma_f32_32x32x16_bf16 v[48:63], v[84:87], v[72:75], v[48:63]
    s_waitcnt vmcnt(26)
    s_barrier
    ds_read_b128 v[72:75], v10 offset:45056
    ds_read_b64_tr_b16 v[84:85], v12 offset:45056
    ds_read_b64_tr_b16 v[86:87], v12 offset:45312
    s_waitcnt lgkmcnt(6)
    v_mfma_f32_32x32x16_bf16 v[48:63], v[76:79], v[64:67], v[48:63]
    s_add_u32 m0, s31, 36864
    s_nop 0
    buffer_load_dwordx4 v8, s[4:7], s27 offen lds
    s_add_u32 m0, s32, 36864
    s_nop 0
    buffer_load_dwordx4 v9, s[12:15], s30 offen lds
    s_add_u32 s27, s27, 64
    s_add_u32 s30, s30, 32768
    ds_read_b128 v[64:67], v11 offset:45056
    ds_read_b64_tr_b16 v[76:77], v12 offset:47104
    ds_read_b64_tr_b16 v[78:79], v12 offset:47360
    s_waitcnt lgkmcnt(6)
    v_mfma_f32_32x32x16_bf16 v[48:63], v[80:83], v[68:71], v[48:63]
    s_waitcnt vmcnt(26)
    s_barrier
    ds_read_b128 v[68:71], v10 offset:49152
    ds_read_b64_tr_b16 v[80:81], v12 offset:49152
    ds_read_b64_tr_b16 v[82:83], v12 offset:49408
    s_waitcnt lgkmcnt(6)
    v_mfma_f32_32x32x16_bf16 v[48:63], v[84:87], v[72:75], v[48:63]
    s_add_u32 m0, s31, 40960
    s_nop 0
    buffer_load_dwordx4 v8, s[4:7], s27 offen lds
    s_add_u32 m0, s32, 40960
    s_nop 0
    buffer_load_dwordx4 v9, s[12:15], s30 offen lds
    s_add_u32 s27, s27, 64
    s_add_u32 s30, s30, 32768
    ds_read_b128 v[72:75], v11 offset:49152
    ds_read_b64_tr_b16 v[84:85], v12 offset:51200
    ds_read_b64_tr_b16 v[86:87], v12 offset:51456
    s_waitcnt lgkmcnt(6)
    v_mfma_f32_32x32x16_bf16 v[48:63], v[76:79], v[64:67], v[48:63]
    s_waitcnt vmcnt(26)
    s_barrier
    ds_read_b128 v[64:67], v10 offset:53248
    ds_read_b64_tr_b16 v[76:77], v12 offset:53248
    ds_read_b64_tr_b16 v[78:79], v12 offset:53504
    s_waitcnt lgkmcnt(6)
    v_mfma_f32_32x32x16_bf16 v[48:63], v[80:83], v[68:71], v[48:63]
    ds_read_b128 v[68:71], v11 offset:53248
    ds_read_b64_tr_b16 v[80:81], v12 offset:55296
    ds_read_b64_tr_b16 v[82:83], v12 offset:55552
    s_waitcnt lgkmcnt(6)
    v_mfma_f32_32x32x16_bf16 v[48:63], v[84:87], v[72:75], v[48:63]
    s_waitcnt vmcnt(24)
    s_barrier
    ds_read_b128 v[72:75], v10 offset:57344
    ds_read_b64_tr_b16 v[84:85], v12 offset:57344
    ds_read_b64_tr_b16 v[86:87], v12 offset:57600
    s_waitcnt lgkmcnt(6)
    v_mfma_f32_32x32x16_bf16 v[48:63], v[76:79], v[64:67], v[48:63]
    ds_read_b128 v[64:67], v11 offset:57344
    ds_read_b64_tr_b16 v[76:77], v12 offset:59392
    ds_read_b64_tr_b16 v[78:79], v12 offset:59648
    s_waitcnt lgkmcnt(6)
    v_mfma_f32_32x32x16_bf16 v[48:63], v[80:83], v[68:71], v[48:63]
    s_waitcnt vmcnt(22)
    s_barrier
    ds_read_b128 v[68:71], v10 offset:61440
    ds_read_b64_tr_b16 v[80:81], v12 offset:61440
    ds_read_b64_tr_b16 v[82:83], v12 offset:61696
    s_waitcnt lgkmcnt(6)
    v_mfma_f32_32x32x16_bf16 v[48:63], v[84:87], v[72:75], v[48:63]
    ds_read_b128 v[72:75], v11 offset:61440
    ds_read_b64_tr_b16 v[84:85], v12 offset:63488
    ds_read_b64_tr_b16 v[86:87], v12 offset:63744
    s_waitcnt lgkmcnt(6)
    v_mfma_f32_32x32x16_bf16 v[48:63], v[76:79], v[64:67], v[48:63]
    s_waitcnt vmcnt(20)
    s_barrier
    ds_read_b128 v[64:67], v10 offset:0
    ds_read_b64_tr_b16 v[76:77], v12 offset:0
    ds_read_b64_tr_b16 v[78:79], v12 offset:256
    s_waitcnt lgkmcnt(6)
    v_mfma_f32_32x32x16_bf16 v[48:63], v[80:83], v[68:71], v[48:63]
    ds_read_b128 v[68:71], v11 offset:0
    ds_read_b64_tr_b16 v[80:81], v12 offset:2048
    ds_read_b64_tr_b16 v[82:83], v12 offset:2304
    s_waitcnt lgkmcnt(6)
    v_mfma_f32_32x32x16_bf16 v[48:63], v[84:87], v[72:75], v[48:63]
    s_waitcnt vmcnt(18)
    s_barrier
    ds_read_b128 v[72:75], v10 offset:4096
    ds_read_b64_tr_b16 v[84:85], v12 offset:4096
    ds_read_b64_tr_b16 v[86:87], v12 offset:4352
    s_waitcnt lgkmcnt(6)
    v_mfma_f32_32x32x16_bf16 v[48:63], v[76:79], v[64:67], v[48:63]
    ds_read_b128 v[64:67], v11 offset:4096
    ds_read_b64_tr_b16 v[76:77], v12 offset:6144
    ds_read_b64_tr_b16 v[78:79], v12 offset:6400
    s_waitcnt lgkmcnt(6)
    v_mfma_f32_32x32x16_bf16 v[48:63], v[80:83], v[68:71], v[48:63]
    s_waitcnt vmcnt(16)
    s_barrier
    ds_read_b128 v[68:71], v10 offset:8192
    ds_read_b64_tr_b16 v[80:81], v12 offset:8192
    ds_read_b64_tr_b16 v[82:83], v12 offset:8448
    s_waitcnt lgkmcnt(6)
    v_mfma_f32_32x32x16_bf16 v[48:63], v[84:87], v[72:75], v[48:63]
    ds_read_b128 v[72:75], v11 offset:8192
    ds_read_b64_tr_b16 v[84:85], v12 offset:10240
    ds_read_b64_tr_b16 v[86:87], v12 offset:10496
    s_waitcnt lgkmcnt(6)
    v_mfma_f32_32x32x16_bf16 v[48:63], v[76:79], v[64:67], v[48:63]
    s_waitcnt vmcnt(14)
    s_barrier
    ds_read_b128 v[64:67], v10 offset:12288
    ds_read_b64_tr_b16 v[76:77], v12 offset:12288
    ds_read_b64_tr_b16 v[78:79], v12 offset:12544
    s_waitcnt lgkmcnt(6)
    v_mfma_f32_32x32x16_bf16 v[48:63], v[80:83], v[68:71], v[48:63]
    ds_read_b128 v[68:71], v11 offset:12288
    ds_read_b64_tr_b16 v[80:81], v12 offset:14336
    ds_read_b64_tr_b16 v[82:83], v12 offset:14592
    s_waitcnt lgkmcnt(6)
    v_mfma_f32_32x32x16_bf16 v[48:63], v[84:87], v[72:75], v[48:63]
    s_waitcnt vmcnt(12)
    s_barrier
    ds_read_b128 v[72:75], v10 offset:16384
    ds_read_b64_tr_b16 v[84:85], v12 offset:16384
    ds_read_b64_tr_b16 v[86:87], v12 offset:16640
    s_waitcnt lgkmcnt(6)
    v_mfma_f32_32x32x16_bf16 v[48:63], v[76:79], v[64:67], v[48:63]
    ds_read_b128 v[64:67], v11 offset:16384
    ds_read_b64_tr_b16 v[76:77], v12 offset:18432
    ds_read_b64_tr_b16 v[78:79], v12 offset:18688
    s_waitcnt lgkmcnt(6)
    v_mfma_f32_32x32x16_bf16 v[48:63], v[80:83], v[68:71], v[48:63]
    s_waitcnt vmcnt(10)
    s_barrier
    ds_read_b128 v[68:71], v10 offset:20480
    ds_read_b64_tr_b16 v[80:81], v12 offset:20480
    ds_read_b64_tr_b16 v[82:83], v12 offset:20736
    s_waitcnt lgkmcnt(6)
    v_mfma_f32_32x32x16_bf16 v[48:63], v[84:87], v[72:75], v[48:63]
    ds_read_b128 v[72:75], v11 offset:20480
    ds_read_b64_tr_b16 v[84:85], v12 offset:22528
    ds_read_b64_tr_b16 v[86:87], v12 offset:22784
    s_waitcnt lgkmcnt(6)
    v_mfma_f32_32x32x16_bf16 v[48:63], v[76:79], v[64:67], v[48:63]
    s_waitcnt vmcnt(8)
    s_barrier
    ds_read_b128 v[64:67], v10 offset:24576
    ds_read_b64_tr_b16 v[76:77], v12 offset:24576
    ds_read_b64_tr_b16 v[78:79], v12 offset:24832
    s_waitcnt lgkmcnt(6)
    v_mfma_f32_32x32x16_bf16 v[48:63], v[80:83], v[68:71], v[48:63]
    ds_read_b128 v[68:71], v11 offset:24576
    ds_read_b64_tr_b16 v[80:81], v12 offset:26624
    ds_read_b64_tr_b16 v[82:83], v12 offset:26880
    s_waitcnt lgkmcnt(6)
    v_mfma_f32_32x32x16_bf16 v[48:63], v[84:87], v[72:75], v[48:63]
    s_waitcnt vmcnt(6)
    s_barrier
    ds_read_b128 v[72:75], v10 offset:28672
    ds_read_b64_tr_b16 v[84:85], v12 offset:28672
    ds_read_b64_tr_b16 v[86:87], v12 offset:28928
    s_waitcnt lgkmcnt(6)
    v_mfma_f32_32x32x16_bf16 v[48:63], v[76:79], v[64:67], v[48:63]
    ds_read_b128 v[64:67], v11 offset:28672
    ds_read_b64_tr_b16 v[76:77], v12 offset:30720
    ds_read_b64_tr_b16 v[78:79], v12 offset:30976
    s_waitcnt lgkmcnt(6)
    v_mfma_f32_32x32x16_bf16 v[48:63], v[80:83], v[68:71], v[48:63]
    s_waitcnt vmcnt(4)
    s_barrier
    ds_read_b128 v[68:71], v10 offset:32768
    ds_read_b64_tr_b16 v[80:81], v12 offset:32768
    ds_read_b64_tr_b16 v[82:83], v12 offset:33024
    s_waitcnt lgkmcnt(6)
    v_mfma_f32_32x32x16_bf16 v[48:63], v[84:87], v[72:75], v[48:63]
    ds_read_b128 v[72:75], v11 offset:32768
    ds_read_b64_tr_b16 v[84:85], v12 offset:34816
    ds_read_b64_tr_b16 v[86:87], v12 offset:35072
    s_waitcnt lgkmcnt(6)
    v_mfma_f32_32x32x16_bf16 v[48:63], v[76:79], v[64:67], v[48:63]
    s_waitcnt vmcnt(2)
    s_barrier
    ds_read_b128 v[64:67], v10 offset:36864
    ds_read_b64_tr_b16 v[76:77], v12 offset:36864
    ds_read_b64_tr_b16 v[78:79], v12 offset:37120
    s_waitcnt lgkmcnt(6)
    v_mfma_f32_32x32x16_bf16 v[48:63], v[80:83], v[68:71], v[48:63]
    ds_read_b128 v[68:71], v11 offset:36864
    ds_read_b64_tr_b16 v[80:81], v12 offset:38912
    ds_read_b64_tr_b16 v[82:83], v12 offset:39168
    s_waitcnt lgkmcnt(6)
    v_mfma_f32_32x32x16_bf16 v[48:63], v[84:87], v[72:75], v[48:63]
    s_waitcnt vmcnt(0)
    s_barrier
    ds_read_b128 v[72:75], v10 offset:40960
    ds_read_b64_tr_b16 v[84:85], v12 offset:40960
    ds_read_b64_tr_b16 v[86:87], v12 offset:41216
    s_waitcnt lgkmcnt(6)
    v_mfma_f32_32x32x16_bf16 v[48:63], v[76:79], v[64:67], v[48:63]
    ds_read_b128 v[64:67], v11 offset:40960
    ds_read_b64_tr_b16 v[76:77], v12 offset:43008
    ds_read_b64_tr_b16 v[78:79], v12 offset:43264
    s_waitcnt lgkmcnt(6)
    v_mfma_f32_32x32x16_bf16 v[48:63], v[80:83], v[68:71], v[48:63]
    s_waitcnt lgkmcnt(3)
    v_mfma_f32_32x32x16_bf16 v[48:63], v[84:87], v[72:75], v[48:63]
    s_waitcnt lgkmcnt(0)
    v_mfma_f32_32x32x16_bf16 v[48:63], v[76:79], v[64:67], v[48:63]
    s_mov_b32 s33, 0xbfb8aa3b
    s_nop 10
    v_mul_f32 v88, s33, v48
    v_mul_f32 v89, s33, v49
    v_mul_f32 v90, s33, v50
    v_mul_f32 v91, s33, v51
    v_mul_f32 v92, s33, v52
    v_mul_f32 v93, s33, v53
    v_mul_f32 v94, s33, v54
    v_mul_f32 v95, s33, v55
    v_mul_f32 v96, s33, v56
    v_mul_f32 v97, s33, v57
    v_mul_f32 v98, s33, v58
    v_mul_f32 v99, s33, v59
    v_mul_f32 v100, s33, v60
    v_mul_f32 v101, s33, v61
    v_mul_f32 v102, s33, v62
    v_mul_f32 v103, s33, v63
    v_exp_f32 v88, v88
    v_exp_f32 v89, v89
    v_exp_f32 v90, v90
    v_exp_f32 v91, v91
    v_exp_f32 v92, v92
    v_exp_f32 v93, v93
    v_exp_f32 v94, v94
    v_exp_f32 v95, v95
    v_exp_f32 v96, v96
    v_exp_f32 v97, v97
    v_exp_f32 v98, v98
    v_exp_f32 v99, v99
    v_exp_f32 v100, v100
    v_exp_f32 v101, v101
    v_exp_f32 v102, v102
    v_exp_f32 v103, v103
    v_add_f32 v88, 1.0, v88
    v_add_f32 v89, 1.0, v89
    v_add_f32 v90, 1.0, v90
    v_add_f32 v91, 1.0, v91
    v_add_f32 v92, 1.0, v92
    v_add_f32 v93, 1.0, v93
    v_add_f32 v94, 1.0, v94
    v_add_f32 v95, 1.0, v95
    v_add_f32 v96, 1.0, v96
    v_add_f32 v97, 1.0, v97
    v_add_f32 v98, 1.0, v98
    v_add_f32 v99, 1.0, v99
    v_add_f32 v100, 1.0, v100
    v_add_f32 v101, 1.0, v101
    v_add_f32 v102, 1.0, v102
    v_add_f32 v103, 1.0, v103
    v_rcp_f32 v88, v88
    v_rcp_f32 v89, v89
    v_rcp_f32 v90, v90
    v_rcp_f32 v91, v91
    v_rcp_f32 v92, v92
    v_rcp_f32 v93, v93
    v_rcp_f32 v94, v94
    v_rcp_f32 v95, v95
    v_rcp_f32 v96, v96
    v_rcp_f32 v97, v97
    v_rcp_f32 v98, v98
    v_rcp_f32 v99, v99
    v_rcp_f32 v100, v100
    v_rcp_f32 v101, v101
    v_rcp_f32 v102, v102
    v_rcp_f32 v103, v103
    v_mul_f32 v48, v48, v88
    v_mul_f32 v49, v49, v89
    v_mul_f32 v50, v50, v90
    v_mul_f32 v51, v51, v91
    v_mul_f32 v52, v52, v92
    v_mul_f32 v53, v53, v93
    v_mul_f32 v54, v54, v94
    v_mul_f32 v55, v55, v95
    v_mul_f32 v56, v56, v96
    v_mul_f32 v57, v57, v97
    v_mul_f32 v58, v58, v98
    v_mul_f32 v59, v59, v99
    v_mul_f32 v60, v60, v100
    v_mul_f32 v61, v61, v101
    v_mul_f32 v62, v62, v102
    v_mul_f32 v63, v63, v103
    v_lshlrev_b32 v88, 16, v16
    v_and_b32 v89, 0xffff0000, v16
    v_lshlrev_b32 v90, 16, v17
    v_and_b32 v91, 0xffff0000, v17
    v_lshlrev_b32 v92, 16, v18
    v_and_b32 v93, 0xffff0000, v18
    v_lshlrev_b32 v94, 16, v19
    v_and_b32 v95, 0xffff0000, v19
    v_lshlrev_b32 v96, 16, v20
    v_and_b32 v97, 0xffff0000, v20
    v_lshlrev_b32 v98, 16, v21
    v_and_b32 v99, 0xffff0000, v21
    v_lshlrev_b32 v100, 16, v22
    v_and_b32 v101, 0xffff0000, v22
    v_lshlrev_b32 v102, 16, v23
    v_and_b32 v103, 0xffff0000, v23
    v_fma_f32 v32, v32, v48, v88
    v_fma_f32 v33, v33, v49, v89
    v_fma_f32 v34, v34, v50, v90
    v_fma_f32 v35, v35, v51, v91
    v_fma_f32 v36, v36, v52, v92
    v_fma_f32 v37, v37, v53, v93
    v_fma_f32 v38, v38, v54, v94
    v_fma_f32 v39, v39, v55, v95
    v_fma_f32 v40, v40, v56, v96
    v_fma_f32 v41, v41, v57, v97
    v_fma_f32 v42, v42, v58, v98
    v_fma_f32 v43, v43, v59, v99
    v_fma_f32 v44, v44, v60, v100
    v_fma_f32 v45, v45, v61, v101
    v_fma_f32 v46, v46, v62, v102
    v_fma_f32 v47, v47, v63, v103
    v_cvt_pk_bf16_f32 v104, v32, v33
    v_cvt_pk_bf16_f32 v105, v34, v35
    v_cvt_pk_bf16_f32 v106, v36, v37
    v_cvt_pk_bf16_f32 v107, v38, v39
    v_cvt_pk_bf16_f32 v108, v40, v41
    v_cvt_pk_bf16_f32 v109, v42, v43
    v_cvt_pk_bf16_f32 v110, v44, v45
    v_cvt_pk_bf16_f32 v111, v46, v47
    v_permlane32_swap_b32 v104, v106
    v_permlane32_swap_b32 v105, v107
    v_permlane32_swap_b32 v108, v110
    v_permlane32_swap_b32 v109, v111
    v_lshl_add_u32 v13, v3, 3, v13
    buffer_store_dwordx4 v[104:107], v13, s[20:23], 0 offen
    buffer_store_dwordx4 v[108:111], v13, s[20:23], 0 offen offset:32
    s_waitcnt vmcnt(0)
    s_nop 1
L_k3_exit:
    s_endpgm
.section .rodata,"a"
.p2align 6
.amdhsa_kernel k3_out_kernel
  .amdhsa_next_free_vgpr 128
  .amdhsa_next_free_sgpr 64
  .amdhsa_accum_offset 128
  .amdhsa_group_segment_fixed_size 0
  .amdhsa_kernarg_size 80
  .amdhsa_user_sgpr_count 2
  .amdhsa_user_sgpr_kernarg_segment_ptr 1
  .amdhsa_system_sgpr_workgroup_id_x 1
.end_amdhsa_kernel
.text
```
